```python
import torch

def _softmax(x, axis=-1):
    return torch.softmax(x, dim=axis)

def _gelu(x):
    return torch.nn.functional.gelu(x, approximate='tanh')

def _silu(x):
    return torch.nn.functional.silu(x)

def _sigmoid(x):
    return torch.sigmoid(x)

def _layernorm(x, axis=-1, eps=1e-05):
    m = x.mean(dim=axis, keepdim=True)
    v = x.var(dim=axis, keepdim=True, unbiased=False)
    return (x - m) / torch.sqrt(v + eps)

def _scatter_add(tgt, idx, src, axis=0):
    return tgt.clone().index_add_(axis, idx, src)

def _segment_sum(src, seg, n):
    out = torch.zeros((n,) + src.shape[1:], dtype=src.dtype)
    return out.index_add_(0, seg, src)

def _pad(x, pw):
    flat = tuple((v for pair in reversed(pw) for v in pair))
    return torch.nn.functional.pad(x, flat)
kernel_name = 'adaLN_cond__gqa_block_cached__swiglu_ffn__prompt'

def setup_inputs():

    _w = lambda a: (lambda t: t.to(torch.bfloat16) if t.is_floating_point() else t)(torch.as_tensor(a))

    def _A_setup():
        B, Sq, D = (1, 2048, 1024)
        Hq, Hkv, Sk, Dh = (32, 4, 2048, 128)
        assert Hq % Hkv == 0, (Hq, Hkv)
        return {'x': _w((lambda *s: torch.randn(*s, dtype=torch.bfloat16) * 0.05)(B, Sq, D)), 'k_cache': _w((lambda *s: torch.randn(*s, dtype=torch.bfloat16) * 3.2)(B, Hkv, Sk, Dh)), 'v_cache': _w((lambda *s: torch.randn(*s, dtype=torch.bfloat16) * 0.4)(B, Hkv, Sk, Dh)), 'wq': _w((lambda *s: torch.randn(*s, dtype=torch.bfloat16) * 3.2)(D, Hq * Dh) * D ** (-0.5)), 'wo': _w((lambda *s: torch.randn(*s, dtype=torch.bfloat16) * 0.4)(Hq * Dh, D) * (Hq * Dh) ** (-0.5))}
    _A_in = _A_setup()

    def _B_setup():
        B, S, D, F = (1, 2048, 1024, 3584)
        return {'x': _w((lambda *s: torch.randn(*s, dtype=torch.bfloat16) * 0.05)(B, S, D)), 'w_gate': _w((lambda *s: torch.randn(*s, dtype=torch.bfloat16) * 0.05)(D, F)), 'w_up': _w((lambda *s: torch.randn(*s, dtype=torch.bfloat16) * 0.05)(D, F)), 'w_down': _w((lambda *s: torch.randn(*s, dtype=torch.bfloat16) * 0.05)(F, D))}
    _B_in = _B_setup()
    return {'A_x': _A_in['x'], 'A_k_cache': _A_in['k_cache'], 'A_v_cache': _A_in['v_cache'], 'A_wq': _A_in['wq'], 'A_wo': _A_in['wo'], 'B_x': _B_in['x'], 'B_w_gate': _B_in['w_gate'], 'B_w_up': _B_in['w_up'], 'B_w_down': _B_in['w_down'], 'c': _w((lambda *s: torch.randn(*s, dtype=torch.bfloat16) * 0.1)(1, 1024) * 8.0), 'w_mod': _w((lambda *s: torch.randn(*s, dtype=torch.bfloat16) * 0.1)(1024, 6 * 1024) * 1024 ** (-0.5) * 8.0)}

def reference(A_x, A_k_cache, A_v_cache, A_wq, A_wo, B_x, B_w_gate, B_w_up, B_w_down, c, w_mod):

    def _A_ref(x, k_cache, v_cache, wq, wo):
        B, Sq, D = x.shape
        Hq, Dh = (32, 128)
        Hkv = k_cache.shape[1]
        rep = Hq // Hkv
        q = (lambda x, *d: x.permute(*d))((x @ wq).reshape(B, Sq, Hq, Dh), 0, 2, 1, 3)
        k = (lambda x, n, axis: torch.repeat_interleave(x, n, dim=axis))(k_cache, rep, axis=1)
        v = (lambda x, n, axis: torch.repeat_interleave(x, n, dim=axis))(v_cache, rep, axis=1)
        scores = torch.einsum('bhqd,bhkd->bhqk', q, k) * Dh ** (-0.5)
        p = _softmax(scores, axis=-1)
        o = torch.einsum('bhqk,bhkd->bhqd', p, v)
        return (lambda x, *d: x.permute(*d))(o, 0, 2, 1, 3).reshape(B, Sq, Hq * Dh) @ wo

    def _B_ref(x, w_gate, w_up, w_down):
        g = _silu(x @ w_gate)
        u = x @ w_up
        return g * u @ w_down
    x = A_x
    mod = (_silu(c) @ w_mod).reshape(c.shape[0], 6, 1, -1)
    sa, ca, ga, sb, cb, gb = (mod[:, 0].clone(), mod[:, 1].clone(), mod[:, 2].clone(), mod[:, 3].clone(), mod[:, 4].clone(), mod[:, 5].clone())
    h = _layernorm(x, axis=-1) * (1 + ca) + sa
    x = x + ga * _A_ref(h, A_k_cache, A_v_cache, A_wq, A_wo)
    h = _layernorm(x, axis=-1) * (1 + cb) + sb
    x = x + gb * _B_ref(h, B_w_gate, B_w_up, B_w_down)
    return x
```

```asm
; @launch kernel=mod_kernel grid=(192,1,1) block=(256,1,1) lds=16384
; @launch kernel=ln1_kernel grid=(512,1,1) block=(256,1,1) lds=0
; @launch kernel=attn_kernel grid=(256,1,1) block=(512,1,1) lds=163840
; @launch kernel=wo_kernel grid=(256,1,1) block=(512,1,1) lds=131072
; @launch kernel=ln2_kernel grid=(512,1,1) block=(256,1,1) lds=0
; @launch kernel=gu_kernel grid=(256,1,1) block=(512,1,1) lds=131072
; @launch kernel=down_kernel grid=(256,1,1) block=(512,1,1) lds=147456
.amdgcn_target "amdgcn-amd-amdhsa--gfx950"
.text
.globl mod_kernel
.p2align 8
.type mod_kernel,@function
mod_kernel:
    s_cmp_ge_u32 s2, 192
    s_cbranch_scc1 L_mod_end
    s_load_dwordx2 s[4:5], s[0:1], 72
    s_load_dwordx2 s[6:7], s[0:1], 80
    s_load_dwordx2 s[8:9], s[0:1], 104
    v_lshrrev_b32 v1, 2, v0
    v_and_b32 v2, 3, v0
    v_lshlrev_b32 v3, 1, v1
    s_mov_b32 s3, 12288
    v_mul_lo_u32 v4, v1, s3
    v_lshl_add_u32 v4, v2, 4, v4
    s_lshl_b32 s3, s2, 6
    v_add_u32 v4, s3, v4
    s_waitcnt lgkmcnt(0)
    s_mov_b32 s12, s4
    s_mov_b32 s13, s5
    s_mov_b32 s14, 0x800
    s_mov_b32 s15, 0x00020000
    s_mov_b32 s16, s6
    s_mov_b32 s17, s7
    s_mov_b32 s18, 0xc00000
    s_mov_b32 s19, 0x00020000
    s_mov_b32 s20, s8
    s_mov_b32 s21, s9
    s_mov_b32 s22, 0x6000
    s_mov_b32 s23, 0x00020000
    buffer_load_ushort v10, v3, s[12:15], 0 offen offset:0
    buffer_load_ushort v11, v3, s[12:15], 0 offen offset:128
    buffer_load_ushort v12, v3, s[12:15], 0 offen offset:256
    buffer_load_ushort v13, v3, s[12:15], 0 offen offset:384
    buffer_load_ushort v14, v3, s[12:15], 0 offen offset:512
    buffer_load_ushort v15, v3, s[12:15], 0 offen offset:640
    buffer_load_ushort v16, v3, s[12:15], 0 offen offset:768
    buffer_load_ushort v17, v3, s[12:15], 0 offen offset:896
    buffer_load_ushort v18, v3, s[12:15], 0 offen offset:1024
    buffer_load_ushort v19, v3, s[12:15], 0 offen offset:1152
    buffer_load_ushort v20, v3, s[12:15], 0 offen offset:1280
    buffer_load_ushort v21, v3, s[12:15], 0 offen offset:1408
    buffer_load_ushort v22, v3, s[12:15], 0 offen offset:1536
    buffer_load_ushort v23, v3, s[12:15], 0 offen offset:1664
    buffer_load_ushort v24, v3, s[12:15], 0 offen offset:1792
    buffer_load_ushort v25, v3, s[12:15], 0 offen offset:1920
    s_mov_b32 s24, 0
    buffer_load_dwordx4 v[32:35], v4, s[16:19], s24 offen
    s_mov_b32 s24, 786432
    buffer_load_dwordx4 v[36:39], v4, s[16:19], s24 offen
    s_mov_b32 s24, 1572864
    buffer_load_dwordx4 v[40:43], v4, s[16:19], s24 offen
    s_mov_b32 s24, 2359296
    buffer_load_dwordx4 v[44:47], v4, s[16:19], s24 offen
    s_mov_b32 s24, 3145728
    buffer_load_dwordx4 v[48:51], v4, s[16:19], s24 offen
    s_mov_b32 s24, 3932160
    buffer_load_dwordx4 v[52:55], v4, s[16:19], s24 offen
    s_mov_b32 s24, 4718592
    buffer_load_dwordx4 v[56:59], v4, s[16:19], s24 offen
    s_mov_b32 s24, 5505024
    buffer_load_dwordx4 v[60:63], v4, s[16:19], s24 offen
    s_mov_b32 s24, 6291456
    buffer_load_dwordx4 v[64:67], v4, s[16:19], s24 offen
    s_mov_b32 s24, 7077888
    buffer_load_dwordx4 v[68:71], v4, s[16:19], s24 offen
    s_mov_b32 s24, 7864320
    buffer_load_dwordx4 v[72:75], v4, s[16:19], s24 offen
    s_mov_b32 s24, 8650752
    buffer_load_dwordx4 v[76:79], v4, s[16:19], s24 offen
    s_mov_b32 s24, 9437184
    buffer_load_dwordx4 v[80:83], v4, s[16:19], s24 offen
    s_mov_b32 s24, 10223616
    buffer_load_dwordx4 v[84:87], v4, s[16:19], s24 offen
    s_mov_b32 s24, 11010048
    buffer_load_dwordx4 v[88:91], v4, s[16:19], s24 offen
    s_mov_b32 s24, 11796480
    buffer_load_dwordx4 v[92:95], v4, s[16:19], s24 offen
    s_waitcnt vmcnt(16)
    s_mov_b32 s25, 0x3fb8aa3b
    v_lshlrev_b32 v10, 16, v10
    v_mul_f32 v5, s25, v10
    v_exp_f32 v5, -v5
    s_nop 0
    v_add_f32 v5, 1.0, v5
    v_rcp_f32 v6, v5
    s_nop 0
    v_mul_f32 v7, v10, v6
    v_fma_f32 v8, -v7, v5, v10
    v_fma_f32 v7, v8, v6, v7
    v_cvt_pk_bf16_f32 v10, 0, v7
    v_lshlrev_b32 v11, 16, v11
    v_mul_f32 v5, s25, v11
    v_exp_f32 v5, -v5
    s_nop 0
    v_add_f32 v5, 1.0, v5
    v_rcp_f32 v6, v5
    s_nop 0
    v_mul_f32 v7, v11, v6
    v_fma_f32 v8, -v7, v5, v11
    v_fma_f32 v7, v8, v6, v7
    v_cvt_pk_bf16_f32 v11, 0, v7
    v_lshlrev_b32 v12, 16, v12
    v_mul_f32 v5, s25, v12
    v_exp_f32 v5, -v5
    s_nop 0
    v_add_f32 v5, 1.0, v5
    v_rcp_f32 v6, v5
    s_nop 0
    v_mul_f32 v7, v12, v6
    v_fma_f32 v8, -v7, v5, v12
    v_fma_f32 v7, v8, v6, v7
    v_cvt_pk_bf16_f32 v12, 0, v7
    v_lshlrev_b32 v13, 16, v13
    v_mul_f32 v5, s25, v13
    v_exp_f32 v5, -v5
    s_nop 0
    v_add_f32 v5, 1.0, v5
    v_rcp_f32 v6, v5
    s_nop 0
    v_mul_f32 v7, v13, v6
    v_fma_f32 v8, -v7, v5, v13
    v_fma_f32 v7, v8, v6, v7
    v_cvt_pk_bf16_f32 v13, 0, v7
    v_lshlrev_b32 v14, 16, v14
    v_mul_f32 v5, s25, v14
    v_exp_f32 v5, -v5
    s_nop 0
    v_add_f32 v5, 1.0, v5
    v_rcp_f32 v6, v5
    s_nop 0
    v_mul_f32 v7, v14, v6
    v_fma_f32 v8, -v7, v5, v14
    v_fma_f32 v7, v8, v6, v7
    v_cvt_pk_bf16_f32 v14, 0, v7
    v_lshlrev_b32 v15, 16, v15
    v_mul_f32 v5, s25, v15
    v_exp_f32 v5, -v5
    s_nop 0
    v_add_f32 v5, 1.0, v5
    v_rcp_f32 v6, v5
    s_nop 0
    v_mul_f32 v7, v15, v6
    v_fma_f32 v8, -v7, v5, v15
    v_fma_f32 v7, v8, v6, v7
    v_cvt_pk_bf16_f32 v15, 0, v7
    v_lshlrev_b32 v16, 16, v16
    v_mul_f32 v5, s25, v16
    v_exp_f32 v5, -v5
    s_nop 0
    v_add_f32 v5, 1.0, v5
    v_rcp_f32 v6, v5
    s_nop 0
    v_mul_f32 v7, v16, v6
    v_fma_f32 v8, -v7, v5, v16
    v_fma_f32 v7, v8, v6, v7
    v_cvt_pk_bf16_f32 v16, 0, v7
    v_lshlrev_b32 v17, 16, v17
    v_mul_f32 v5, s25, v17
    v_exp_f32 v5, -v5
    s_nop 0
    v_add_f32 v5, 1.0, v5
    v_rcp_f32 v6, v5
    s_nop 0
    v_mul_f32 v7, v17, v6
    v_fma_f32 v8, -v7, v5, v17
    v_fma_f32 v7, v8, v6, v7
    v_cvt_pk_bf16_f32 v17, 0, v7
    v_lshlrev_b32 v18, 16, v18
    v_mul_f32 v5, s25, v18
    v_exp_f32 v5, -v5
    s_nop 0
    v_add_f32 v5, 1.0, v5
    v_rcp_f32 v6, v5
    s_nop 0
    v_mul_f32 v7, v18, v6
    v_fma_f32 v8, -v7, v5, v18
    v_fma_f32 v7, v8, v6, v7
    v_cvt_pk_bf16_f32 v18, 0, v7
    v_lshlrev_b32 v19, 16, v19
    v_mul_f32 v5, s25, v19
    v_exp_f32 v5, -v5
    s_nop 0
    v_add_f32 v5, 1.0, v5
    v_rcp_f32 v6, v5
    s_nop 0
    v_mul_f32 v7, v19, v6
    v_fma_f32 v8, -v7, v5, v19
    v_fma_f32 v7, v8, v6, v7
    v_cvt_pk_bf16_f32 v19, 0, v7
    v_lshlrev_b32 v20, 16, v20
    v_mul_f32 v5, s25, v20
    v_exp_f32 v5, -v5
    s_nop 0
    v_add_f32 v5, 1.0, v5
    v_rcp_f32 v6, v5
    s_nop 0
    v_mul_f32 v7, v20, v6
    v_fma_f32 v8, -v7, v5, v20
    v_fma_f32 v7, v8, v6, v7
    v_cvt_pk_bf16_f32 v20, 0, v7
    v_lshlrev_b32 v21, 16, v21
    v_mul_f32 v5, s25, v21
    v_exp_f32 v5, -v5
    s_nop 0
    v_add_f32 v5, 1.0, v5
    v_rcp_f32 v6, v5
    s_nop 0
    v_mul_f32 v7, v21, v6
    v_fma_f32 v8, -v7, v5, v21
    v_fma_f32 v7, v8, v6, v7
    v_cvt_pk_bf16_f32 v21, 0, v7
    v_lshlrev_b32 v22, 16, v22
    v_mul_f32 v5, s25, v22
    v_exp_f32 v5, -v5
    s_nop 0
    v_add_f32 v5, 1.0, v5
    v_rcp_f32 v6, v5
    s_nop 0
    v_mul_f32 v7, v22, v6
    v_fma_f32 v8, -v7, v5, v22
    v_fma_f32 v7, v8, v6, v7
    v_cvt_pk_bf16_f32 v22, 0, v7
    v_lshlrev_b32 v23, 16, v23
    v_mul_f32 v5, s25, v23
    v_exp_f32 v5, -v5
    s_nop 0
    v_add_f32 v5, 1.0, v5
    v_rcp_f32 v6, v5
    s_nop 0
    v_mul_f32 v7, v23, v6
    v_fma_f32 v8, -v7, v5, v23
    v_fma_f32 v7, v8, v6, v7
    v_cvt_pk_bf16_f32 v23, 0, v7
    v_lshlrev_b32 v24, 16, v24
    v_mul_f32 v5, s25, v24
    v_exp_f32 v5, -v5
    s_nop 0
    v_add_f32 v5, 1.0, v5
    v_rcp_f32 v6, v5
    s_nop 0
    v_mul_f32 v7, v24, v6
    v_fma_f32 v8, -v7, v5, v24
    v_fma_f32 v7, v8, v6, v7
    v_cvt_pk_bf16_f32 v24, 0, v7
    v_lshlrev_b32 v25, 16, v25
    v_mul_f32 v5, s25, v25
    v_exp_f32 v5, -v5
    s_nop 0
    v_add_f32 v5, 1.0, v5
    v_rcp_f32 v6, v5
    s_nop 0
    v_mul_f32 v7, v25, v6
    v_fma_f32 v8, -v7, v5, v25
    v_fma_f32 v7, v8, v6, v7
    v_cvt_pk_bf16_f32 v25, 0, v7
    v_mov_b32 v100, 0
    v_mov_b32 v101, 0
    v_mov_b32 v102, 0
    v_mov_b32 v103, 0
    v_mov_b32 v104, 0
    v_mov_b32 v105, 0
    v_mov_b32 v106, 0
    v_mov_b32 v107, 0
    s_mov_b32 s26, 0xffff0000
    s_waitcnt vmcnt(15)
    v_lshlrev_b32 v5, 16, v32
    v_and_b32 v6, s26, v32
    v_fmac_f32 v100, v10, v5
    v_fmac_f32 v101, v10, v6
    v_lshlrev_b32 v5, 16, v33
    v_and_b32 v6, s26, v33
    v_fmac_f32 v102, v10, v5
    v_fmac_f32 v103, v10, v6
    v_lshlrev_b32 v5, 16, v34
    v_and_b32 v6, s26, v34
    v_fmac_f32 v104, v10, v5
    v_fmac_f32 v105, v10, v6
    v_lshlrev_b32 v5, 16, v35
    v_and_b32 v6, s26, v35
    v_fmac_f32 v106, v10, v5
    v_fmac_f32 v107, v10, v6
    s_waitcnt vmcnt(14)
    v_lshlrev_b32 v5, 16, v36
    v_and_b32 v6, s26, v36
    v_fmac_f32 v100, v11, v5
    v_fmac_f32 v101, v11, v6
    v_lshlrev_b32 v5, 16, v37
    v_and_b32 v6, s26, v37
    v_fmac_f32 v102, v11, v5
    v_fmac_f32 v103, v11, v6
    v_lshlrev_b32 v5, 16, v38
    v_and_b32 v6, s26, v38
    v_fmac_f32 v104, v11, v5
    v_fmac_f32 v105, v11, v6
    v_lshlrev_b32 v5, 16, v39
    v_and_b32 v6, s26, v39
    v_fmac_f32 v106, v11, v5
    v_fmac_f32 v107, v11, v6
    s_waitcnt vmcnt(13)
    v_lshlrev_b32 v5, 16, v40
    v_and_b32 v6, s26, v40
    v_fmac_f32 v100, v12, v5
    v_fmac_f32 v101, v12, v6
    v_lshlrev_b32 v5, 16, v41
    v_and_b32 v6, s26, v41
    v_fmac_f32 v102, v12, v5
    v_fmac_f32 v103, v12, v6
    v_lshlrev_b32 v5, 16, v42
    v_and_b32 v6, s26, v42
    v_fmac_f32 v104, v12, v5
    v_fmac_f32 v105, v12, v6
    v_lshlrev_b32 v5, 16, v43
    v_and_b32 v6, s26, v43
    v_fmac_f32 v106, v12, v5
    v_fmac_f32 v107, v12, v6
    s_waitcnt vmcnt(12)
    v_lshlrev_b32 v5, 16, v44
    v_and_b32 v6, s26, v44
    v_fmac_f32 v100, v13, v5
    v_fmac_f32 v101, v13, v6
    v_lshlrev_b32 v5, 16, v45
    v_and_b32 v6, s26, v45
    v_fmac_f32 v102, v13, v5
    v_fmac_f32 v103, v13, v6
    v_lshlrev_b32 v5, 16, v46
    v_and_b32 v6, s26, v46
    v_fmac_f32 v104, v13, v5
    v_fmac_f32 v105, v13, v6
    v_lshlrev_b32 v5, 16, v47
    v_and_b32 v6, s26, v47
    v_fmac_f32 v106, v13, v5
    v_fmac_f32 v107, v13, v6
    s_waitcnt vmcnt(11)
    v_lshlrev_b32 v5, 16, v48
    v_and_b32 v6, s26, v48
    v_fmac_f32 v100, v14, v5
    v_fmac_f32 v101, v14, v6
    v_lshlrev_b32 v5, 16, v49
    v_and_b32 v6, s26, v49
    v_fmac_f32 v102, v14, v5
    v_fmac_f32 v103, v14, v6
    v_lshlrev_b32 v5, 16, v50
    v_and_b32 v6, s26, v50
    v_fmac_f32 v104, v14, v5
    v_fmac_f32 v105, v14, v6
    v_lshlrev_b32 v5, 16, v51
    v_and_b32 v6, s26, v51
    v_fmac_f32 v106, v14, v5
    v_fmac_f32 v107, v14, v6
    s_waitcnt vmcnt(10)
    v_lshlrev_b32 v5, 16, v52
    v_and_b32 v6, s26, v52
    v_fmac_f32 v100, v15, v5
    v_fmac_f32 v101, v15, v6
    v_lshlrev_b32 v5, 16, v53
    v_and_b32 v6, s26, v53
    v_fmac_f32 v102, v15, v5
    v_fmac_f32 v103, v15, v6
    v_lshlrev_b32 v5, 16, v54
    v_and_b32 v6, s26, v54
    v_fmac_f32 v104, v15, v5
    v_fmac_f32 v105, v15, v6
    v_lshlrev_b32 v5, 16, v55
    v_and_b32 v6, s26, v55
    v_fmac_f32 v106, v15, v5
    v_fmac_f32 v107, v15, v6
    s_waitcnt vmcnt(9)
    v_lshlrev_b32 v5, 16, v56
    v_and_b32 v6, s26, v56
    v_fmac_f32 v100, v16, v5
    v_fmac_f32 v101, v16, v6
    v_lshlrev_b32 v5, 16, v57
    v_and_b32 v6, s26, v57
    v_fmac_f32 v102, v16, v5
    v_fmac_f32 v103, v16, v6
    v_lshlrev_b32 v5, 16, v58
    v_and_b32 v6, s26, v58
    v_fmac_f32 v104, v16, v5
    v_fmac_f32 v105, v16, v6
    v_lshlrev_b32 v5, 16, v59
    v_and_b32 v6, s26, v59
    v_fmac_f32 v106, v16, v5
    v_fmac_f32 v107, v16, v6
    s_waitcnt vmcnt(8)
    v_lshlrev_b32 v5, 16, v60
    v_and_b32 v6, s26, v60
    v_fmac_f32 v100, v17, v5
    v_fmac_f32 v101, v17, v6
    v_lshlrev_b32 v5, 16, v61
    v_and_b32 v6, s26, v61
    v_fmac_f32 v102, v17, v5
    v_fmac_f32 v103, v17, v6
    v_lshlrev_b32 v5, 16, v62
    v_and_b32 v6, s26, v62
    v_fmac_f32 v104, v17, v5
    v_fmac_f32 v105, v17, v6
    v_lshlrev_b32 v5, 16, v63
    v_and_b32 v6, s26, v63
    v_fmac_f32 v106, v17, v5
    v_fmac_f32 v107, v17, v6
    s_waitcnt vmcnt(7)
    v_lshlrev_b32 v5, 16, v64
    v_and_b32 v6, s26, v64
    v_fmac_f32 v100, v18, v5
    v_fmac_f32 v101, v18, v6
    v_lshlrev_b32 v5, 16, v65
    v_and_b32 v6, s26, v65
    v_fmac_f32 v102, v18, v5
    v_fmac_f32 v103, v18, v6
    v_lshlrev_b32 v5, 16, v66
    v_and_b32 v6, s26, v66
    v_fmac_f32 v104, v18, v5
    v_fmac_f32 v105, v18, v6
    v_lshlrev_b32 v5, 16, v67
    v_and_b32 v6, s26, v67
    v_fmac_f32 v106, v18, v5
    v_fmac_f32 v107, v18, v6
    s_waitcnt vmcnt(6)
    v_lshlrev_b32 v5, 16, v68
    v_and_b32 v6, s26, v68
    v_fmac_f32 v100, v19, v5
    v_fmac_f32 v101, v19, v6
    v_lshlrev_b32 v5, 16, v69
    v_and_b32 v6, s26, v69
    v_fmac_f32 v102, v19, v5
    v_fmac_f32 v103, v19, v6
    v_lshlrev_b32 v5, 16, v70
    v_and_b32 v6, s26, v70
    v_fmac_f32 v104, v19, v5
    v_fmac_f32 v105, v19, v6
    v_lshlrev_b32 v5, 16, v71
    v_and_b32 v6, s26, v71
    v_fmac_f32 v106, v19, v5
    v_fmac_f32 v107, v19, v6
    s_waitcnt vmcnt(5)
    v_lshlrev_b32 v5, 16, v72
    v_and_b32 v6, s26, v72
    v_fmac_f32 v100, v20, v5
    v_fmac_f32 v101, v20, v6
    v_lshlrev_b32 v5, 16, v73
    v_and_b32 v6, s26, v73
    v_fmac_f32 v102, v20, v5
    v_fmac_f32 v103, v20, v6
    v_lshlrev_b32 v5, 16, v74
    v_and_b32 v6, s26, v74
    v_fmac_f32 v104, v20, v5
    v_fmac_f32 v105, v20, v6
    v_lshlrev_b32 v5, 16, v75
    v_and_b32 v6, s26, v75
    v_fmac_f32 v106, v20, v5
    v_fmac_f32 v107, v20, v6
    s_waitcnt vmcnt(4)
    v_lshlrev_b32 v5, 16, v76
    v_and_b32 v6, s26, v76
    v_fmac_f32 v100, v21, v5
    v_fmac_f32 v101, v21, v6
    v_lshlrev_b32 v5, 16, v77
    v_and_b32 v6, s26, v77
    v_fmac_f32 v102, v21, v5
    v_fmac_f32 v103, v21, v6
    v_lshlrev_b32 v5, 16, v78
    v_and_b32 v6, s26, v78
    v_fmac_f32 v104, v21, v5
    v_fmac_f32 v105, v21, v6
    v_lshlrev_b32 v5, 16, v79
    v_and_b32 v6, s26, v79
    v_fmac_f32 v106, v21, v5
    v_fmac_f32 v107, v21, v6
    s_waitcnt vmcnt(3)
    v_lshlrev_b32 v5, 16, v80
    v_and_b32 v6, s26, v80
    v_fmac_f32 v100, v22, v5
    v_fmac_f32 v101, v22, v6
    v_lshlrev_b32 v5, 16, v81
    v_and_b32 v6, s26, v81
    v_fmac_f32 v102, v22, v5
    v_fmac_f32 v103, v22, v6
    v_lshlrev_b32 v5, 16, v82
    v_and_b32 v6, s26, v82
    v_fmac_f32 v104, v22, v5
    v_fmac_f32 v105, v22, v6
    v_lshlrev_b32 v5, 16, v83
    v_and_b32 v6, s26, v83
    v_fmac_f32 v106, v22, v5
    v_fmac_f32 v107, v22, v6
    s_waitcnt vmcnt(2)
    v_lshlrev_b32 v5, 16, v84
    v_and_b32 v6, s26, v84
    v_fmac_f32 v100, v23, v5
    v_fmac_f32 v101, v23, v6
    v_lshlrev_b32 v5, 16, v85
    v_and_b32 v6, s26, v85
    v_fmac_f32 v102, v23, v5
    v_fmac_f32 v103, v23, v6
    v_lshlrev_b32 v5, 16, v86
    v_and_b32 v6, s26, v86
    v_fmac_f32 v104, v23, v5
    v_fmac_f32 v105, v23, v6
    v_lshlrev_b32 v5, 16, v87
    v_and_b32 v6, s26, v87
    v_fmac_f32 v106, v23, v5
    v_fmac_f32 v107, v23, v6
    s_waitcnt vmcnt(1)
    v_lshlrev_b32 v5, 16, v88
    v_and_b32 v6, s26, v88
    v_fmac_f32 v100, v24, v5
    v_fmac_f32 v101, v24, v6
    v_lshlrev_b32 v5, 16, v89
    v_and_b32 v6, s26, v89
    v_fmac_f32 v102, v24, v5
    v_fmac_f32 v103, v24, v6
    v_lshlrev_b32 v5, 16, v90
    v_and_b32 v6, s26, v90
    v_fmac_f32 v104, v24, v5
    v_fmac_f32 v105, v24, v6
    v_lshlrev_b32 v5, 16, v91
    v_and_b32 v6, s26, v91
    v_fmac_f32 v106, v24, v5
    v_fmac_f32 v107, v24, v6
    s_waitcnt vmcnt(0)
    v_lshlrev_b32 v5, 16, v92
    v_and_b32 v6, s26, v92
    v_fmac_f32 v100, v25, v5
    v_fmac_f32 v101, v25, v6
    v_lshlrev_b32 v5, 16, v93
    v_and_b32 v6, s26, v93
    v_fmac_f32 v102, v25, v5
    v_fmac_f32 v103, v25, v6
    v_lshlrev_b32 v5, 16, v94
    v_and_b32 v6, s26, v94
    v_fmac_f32 v104, v25, v5
    v_fmac_f32 v105, v25, v6
    v_lshlrev_b32 v5, 16, v95
    v_and_b32 v6, s26, v95
    v_fmac_f32 v106, v25, v5
    v_fmac_f32 v107, v25, v6
    v_lshlrev_b32 v5, 5, v0
    ds_write_b128 v5, v[100:103]
    ds_write_b128 v5, v[104:107] offset:16
    v_and_b32 v6, 31, v0
    v_lshrrev_b32 v7, 5, v0
    v_lshlrev_b32 v8, 10, v7
    v_lshl_add_u32 v8, v6, 2, v8
    s_waitcnt lgkmcnt(0)
    s_barrier
    ds_read_b32 v10, v8 offset:0
    ds_read_b32 v11, v8 offset:128
    ds_read_b32 v12, v8 offset:256
    ds_read_b32 v13, v8 offset:384
    ds_read_b32 v14, v8 offset:512
    ds_read_b32 v15, v8 offset:640
    ds_read_b32 v16, v8 offset:768
    ds_read_b32 v17, v8 offset:896
    s_waitcnt lgkmcnt(0)
    v_add_f32 v10, v10, v11
    v_add_f32 v10, v10, v12
    v_add_f32 v10, v10, v13
    v_add_f32 v10, v10, v14
    v_add_f32 v10, v10, v15
    v_add_f32 v10, v10, v16
    v_add_f32 v10, v10, v17
    v_lshlrev_b32 v8, 7, v7
    v_lshl_add_u32 v8, v6, 2, v8
    ds_write_b32 v8, v10 offset:8192
    v_lshlrev_b32 v9, 2, v6
    s_waitcnt lgkmcnt(0)
    s_barrier
    ds_read_b32 v10, v9 offset:8192
    ds_read_b32 v11, v9 offset:8320
    ds_read_b32 v12, v9 offset:8448
    ds_read_b32 v13, v9 offset:8576
    ds_read_b32 v14, v9 offset:8704
    ds_read_b32 v15, v9 offset:8832
    ds_read_b32 v16, v9 offset:8960
    ds_read_b32 v17, v9 offset:9088
    s_waitcnt lgkmcnt(0)
    v_add_f32 v10, v10, v11
    v_add_f32 v10, v10, v12
    v_add_f32 v10, v10, v13
    v_add_f32 v10, v10, v14
    v_add_f32 v10, v10, v15
    v_add_f32 v10, v10, v16
    v_add_f32 v10, v10, v17
    v_cvt_pk_bf16_f32 v10, 0, v10
    s_lshl_b32 s3, s2, 7
    v_add_u32 v9, s3, v9
    v_cmp_gt_u32 vcc, 32, v0
    s_nop 0
    s_and_saveexec_b64 s[28:29], vcc
    s_cbranch_execz L_mod_end
    buffer_store_dword v10, v9, s[20:23], 0 offen
L_mod_end:
    s_endpgm
.globl ln1_kernel
.p2align 8
.type ln1_kernel,@function
ln1_kernel:
    s_cmp_ge_u32 s2, 512
    s_cbranch_scc1 L_ln1_kernel_end
    s_load_dwordx2 s[4:5], s[0:1], 0
    s_load_dwordx2 s[8:9], s[0:1], 104
    s_load_dwordx2 s[28:29], s[0:1], 104
    v_lshrrev_b32 v1, 6, v0
    v_and_b32 v2, 63, v0
    s_lshl_b32 s3, s2, 2
    v_add_u32 v1, s3, v1
    v_lshlrev_b32 v33, 12, v1
    v_lshl_add_u32 v33, v2, 6, v33
    v_lshlrev_b32 v1, 11, v1
    v_lshl_add_u32 v1, v2, 4, v1
    v_lshlrev_b32 v3, 5, v2
    s_waitcnt lgkmcnt(0)
    s_mov_b32 s12, s4
    s_mov_b32 s13, s5
    s_mov_b32 s14, 0x400000
    s_mov_b32 s15, 0x00020000
    s_mov_b32 s16, s8
    s_mov_b32 s17, s9
    s_mov_b32 s18, 0x6000
    s_mov_b32 s19, 0x00020000
    s_add_u32 s20, s8, 0x100000
    s_addc_u32 s21, s9, 0
    s_mov_b32 s22, 0x400000
    s_mov_b32 s23, 0x00020000
    buffer_load_dwordx4 v[4:7], v1, s[12:15], 0 offen
    buffer_load_dwordx4 v[8:11], v1, s[12:15], 0 offen offset:1024
    s_mov_b32 s24, 0
    s_mov_b32 s25, 4096
    buffer_load_dwordx4 v[48:51], v3, s[16:19], s24 offen
    buffer_load_dwordx4 v[52:55], v3, s[16:19], s24 offen offset:16
    buffer_load_dwordx4 v[56:59], v3, s[16:19], s24 offen offset:2048
    buffer_load_dwordx4 v[60:63], v3, s[16:19], s24 offen offset:2064
    buffer_load_dwordx4 v[64:67], v3, s[16:19], s25 offen
    buffer_load_dwordx4 v[68:71], v3, s[16:19], s25 offen offset:16
    buffer_load_dwordx4 v[72:75], v3, s[16:19], s25 offen offset:2048
    buffer_load_dwordx4 v[76:79], v3, s[16:19], s25 offen offset:2064
    s_mov_b32 s26, 0xffff0000
    s_waitcnt vmcnt(8)
    v_lshlrev_b32 v16, 16, v4
    v_and_b32 v17, s26, v4
    v_lshlrev_b32 v18, 16, v5
    v_and_b32 v19, s26, v5
    v_lshlrev_b32 v20, 16, v6
    v_and_b32 v21, s26, v6
    v_lshlrev_b32 v22, 16, v7
    v_and_b32 v23, s26, v7
    v_lshlrev_b32 v24, 16, v8
    v_and_b32 v25, s26, v8
    v_lshlrev_b32 v26, 16, v9
    v_and_b32 v27, s26, v9
    v_lshlrev_b32 v28, 16, v10
    v_and_b32 v29, s26, v10
    v_lshlrev_b32 v30, 16, v11
    v_and_b32 v31, s26, v11
    v_add_f32 v12, v16, v17
    v_add_f32 v12, v12, v18
    v_add_f32 v12, v12, v19
    v_add_f32 v12, v12, v20
    v_add_f32 v12, v12, v21
    v_add_f32 v12, v12, v22
    v_add_f32 v12, v12, v23
    v_add_f32 v12, v12, v24
    v_add_f32 v12, v12, v25
    v_add_f32 v12, v12, v26
    v_add_f32 v12, v12, v27
    v_add_f32 v12, v12, v28
    v_add_f32 v12, v12, v29
    v_add_f32 v12, v12, v30
    v_add_f32 v12, v12, v31
    ds_swizzle_b32 v13, v12 offset:0x41f
    s_waitcnt lgkmcnt(0)
    v_add_f32 v12, v12, v13
    ds_swizzle_b32 v13, v12 offset:0x81f
    s_waitcnt lgkmcnt(0)
    v_add_f32 v12, v12, v13
    ds_swizzle_b32 v13, v12 offset:0x101f
    s_waitcnt lgkmcnt(0)
    v_add_f32 v12, v12, v13
    ds_swizzle_b32 v13, v12 offset:0x201f
    s_waitcnt lgkmcnt(0)
    v_add_f32 v12, v12, v13
    ds_swizzle_b32 v13, v12 offset:0x401f
    s_waitcnt lgkmcnt(0)
    v_add_f32 v12, v12, v13
    v_mov_b32 v13, v12
    s_nop 1
    v_permlane32_swap_b32 v12, v13
    v_add_f32 v12, v12, v13
    v_mul_f32 v12, 0x3a800000, v12
    v_mov_b32 v14, 0
    v_sub_f32 v13, v16, v12
    v_fmac_f32 v14, v13, v13
    v_sub_f32 v13, v17, v12
    v_fmac_f32 v14, v13, v13
    v_sub_f32 v13, v18, v12
    v_fmac_f32 v14, v13, v13
    v_sub_f32 v13, v19, v12
    v_fmac_f32 v14, v13, v13
    v_sub_f32 v13, v20, v12
    v_fmac_f32 v14, v13, v13
    v_sub_f32 v13, v21, v12
    v_fmac_f32 v14, v13, v13
    v_sub_f32 v13, v22, v12
    v_fmac_f32 v14, v13, v13
    v_sub_f32 v13, v23, v12
    v_fmac_f32 v14, v13, v13
    v_sub_f32 v13, v24, v12
    v_fmac_f32 v14, v13, v13
    v_sub_f32 v13, v25, v12
    v_fmac_f32 v14, v13, v13
    v_sub_f32 v13, v26, v12
    v_fmac_f32 v14, v13, v13
    v_sub_f32 v13, v27, v12
    v_fmac_f32 v14, v13, v13
    v_sub_f32 v13, v28, v12
    v_fmac_f32 v14, v13, v13
    v_sub_f32 v13, v29, v12
    v_fmac_f32 v14, v13, v13
    v_sub_f32 v13, v30, v12
    v_fmac_f32 v14, v13, v13
    v_sub_f32 v13, v31, v12
    v_fmac_f32 v14, v13, v13
    ds_swizzle_b32 v13, v14 offset:0x41f
    s_waitcnt lgkmcnt(0)
    v_add_f32 v14, v14, v13
    ds_swizzle_b32 v13, v14 offset:0x81f
    s_waitcnt lgkmcnt(0)
    v_add_f32 v14, v14, v13
    ds_swizzle_b32 v13, v14 offset:0x101f
    s_waitcnt lgkmcnt(0)
    v_add_f32 v14, v14, v13
    ds_swizzle_b32 v13, v14 offset:0x201f
    s_waitcnt lgkmcnt(0)
    v_add_f32 v14, v14, v13
    ds_swizzle_b32 v13, v14 offset:0x401f
    s_waitcnt lgkmcnt(0)
    v_add_f32 v14, v14, v13
    v_mov_b32 v13, v14
    s_nop 1
    v_permlane32_swap_b32 v14, v13
    v_add_f32 v14, v14, v13
    v_mul_f32 v14, 0x3a800000, v14
    v_cvt_pk_bf16_f32 v12, 0, v12
    v_cvt_pk_bf16_f32 v14, 0, v14
    v_add_f32 v14, 0x3727c5ac, v14
    v_cvt_pk_bf16_f32 v14, 0, v14
    v_sqrt_f32 v14, v14
    s_nop 0
    v_cvt_pk_bf16_f32 v14, 0, v14
    v_rcp_f32 v15, v14
    s_waitcnt vmcnt(0)
    v_sub_f32 v16, v16, v12
    v_cvt_pk_bf16_f32 v16, 0, v16
    v_mul_f32 v13, v16, v15
    v_fma_f32 v32, -v13, v14, v16
    v_fma_f32 v13, v32, v15, v13
    v_cvt_pk_bf16_f32 v13, 0, v13
    v_add_f32 v32, 1.0, v64
    v_cvt_pk_bf16_f32 v32, 0, v32
    v_mul_f32 v13, v13, v32
    v_cvt_pk_bf16_f32 v13, 0, v13
    v_add_f32 v16, v13, v48
    v_sub_f32 v17, v17, v12
    v_cvt_pk_bf16_f32 v17, 0, v17
    v_mul_f32 v13, v17, v15
    v_fma_f32 v32, -v13, v14, v17
    v_fma_f32 v13, v32, v15, v13
    v_cvt_pk_bf16_f32 v13, 0, v13
    v_add_f32 v32, 1.0, v65
    v_cvt_pk_bf16_f32 v32, 0, v32
    v_mul_f32 v13, v13, v32
    v_cvt_pk_bf16_f32 v13, 0, v13
    v_add_f32 v17, v13, v49
    v_sub_f32 v18, v18, v12
    v_cvt_pk_bf16_f32 v18, 0, v18
    v_mul_f32 v13, v18, v15
    v_fma_f32 v32, -v13, v14, v18
    v_fma_f32 v13, v32, v15, v13
    v_cvt_pk_bf16_f32 v13, 0, v13
    v_add_f32 v32, 1.0, v66
    v_cvt_pk_bf16_f32 v32, 0, v32
    v_mul_f32 v13, v13, v32
    v_cvt_pk_bf16_f32 v13, 0, v13
    v_add_f32 v18, v13, v50
    v_sub_f32 v19, v19, v12
    v_cvt_pk_bf16_f32 v19, 0, v19
    v_mul_f32 v13, v19, v15
    v_fma_f32 v32, -v13, v14, v19
    v_fma_f32 v13, v32, v15, v13
    v_cvt_pk_bf16_f32 v13, 0, v13
    v_add_f32 v32, 1.0, v67
    v_cvt_pk_bf16_f32 v32, 0, v32
    v_mul_f32 v13, v13, v32
    v_cvt_pk_bf16_f32 v13, 0, v13
    v_add_f32 v19, v13, v51
    v_sub_f32 v20, v20, v12
    v_cvt_pk_bf16_f32 v20, 0, v20
    v_mul_f32 v13, v20, v15
    v_fma_f32 v32, -v13, v14, v20
    v_fma_f32 v13, v32, v15, v13
    v_cvt_pk_bf16_f32 v13, 0, v13
    v_add_f32 v32, 1.0, v68
    v_cvt_pk_bf16_f32 v32, 0, v32
    v_mul_f32 v13, v13, v32
    v_cvt_pk_bf16_f32 v13, 0, v13
    v_add_f32 v20, v13, v52
    v_sub_f32 v21, v21, v12
    v_cvt_pk_bf16_f32 v21, 0, v21
    v_mul_f32 v13, v21, v15
    v_fma_f32 v32, -v13, v14, v21
    v_fma_f32 v13, v32, v15, v13
    v_cvt_pk_bf16_f32 v13, 0, v13
    v_add_f32 v32, 1.0, v69
    v_cvt_pk_bf16_f32 v32, 0, v32
    v_mul_f32 v13, v13, v32
    v_cvt_pk_bf16_f32 v13, 0, v13
    v_add_f32 v21, v13, v53
    v_sub_f32 v22, v22, v12
    v_cvt_pk_bf16_f32 v22, 0, v22
    v_mul_f32 v13, v22, v15
    v_fma_f32 v32, -v13, v14, v22
    v_fma_f32 v13, v32, v15, v13
    v_cvt_pk_bf16_f32 v13, 0, v13
    v_add_f32 v32, 1.0, v70
    v_cvt_pk_bf16_f32 v32, 0, v32
    v_mul_f32 v13, v13, v32
    v_cvt_pk_bf16_f32 v13, 0, v13
    v_add_f32 v22, v13, v54
    v_sub_f32 v23, v23, v12
    v_cvt_pk_bf16_f32 v23, 0, v23
    v_mul_f32 v13, v23, v15
    v_fma_f32 v32, -v13, v14, v23
    v_fma_f32 v13, v32, v15, v13
    v_cvt_pk_bf16_f32 v13, 0, v13
    v_add_f32 v32, 1.0, v71
    v_cvt_pk_bf16_f32 v32, 0, v32
    v_mul_f32 v13, v13, v32
    v_cvt_pk_bf16_f32 v13, 0, v13
    v_add_f32 v23, v13, v55
    v_sub_f32 v24, v24, v12
    v_cvt_pk_bf16_f32 v24, 0, v24
    v_mul_f32 v13, v24, v15
    v_fma_f32 v32, -v13, v14, v24
    v_fma_f32 v13, v32, v15, v13
    v_cvt_pk_bf16_f32 v13, 0, v13
    v_add_f32 v32, 1.0, v72
    v_cvt_pk_bf16_f32 v32, 0, v32
    v_mul_f32 v13, v13, v32
    v_cvt_pk_bf16_f32 v13, 0, v13
    v_add_f32 v24, v13, v56
    v_sub_f32 v25, v25, v12
    v_cvt_pk_bf16_f32 v25, 0, v25
    v_mul_f32 v13, v25, v15
    v_fma_f32 v32, -v13, v14, v25
    v_fma_f32 v13, v32, v15, v13
    v_cvt_pk_bf16_f32 v13, 0, v13
    v_add_f32 v32, 1.0, v73
    v_cvt_pk_bf16_f32 v32, 0, v32
    v_mul_f32 v13, v13, v32
    v_cvt_pk_bf16_f32 v13, 0, v13
    v_add_f32 v25, v13, v57
    v_sub_f32 v26, v26, v12
    v_cvt_pk_bf16_f32 v26, 0, v26
    v_mul_f32 v13, v26, v15
    v_fma_f32 v32, -v13, v14, v26
    v_fma_f32 v13, v32, v15, v13
    v_cvt_pk_bf16_f32 v13, 0, v13
    v_add_f32 v32, 1.0, v74
    v_cvt_pk_bf16_f32 v32, 0, v32
    v_mul_f32 v13, v13, v32
    v_cvt_pk_bf16_f32 v13, 0, v13
    v_add_f32 v26, v13, v58
    v_sub_f32 v27, v27, v12
    v_cvt_pk_bf16_f32 v27, 0, v27
    v_mul_f32 v13, v27, v15
    v_fma_f32 v32, -v13, v14, v27
    v_fma_f32 v13, v32, v15, v13
    v_cvt_pk_bf16_f32 v13, 0, v13
    v_add_f32 v32, 1.0, v75
    v_cvt_pk_bf16_f32 v32, 0, v32
    v_mul_f32 v13, v13, v32
    v_cvt_pk_bf16_f32 v13, 0, v13
    v_add_f32 v27, v13, v59
    v_sub_f32 v28, v28, v12
    v_cvt_pk_bf16_f32 v28, 0, v28
    v_mul_f32 v13, v28, v15
    v_fma_f32 v32, -v13, v14, v28
    v_fma_f32 v13, v32, v15, v13
    v_cvt_pk_bf16_f32 v13, 0, v13
    v_add_f32 v32, 1.0, v76
    v_cvt_pk_bf16_f32 v32, 0, v32
    v_mul_f32 v13, v13, v32
    v_cvt_pk_bf16_f32 v13, 0, v13
    v_add_f32 v28, v13, v60
    v_sub_f32 v29, v29, v12
    v_cvt_pk_bf16_f32 v29, 0, v29
    v_mul_f32 v13, v29, v15
    v_fma_f32 v32, -v13, v14, v29
    v_fma_f32 v13, v32, v15, v13
    v_cvt_pk_bf16_f32 v13, 0, v13
    v_add_f32 v32, 1.0, v77
    v_cvt_pk_bf16_f32 v32, 0, v32
    v_mul_f32 v13, v13, v32
    v_cvt_pk_bf16_f32 v13, 0, v13
    v_add_f32 v29, v13, v61
    v_sub_f32 v30, v30, v12
    v_cvt_pk_bf16_f32 v30, 0, v30
    v_mul_f32 v13, v30, v15
    v_fma_f32 v32, -v13, v14, v30
    v_fma_f32 v13, v32, v15, v13
    v_cvt_pk_bf16_f32 v13, 0, v13
    v_add_f32 v32, 1.0, v78
    v_cvt_pk_bf16_f32 v32, 0, v32
    v_mul_f32 v13, v13, v32
    v_cvt_pk_bf16_f32 v13, 0, v13
    v_add_f32 v30, v13, v62
    v_sub_f32 v31, v31, v12
    v_cvt_pk_bf16_f32 v31, 0, v31
    v_mul_f32 v13, v31, v15
    v_fma_f32 v32, -v13, v14, v31
    v_fma_f32 v13, v32, v15, v13
    v_cvt_pk_bf16_f32 v13, 0, v13
    v_add_f32 v32, 1.0, v79
    v_cvt_pk_bf16_f32 v32, 0, v32
    v_mul_f32 v13, v13, v32
    v_cvt_pk_bf16_f32 v13, 0, v13
    v_add_f32 v31, v13, v63
    v_cvt_pk_bf16_f32 v4, v16, v17
    v_cvt_pk_bf16_f32 v5, v18, v19
    v_cvt_pk_bf16_f32 v6, v20, v21
    v_cvt_pk_bf16_f32 v7, v22, v23
    v_cvt_pk_bf16_f32 v8, v24, v25
    v_cvt_pk_bf16_f32 v9, v26, v27
    v_cvt_pk_bf16_f32 v10, v28, v29
    v_cvt_pk_bf16_f32 v11, v30, v31
    buffer_store_dwordx4 v[4:7], v1, s[20:23], 0 offen
    buffer_store_dwordx4 v[8:11], v1, s[20:23], 0 offen offset:1024
L_ln1_kernel_end:
    s_endpgm
.globl attn_kernel
.p2align 8
.type attn_kernel,@function
attn_kernel:
    s_cmp_ge_u32 s2, 256
    s_cbranch_scc1 L_attn_kernel_end
    s_load_dwordx2 s[4:5], s[0:1], 104
    s_load_dwordx2 s[6:7], s[0:1], 8
    s_load_dwordx2 s[40:41], s[0:1], 16
    s_load_dwordx2 s[24:25], s[0:1], 32
    s_load_dwordx4 s[28:31], s[0:1], 48
    s_load_dwordx2 s[26:27], s[0:1], 64
    s_load_dwordx2 s[88:89], s[0:1], 24
    v_lshrrev_b32 v204, 6, v0
    v_and_b32 v0, 63, v0
    s_nop 0
    v_readfirstlane_b32 s34, v204
    s_and_b32 s3, s2, 7
    s_lshr_b32 s35, s2, 3
    s_lshr_b32 s32, s3, 1
    s_lshl_b32 s33, s3, 2
    s_and_b32 s36, s35, 3
    s_add_u32 s33, s33, s36
    s_lshr_b32 s36, s35, 2
    s_lshr_b32 s49, s34, 2
    s_waitcnt lgkmcnt(0)
    s_add_u32 s8, s4, 0x100000
    s_addc_u32 s9, s5, 0
    s_mov_b32 s10, 0x400000
    s_mov_b32 s11, 0x00020000
    s_mov_b32 s84, s88
    s_mov_b32 s85, s89
    s_mov_b32 s86, 0x800000
    s_mov_b32 s87, 0x00020000
    s_add_u32 s20, s4, 0x2000000
    s_addc_u32 s21, s5, 0
    s_mov_b32 s22, 0x1000000
    s_mov_b32 s23, 0x00020000
    s_lshr_b32 s37, s34, 1
    s_cmp_eq_u32 s37, 1
    s_cselect_b32 s24, s28, s24
    s_cselect_b32 s25, s29, s25
    s_cmp_eq_u32 s37, 2
    s_cselect_b32 s24, s30, s24
    s_cselect_b32 s25, s31, s25
    s_cmp_eq_u32 s37, 3
    s_cselect_b32 s24, s26, s24
    s_cselect_b32 s25, s27, s25
    s_cmp_eq_u32 s37, 0
    s_cselect_b32 s38, 0x800000, 0
    s_cmp_lg_u32 s37, 0
    s_cselect_b32 s18, 0x700000, s38
    s_mov_b32 s16, s24
    s_mov_b32 s17, s25
    s_mov_b32 s19, 0x00020000
    s_lshr_b32 s38, s18, 8
    s_mul_i32 s38, s38, s2
    s_and_b32 s37, s34, 1
    s_lshl_b32 s37, s37, 14
    s_add_u32 s38, s38, s37
    v_lshlrev_b32 v219, 6, v0
    v_add_u32 v219, s38, v219
    s_cmp_eq_u32 s49, 0
    s_cselect_b32 s6, s40, s6
    s_cselect_b32 s7, s41, s7
    s_lshl_b32 s37, s32, 19
    s_add_u32 s12, s6, s37
    s_addc_u32 s13, s7, 0
    s_mov_b32 s14, 0x80000
    s_mov_b32 s15, 0x00020000
    v_and_b32 v204, 31, v0
    v_lshrrev_b32 v205, 5, v0
    s_lshl_b32 s37, s36, 8
    s_lshl_b32 s38, s34, 5
    s_add_u32 s37, s37, s38
    v_add_u32 v206, s37, v204
    v_lshlrev_b32 v206, 13, v206
    s_lshl_b32 s38, s33, 8
    v_lshl_add_u32 v207, v205, 4, s38
    v_add_u32 v206, v206, v207
    v_mov_b32 v221, v206
    v_lshrrev_b32 v207, 4, v0
    v_and_b32 v208, 15, v0
    s_and_b32 s37, s34, 3
    s_lshl_b32 s37, s37, 4
    s_cmp_eq_u32 s49, 0
    s_cselect_b64 s[50:51], -1, 0
    v_add_u32 v209, s37, v207
    v_add_u32 v209, 0, v209
    v_and_b32 v210, 15, v209
    v_lshlrev_b32 v211, 2, v207
    v_cndmask_b32 v210, v210, v211, s[50:51]
    v_xor_b32 v210, v208, v210
    v_lshlrev_b32 v210, 4, v210
    v_lshl_add_u32 v196, v209, 8, v210
    v_add_u32 v209, s37, v207
    v_add_u32 v209, 4, v209
    v_and_b32 v210, 15, v209
    v_lshlrev_b32 v211, 2, v207
    v_cndmask_b32 v210, v210, v211, s[50:51]
    v_xor_b32 v210, v208, v210
    v_lshlrev_b32 v210, 4, v210
    v_lshl_add_u32 v197, v209, 8, v210
    v_add_u32 v209, s37, v207
    v_add_u32 v209, 8, v209
    v_and_b32 v210, 15, v209
    v_lshlrev_b32 v211, 2, v207
    v_cndmask_b32 v210, v210, v211, s[50:51]
    v_xor_b32 v210, v208, v210
    v_lshlrev_b32 v210, 4, v210
    v_lshl_add_u32 v198, v209, 8, v210
    v_add_u32 v209, s37, v207
    v_add_u32 v209, 12, v209
    v_and_b32 v210, 15, v209
    v_lshlrev_b32 v211, 2, v207
    v_cndmask_b32 v210, v210, v211, s[50:51]
    v_xor_b32 v210, v208, v210
    v_lshlrev_b32 v210, 4, v210
    v_lshl_add_u32 v199, v209, 8, v210
    v_and_b32 v207, 1, v204
    v_xor_b32 v207, v205, v207
    v_lshlrev_b32 v207, 4, v207
    v_lshl_add_u32 v207, v204, 8, v207
    v_bfe_u32 v208, v204, 1, 3
    v_add_u32 v207, 98304, v207
    v_xor_b32 v209, 0, v208
    v_lshl_add_u32 v180, v209, 5, v207
    v_xor_b32 v209, 1, v208
    v_lshl_add_u32 v181, v209, 5, v207
    v_xor_b32 v209, 2, v208
    v_lshl_add_u32 v182, v209, 5, v207
    v_xor_b32 v209, 3, v208
    v_lshl_add_u32 v183, v209, 5, v207
    v_xor_b32 v209, 4, v208
    v_lshl_add_u32 v184, v209, 5, v207
    v_xor_b32 v209, 5, v208
    v_lshl_add_u32 v185, v209, 5, v207
    v_xor_b32 v209, 6, v208
    v_lshl_add_u32 v186, v209, 5, v207
    v_xor_b32 v209, 7, v208
    v_lshl_add_u32 v187, v209, 5, v207
    v_and_b32 v207, 15, v0
    v_lshrrev_b32 v208, 2, v207
    v_lshl_add_u32 v209, v205, 2, v208
    v_lshlrev_b32 v209, 8, v209
    v_bfe_u32 v210, v0, 4, 1
    v_lshl_add_u32 v209, v210, 5, v209
    v_and_b32 v210, 3, v207
    v_lshl_add_u32 v209, v210, 3, v209
    v_add_u32 v209, 32768, v209
    v_xor_b32 v210, 0, v208
    v_lshl_add_u32 v188, v210, 6, v209
    v_xor_b32 v210, 1, v208
    v_lshl_add_u32 v189, v210, 6, v209
    v_xor_b32 v210, 2, v208
    v_lshl_add_u32 v190, v210, 6, v209
    v_xor_b32 v210, 3, v208
    v_lshl_add_u32 v191, v210, 6, v209
    v_mov_b32 v68, 0
    v_mov_b32 v69, 0
    v_mov_b32 v70, 0
    v_mov_b32 v71, 0
    v_mov_b32 v72, 0
    v_mov_b32 v73, 0
    v_mov_b32 v74, 0
    v_mov_b32 v75, 0
    v_mov_b32 v76, 0
    v_mov_b32 v77, 0
    v_mov_b32 v78, 0
    v_mov_b32 v79, 0
    v_mov_b32 v80, 0
    v_mov_b32 v81, 0
    v_mov_b32 v82, 0
    v_mov_b32 v83, 0
    v_mov_b32 v84, 0
    v_mov_b32 v85, 0
    v_mov_b32 v86, 0
    v_mov_b32 v87, 0
    v_mov_b32 v88, 0
    v_mov_b32 v89, 0
    v_mov_b32 v90, 0
    v_mov_b32 v91, 0
    v_mov_b32 v92, 0
    v_mov_b32 v93, 0
    v_mov_b32 v94, 0
    v_mov_b32 v95, 0
    v_mov_b32 v96, 0
    v_mov_b32 v97, 0
    v_mov_b32 v98, 0
    v_mov_b32 v99, 0
    v_mov_b32 v100, 0
    v_mov_b32 v101, 0
    v_mov_b32 v102, 0
    v_mov_b32 v103, 0
    v_mov_b32 v104, 0
    v_mov_b32 v105, 0
    v_mov_b32 v106, 0
    v_mov_b32 v107, 0
    v_mov_b32 v108, 0
    v_mov_b32 v109, 0
    v_mov_b32 v110, 0
    v_mov_b32 v111, 0
    v_mov_b32 v112, 0
    v_mov_b32 v113, 0
    v_mov_b32 v114, 0
    v_mov_b32 v115, 0
    v_mov_b32 v116, 0
    v_mov_b32 v117, 0
    v_mov_b32 v118, 0
    v_mov_b32 v119, 0
    v_mov_b32 v120, 0
    v_mov_b32 v121, 0
    v_mov_b32 v122, 0
    v_mov_b32 v123, 0
    v_mov_b32 v124, 0
    v_mov_b32 v125, 0
    v_mov_b32 v126, 0
    v_mov_b32 v127, 0
    v_mov_b32 v128, 0
    v_mov_b32 v129, 0
    v_mov_b32 v130, 0
    v_mov_b32 v131, 0
    v_mov_b32 v200, 0xff800000
    v_mov_b32 v203, 0xff800000
    v_mov_b32 v201, 0
    v_mov_b32 v216, 0x3fb8aa3b
    v_mov_b32 v217, 0x3db504f3
    v_mov_b32 v218, 0x4b800000
    s_and_b32 s46, s34, 3
    s_lshl_b32 s46, s46, 12
    s_mov_b32 s54, 98304
    s_cmp_eq_u32 s49, 0
    s_cselect_b32 s37, 32768, s54
    s_add_u32 s46, s46, s37
    s_mov_b32 s47, 0
    s_lshl_b32 s53, s49, 15
    v_mov_b32 v218, 0x41800000
    v_and_b32 v204, 31, v0
    v_lshrrev_b32 v205, 5, v0
    v_bfe_u32 v206, v204, 1, 3
    v_xor_b32 v206, v205, v206
    v_lshlrev_b32 v206, 4, v206
    v_lshl_add_u32 v206, v204, 7, v206
    s_lshl_b32 s37, s34, 12
    v_add_u32 v152, s37, v206
    v_xor_b32 v153, 32, v152
    v_xor_b32 v154, 64, v152
    v_xor_b32 v155, 96, v152
    v_and_b32 v206, 15, v0
    v_lshrrev_b32 v207, 2, v206
    v_lshl_add_u32 v208, v205, 3, v207
    v_lshlrev_b32 v208, 7, v208
    v_bfe_u32 v209, v0, 4, 1
    v_and_b32 v210, 2, v207
    v_xor_b32 v209, v209, v210
    v_lshl_add_u32 v208, v209, 5, v208
    v_and_b32 v209, 1, v206
    v_lshl_add_u32 v208, v209, 4, v208
    v_bfe_u32 v209, v206, 1, 1
    v_lshl_add_u32 v208, v209, 3, v208
    v_add_u32 v166, 32768, v208
    v_xor_b32 v167, 64, v166
    v_lshrrev_b32 v206, 3, v0
    v_and_b32 v207, 7, v0
    v_lshrrev_b32 v208, 4, v0
    s_lshl_b32 s37, s36, 8
    s_lshl_b32 s38, s34, 5
    s_add_u32 s37, s37, s38
    v_add_u32 v209, 0, v208
    v_and_b32 v209, 7, v209
    v_xor_b32 v209, v207, v209
    v_lshlrev_b32 v209, 4, v209
    v_add_u32 v210, s37, v206
    v_add_u32 v210, 0, v210
    v_lshl_add_u32 v168, v210, 11, v209
    v_add_u32 v209, 4, v208
    v_and_b32 v209, 7, v209
    v_xor_b32 v209, v207, v209
    v_lshlrev_b32 v209, 4, v209
    v_add_u32 v210, s37, v206
    v_add_u32 v210, 8, v210
    v_lshl_add_u32 v169, v210, 11, v209
    v_add_u32 v209, 0, v208
    v_and_b32 v209, 7, v209
    v_xor_b32 v209, v207, v209
    v_lshlrev_b32 v209, 4, v209
    v_add_u32 v210, s37, v206
    v_add_u32 v210, 16, v210
    v_lshl_add_u32 v170, v210, 11, v209
    v_add_u32 v209, 4, v208
    v_and_b32 v209, 7, v209
    v_xor_b32 v209, v207, v209
    v_lshlrev_b32 v209, 4, v209
    v_add_u32 v210, s37, v206
    v_add_u32 v210, 24, v210
    v_lshl_add_u32 v171, v210, 11, v209
    s_and_b32 s37, s34, 3
    s_lshl_b32 s37, s37, 4
    s_lshl_b32 s38, s33, 8
    s_lshl_b32 s39, s49, 7
    s_add_u32 s38, s38, s39
    v_and_b32 v209, 1, v208
    v_lshlrev_b32 v209, 1, v209
    v_lshrrev_b32 v210, 1, v207
    v_xor_b32 v209, v210, v209
    v_lshlrev_b32 v209, 5, v209
    v_and_b32 v210, 1, v207
    v_lshl_add_u32 v209, v210, 4, v209
    v_add_u32 v209, s38, v209
    v_add_u32 v210, s37, v206
    v_add_u32 v210, 0, v210
    v_lshl_add_u32 v172, v210, 13, v209
    v_add_u32 v210, s37, v206
    v_add_u32 v210, 8, v210
    v_lshl_add_u32 v173, v210, 13, v209
    s_lshl_b32 s90, s34, 12
    s_lshl_b32 s91, s34, 11
    s_add_u32 s91, s91, 32768
    s_cmp_eq_u32 s49, 0
    s_cbranch_scc1 L_attn_kernel_gp0
    s_xor_b32 s52, s53, 16384
    s_add_u32 s52, s52, s46
    s_add_u32 m0, s52, 0
    s_nop 0
    buffer_load_dwordx4 v196, s[12:15], s47 offen lds
    s_add_u32 m0, s52, 1024
    s_nop 0
    buffer_load_dwordx4 v197, s[12:15], s47 offen lds
    s_add_u32 m0, s52, 2048
    s_nop 0
    buffer_load_dwordx4 v198, s[12:15], s47 offen lds
    s_add_u32 m0, s52, 3072
    s_nop 0
    buffer_load_dwordx4 v199, s[12:15], s47 offen lds
    s_add_u32 s47, s47, 16384
L_attn_kernel_gp0:
    s_mov_b32 s92, 0
    s_mov_b32 s93, 0
    s_add_u32 m0, s90, 0
    s_nop 0
    buffer_load_dwordx4 v168, s[8:11], s92 offen lds
    s_add_u32 m0, s90, 1024
    s_nop 0
    buffer_load_dwordx4 v169, s[8:11], s92 offen lds
    s_add_u32 m0, s90, 2048
    s_nop 0
    buffer_load_dwordx4 v170, s[8:11], s92 offen lds
    s_add_u32 m0, s90, 3072
    s_nop 0
    buffer_load_dwordx4 v171, s[8:11], s92 offen lds
    s_add_u32 m0, s91, 0
    s_nop 0
    buffer_load_dwordx4 v172, s[84:87], s93 offen lds
    s_add_u32 m0, s91, 1024
    s_nop 0
    buffer_load_dwordx4 v173, s[84:87], s93 offen lds
    s_mov_b32 s92, 128
    s_mov_b32 s93, 524288
    s_add_u32 m0, s90, 49152
    s_nop 0
    buffer_load_dwordx4 v168, s[8:11], s92 offen lds
    s_add_u32 m0, s90, 50176
    s_nop 0
    buffer_load_dwordx4 v169, s[8:11], s92 offen lds
    s_add_u32 m0, s90, 51200
    s_nop 0
    buffer_load_dwordx4 v170, s[8:11], s92 offen lds
    s_add_u32 m0, s90, 52224
    s_nop 0
    buffer_load_dwordx4 v171, s[8:11], s92 offen lds
    s_add_u32 m0, s91, 49152
    s_nop 0
    buffer_load_dwordx4 v172, s[84:87], s93 offen lds
    s_add_u32 m0, s91, 50176
    s_nop 0
    buffer_load_dwordx4 v173, s[84:87], s93 offen lds
    s_mov_b32 s92, 256
    s_mov_b32 s93, 1048576
    s_add_u32 m0, s90, 98304
    s_nop 0
    buffer_load_dwordx4 v168, s[8:11], s92 offen lds
    s_add_u32 m0, s90, 99328
    s_nop 0
    buffer_load_dwordx4 v169, s[8:11], s92 offen lds
    s_add_u32 m0, s90, 100352
    s_nop 0
    buffer_load_dwordx4 v170, s[8:11], s92 offen lds
    s_add_u32 m0, s90, 101376
    s_nop 0
    buffer_load_dwordx4 v171, s[8:11], s92 offen lds
    s_add_u32 m0, s91, 98304
    s_nop 0
    buffer_load_dwordx4 v172, s[84:87], s93 offen lds
    s_add_u32 m0, s91, 99328
    s_nop 0
    buffer_load_dwordx4 v173, s[84:87], s93 offen lds
    s_waitcnt vmcnt(12)
    s_barrier
    v_add_u32 v148, 0, v152
    v_add_u32 v149, 0, v153
    v_add_u32 v150, 0, v154
    v_add_u32 v151, 0, v155
    v_add_u32 v164, 0, v166
    v_add_u32 v165, 0, v167
    ds_read_b128 v[132:135], v148
    ds_read_b64_tr_b16 v[36:37], v164 offset:0
    ds_read_b64_tr_b16 v[38:39], v164 offset:512
    ds_read_b64_tr_b16 v[40:41], v165 offset:0
    ds_read_b64_tr_b16 v[42:43], v165 offset:512
    ds_read_b64_tr_b16 v[44:45], v164 offset:8192
    ds_read_b64_tr_b16 v[46:47], v164 offset:8704
    ds_read_b64_tr_b16 v[48:49], v165 offset:8192
    ds_read_b64_tr_b16 v[50:51], v165 offset:8704
    s_waitcnt lgkmcnt(0)
    v_mfma_f32_32x32x16_bf16 v[68:83], v[36:39], v[132:135], 0
    ds_read_b128 v[136:139], v149
    ds_read_b64_tr_b16 v[52:53], v164 offset:2048
    ds_read_b64_tr_b16 v[54:55], v164 offset:2560
    v_mfma_f32_32x32x16_bf16 v[84:99], v[40:43], v[132:135], 0
    ds_read_b64_tr_b16 v[56:57], v165 offset:2048
    ds_read_b64_tr_b16 v[58:59], v165 offset:2560
    ds_read_b64_tr_b16 v[60:61], v164 offset:10240
    v_mfma_f32_32x32x16_bf16 v[100:115], v[44:47], v[132:135], 0
    ds_read_b64_tr_b16 v[62:63], v164 offset:10752
    ds_read_b64_tr_b16 v[64:65], v165 offset:10240
    ds_read_b64_tr_b16 v[66:67], v165 offset:10752
    v_mfma_f32_32x32x16_bf16 v[116:131], v[48:51], v[132:135], 0
    s_waitcnt lgkmcnt(0)
    v_mfma_f32_32x32x16_bf16 v[68:83], v[52:55], v[136:139], v[68:83]
    ds_read_b128 v[132:135], v150
    ds_read_b64_tr_b16 v[36:37], v164 offset:4096
    ds_read_b64_tr_b16 v[38:39], v164 offset:4608
    v_mfma_f32_32x32x16_bf16 v[84:99], v[56:59], v[136:139], v[84:99]
    ds_read_b64_tr_b16 v[40:41], v165 offset:4096
    ds_read_b64_tr_b16 v[42:43], v165 offset:4608
    ds_read_b64_tr_b16 v[44:45], v164 offset:12288
    v_mfma_f32_32x32x16_bf16 v[100:115], v[60:63], v[136:139], v[100:115]
    ds_read_b64_tr_b16 v[46:47], v164 offset:12800
    ds_read_b64_tr_b16 v[48:49], v165 offset:12288
    ds_read_b64_tr_b16 v[50:51], v165 offset:12800
    v_mfma_f32_32x32x16_bf16 v[116:131], v[64:67], v[136:139], v[116:131]
    s_waitcnt lgkmcnt(0)
    v_mfma_f32_32x32x16_bf16 v[68:83], v[36:39], v[132:135], v[68:83]
    ds_read_b128 v[136:139], v151
    ds_read_b64_tr_b16 v[52:53], v164 offset:6144
    ds_read_b64_tr_b16 v[54:55], v164 offset:6656
    v_mfma_f32_32x32x16_bf16 v[84:99], v[40:43], v[132:135], v[84:99]
    ds_read_b64_tr_b16 v[56:57], v165 offset:6144
    ds_read_b64_tr_b16 v[58:59], v165 offset:6656
    ds_read_b64_tr_b16 v[60:61], v164 offset:14336
    v_mfma_f32_32x32x16_bf16 v[100:115], v[44:47], v[132:135], v[100:115]
    ds_read_b64_tr_b16 v[62:63], v164 offset:14848
    ds_read_b64_tr_b16 v[64:65], v165 offset:14336
    ds_read_b64_tr_b16 v[66:67], v165 offset:14848
    v_mfma_f32_32x32x16_bf16 v[116:131], v[48:51], v[132:135], v[116:131]
    s_waitcnt lgkmcnt(0)
    s_waitcnt vmcnt(6)
    s_barrier
    v_add_u32 v148, 49152, v152
    v_add_u32 v149, 49152, v153
    v_add_u32 v150, 49152, v154
    v_add_u32 v151, 49152, v155
    v_add_u32 v164, 49152, v166
    v_add_u32 v165, 49152, v167
    v_mfma_f32_32x32x16_bf16 v[68:83], v[52:55], v[136:139], v[68:83]
    ds_read_b128 v[132:135], v148
    ds_read_b64_tr_b16 v[36:37], v164 offset:0
    ds_read_b64_tr_b16 v[38:39], v164 offset:512
    v_mfma_f32_32x32x16_bf16 v[84:99], v[56:59], v[136:139], v[84:99]
    ds_read_b64_tr_b16 v[40:41], v165 offset:0
    ds_read_b64_tr_b16 v[42:43], v165 offset:512
    ds_read_b64_tr_b16 v[44:45], v164 offset:8192
    v_mfma_f32_32x32x16_bf16 v[100:115], v[60:63], v[136:139], v[100:115]
    ds_read_b64_tr_b16 v[46:47], v164 offset:8704
    ds_read_b64_tr_b16 v[48:49], v165 offset:8192
    ds_read_b64_tr_b16 v[50:51], v165 offset:8704
    v_mfma_f32_32x32x16_bf16 v[116:131], v[64:67], v[136:139], v[116:131]
    s_mov_b32 s92, 384
    s_mov_b32 s93, 1572864
    s_add_u32 m0, s90, 0
    s_nop 0
    buffer_load_dwordx4 v168, s[8:11], s92 offen lds
    s_add_u32 m0, s90, 1024
    s_nop 0
    buffer_load_dwordx4 v169, s[8:11], s92 offen lds
    s_add_u32 m0, s90, 2048
    s_nop 0
    buffer_load_dwordx4 v170, s[8:11], s92 offen lds
    s_add_u32 m0, s90, 3072
    s_nop 0
    buffer_load_dwordx4 v171, s[8:11], s92 offen lds
    s_add_u32 m0, s91, 0
    s_nop 0
    buffer_load_dwordx4 v172, s[84:87], s93 offen lds
    s_add_u32 m0, s91, 1024
    s_nop 0
    buffer_load_dwordx4 v173, s[84:87], s93 offen lds
    s_waitcnt lgkmcnt(0)
    v_mfma_f32_32x32x16_bf16 v[68:83], v[36:39], v[132:135], v[68:83]
    ds_read_b128 v[136:139], v149
    ds_read_b64_tr_b16 v[52:53], v164 offset:2048
    ds_read_b64_tr_b16 v[54:55], v164 offset:2560
    v_mfma_f32_32x32x16_bf16 v[84:99], v[40:43], v[132:135], v[84:99]
    ds_read_b64_tr_b16 v[56:57], v165 offset:2048
    ds_read_b64_tr_b16 v[58:59], v165 offset:2560
    ds_read_b64_tr_b16 v[60:61], v164 offset:10240
    v_mfma_f32_32x32x16_bf16 v[100:115], v[44:47], v[132:135], v[100:115]
    ds_read_b64_tr_b16 v[62:63], v164 offset:10752
    ds_read_b64_tr_b16 v[64:65], v165 offset:10240
    ds_read_b64_tr_b16 v[66:67], v165 offset:10752
    v_mfma_f32_32x32x16_bf16 v[116:131], v[48:51], v[132:135], v[116:131]
    s_waitcnt lgkmcnt(0)
    v_mfma_f32_32x32x16_bf16 v[68:83], v[52:55], v[136:139], v[68:83]
    ds_read_b128 v[132:135], v150
    ds_read_b64_tr_b16 v[36:37], v164 offset:4096
    ds_read_b64_tr_b16 v[38:39], v164 offset:4608
    v_mfma_f32_32x32x16_bf16 v[84:99], v[56:59], v[136:139], v[84:99]
    ds_read_b64_tr_b16 v[40:41], v165 offset:4096
    ds_read_b64_tr_b16 v[42:43], v165 offset:4608
    ds_read_b64_tr_b16 v[44:45], v164 offset:12288
    v_mfma_f32_32x32x16_bf16 v[100:115], v[60:63], v[136:139], v[100:115]
    ds_read_b64_tr_b16 v[46:47], v164 offset:12800
    ds_read_b64_tr_b16 v[48:49], v165 offset:12288
    ds_read_b64_tr_b16 v[50:51], v165 offset:12800
    v_mfma_f32_32x32x16_bf16 v[116:131], v[64:67], v[136:139], v[116:131]
    s_waitcnt lgkmcnt(0)
    v_mfma_f32_32x32x16_bf16 v[68:83], v[36:39], v[132:135], v[68:83]
    ds_read_b128 v[136:139], v151
    ds_read_b64_tr_b16 v[52:53], v164 offset:6144
    ds_read_b64_tr_b16 v[54:55], v164 offset:6656
    v_mfma_f32_32x32x16_bf16 v[84:99], v[40:43], v[132:135], v[84:99]
    ds_read_b64_tr_b16 v[56:57], v165 offset:6144
    ds_read_b64_tr_b16 v[58:59], v165 offset:6656
    ds_read_b64_tr_b16 v[60:61], v164 offset:14336
    v_mfma_f32_32x32x16_bf16 v[100:115], v[44:47], v[132:135], v[100:115]
    ds_read_b64_tr_b16 v[62:63], v164 offset:14848
    ds_read_b64_tr_b16 v[64:65], v165 offset:14336
    ds_read_b64_tr_b16 v[66:67], v165 offset:14848
    v_mfma_f32_32x32x16_bf16 v[116:131], v[48:51], v[132:135], v[116:131]
    s_waitcnt lgkmcnt(0)
    s_waitcnt vmcnt(6)
    s_barrier
    v_add_u32 v148, 98304, v152
    v_add_u32 v149, 98304, v153
    v_add_u32 v150, 98304, v154
    v_add_u32 v151, 98304, v155
    v_add_u32 v164, 98304, v166
    v_add_u32 v165, 98304, v167
    v_mfma_f32_32x32x16_bf16 v[68:83], v[52:55], v[136:139], v[68:83]
    ds_read_b128 v[132:135], v148
    ds_read_b64_tr_b16 v[36:37], v164 offset:0
    ds_read_b64_tr_b16 v[38:39], v164 offset:512
    v_mfma_f32_32x32x16_bf16 v[84:99], v[56:59], v[136:139], v[84:99]
    ds_read_b64_tr_b16 v[40:41], v165 offset:0
    ds_read_b64_tr_b16 v[42:43], v165 offset:512
    ds_read_b64_tr_b16 v[44:45], v164 offset:8192
    v_mfma_f32_32x32x16_bf16 v[100:115], v[60:63], v[136:139], v[100:115]
    ds_read_b64_tr_b16 v[46:47], v164 offset:8704
    ds_read_b64_tr_b16 v[48:49], v165 offset:8192
    ds_read_b64_tr_b16 v[50:51], v165 offset:8704
    v_mfma_f32_32x32x16_bf16 v[116:131], v[64:67], v[136:139], v[116:131]
    s_mov_b32 s92, 512
    s_mov_b32 s93, 2097152
    s_add_u32 m0, s90, 49152
    s_nop 0
    buffer_load_dwordx4 v168, s[8:11], s92 offen lds
    s_add_u32 m0, s90, 50176
    s_nop 0
    buffer_load_dwordx4 v169, s[8:11], s92 offen lds
    s_add_u32 m0, s90, 51200
    s_nop 0
    buffer_load_dwordx4 v170, s[8:11], s92 offen lds
    s_add_u32 m0, s90, 52224
    s_nop 0
    buffer_load_dwordx4 v171, s[8:11], s92 offen lds
    s_add_u32 m0, s91, 49152
    s_nop 0
    buffer_load_dwordx4 v172, s[84:87], s93 offen lds
    s_add_u32 m0, s91, 50176
    s_nop 0
    buffer_load_dwordx4 v173, s[84:87], s93 offen lds
    s_waitcnt lgkmcnt(0)
    v_mfma_f32_32x32x16_bf16 v[68:83], v[36:39], v[132:135], v[68:83]
    ds_read_b128 v[136:139], v149
    ds_read_b64_tr_b16 v[52:53], v164 offset:2048
    ds_read_b64_tr_b16 v[54:55], v164 offset:2560
    v_mfma_f32_32x32x16_bf16 v[84:99], v[40:43], v[132:135], v[84:99]
    ds_read_b64_tr_b16 v[56:57], v165 offset:2048
    ds_read_b64_tr_b16 v[58:59], v165 offset:2560
    ds_read_b64_tr_b16 v[60:61], v164 offset:10240
    v_mfma_f32_32x32x16_bf16 v[100:115], v[44:47], v[132:135], v[100:115]
    ds_read_b64_tr_b16 v[62:63], v164 offset:10752
    ds_read_b64_tr_b16 v[64:65], v165 offset:10240
    ds_read_b64_tr_b16 v[66:67], v165 offset:10752
    v_mfma_f32_32x32x16_bf16 v[116:131], v[48:51], v[132:135], v[116:131]
    s_waitcnt lgkmcnt(0)
    v_mfma_f32_32x32x16_bf16 v[68:83], v[52:55], v[136:139], v[68:83]
    ds_read_b128 v[132:135], v150
    ds_read_b64_tr_b16 v[36:37], v164 offset:4096
    ds_read_b64_tr_b16 v[38:39], v164 offset:4608
    v_mfma_f32_32x32x16_bf16 v[84:99], v[56:59], v[136:139], v[84:99]
    ds_read_b64_tr_b16 v[40:41], v165 offset:4096
    ds_read_b64_tr_b16 v[42:43], v165 offset:4608
    ds_read_b64_tr_b16 v[44:45], v164 offset:12288
    v_mfma_f32_32x32x16_bf16 v[100:115], v[60:63], v[136:139], v[100:115]
    ds_read_b64_tr_b16 v[46:47], v164 offset:12800
    ds_read_b64_tr_b16 v[48:49], v165 offset:12288
    ds_read_b64_tr_b16 v[50:51], v165 offset:12800
    v_mfma_f32_32x32x16_bf16 v[116:131], v[64:67], v[136:139], v[116:131]
    s_waitcnt lgkmcnt(0)
    v_mfma_f32_32x32x16_bf16 v[68:83], v[36:39], v[132:135], v[68:83]
    ds_read_b128 v[136:139], v151
    ds_read_b64_tr_b16 v[52:53], v164 offset:6144
    ds_read_b64_tr_b16 v[54:55], v164 offset:6656
    v_mfma_f32_32x32x16_bf16 v[84:99], v[40:43], v[132:135], v[84:99]
    ds_read_b64_tr_b16 v[56:57], v165 offset:6144
    ds_read_b64_tr_b16 v[58:59], v165 offset:6656
    ds_read_b64_tr_b16 v[60:61], v164 offset:14336
    v_mfma_f32_32x32x16_bf16 v[100:115], v[44:47], v[132:135], v[100:115]
    ds_read_b64_tr_b16 v[62:63], v164 offset:14848
    ds_read_b64_tr_b16 v[64:65], v165 offset:14336
    ds_read_b64_tr_b16 v[66:67], v165 offset:14848
    v_mfma_f32_32x32x16_bf16 v[116:131], v[48:51], v[132:135], v[116:131]
    s_waitcnt lgkmcnt(0)
    s_waitcnt vmcnt(6)
    s_barrier
    v_add_u32 v148, 0, v152
    v_add_u32 v149, 0, v153
    v_add_u32 v150, 0, v154
    v_add_u32 v151, 0, v155
    v_add_u32 v164, 0, v166
    v_add_u32 v165, 0, v167
    v_mfma_f32_32x32x16_bf16 v[68:83], v[52:55], v[136:139], v[68:83]
    ds_read_b128 v[132:135], v148
    ds_read_b64_tr_b16 v[36:37], v164 offset:0
    ds_read_b64_tr_b16 v[38:39], v164 offset:512
    v_mfma_f32_32x32x16_bf16 v[84:99], v[56:59], v[136:139], v[84:99]
    ds_read_b64_tr_b16 v[40:41], v165 offset:0
    ds_read_b64_tr_b16 v[42:43], v165 offset:512
    ds_read_b64_tr_b16 v[44:45], v164 offset:8192
    v_mfma_f32_32x32x16_bf16 v[100:115], v[60:63], v[136:139], v[100:115]
    ds_read_b64_tr_b16 v[46:47], v164 offset:8704
    ds_read_b64_tr_b16 v[48:49], v165 offset:8192
    ds_read_b64_tr_b16 v[50:51], v165 offset:8704
    v_mfma_f32_32x32x16_bf16 v[116:131], v[64:67], v[136:139], v[116:131]
    s_mov_b32 s92, 640
    s_mov_b32 s93, 2621440
    s_add_u32 m0, s90, 98304
    s_nop 0
    buffer_load_dwordx4 v168, s[8:11], s92 offen lds
    s_add_u32 m0, s90, 99328
    s_nop 0
    buffer_load_dwordx4 v169, s[8:11], s92 offen lds
    s_add_u32 m0, s90, 100352
    s_nop 0
    buffer_load_dwordx4 v170, s[8:11], s92 offen lds
    s_add_u32 m0, s90, 101376
    s_nop 0
    buffer_load_dwordx4 v171, s[8:11], s92 offen lds
    s_add_u32 m0, s91, 98304
    s_nop 0
    buffer_load_dwordx4 v172, s[84:87], s93 offen lds
    s_add_u32 m0, s91, 99328
    s_nop 0
    buffer_load_dwordx4 v173, s[84:87], s93 offen lds
    s_waitcnt lgkmcnt(0)
    v_mfma_f32_32x32x16_bf16 v[68:83], v[36:39], v[132:135], v[68:83]
    ds_read_b128 v[136:139], v149
    ds_read_b64_tr_b16 v[52:53], v164 offset:2048
    ds_read_b64_tr_b16 v[54:55], v164 offset:2560
    v_mfma_f32_32x32x16_bf16 v[84:99], v[40:43], v[132:135], v[84:99]
    ds_read_b64_tr_b16 v[56:57], v165 offset:2048
    ds_read_b64_tr_b16 v[58:59], v165 offset:2560
    ds_read_b64_tr_b16 v[60:61], v164 offset:10240
    v_mfma_f32_32x32x16_bf16 v[100:115], v[44:47], v[132:135], v[100:115]
    ds_read_b64_tr_b16 v[62:63], v164 offset:10752
    ds_read_b64_tr_b16 v[64:65], v165 offset:10240
    ds_read_b64_tr_b16 v[66:67], v165 offset:10752
    v_mfma_f32_32x32x16_bf16 v[116:131], v[48:51], v[132:135], v[116:131]
    s_waitcnt lgkmcnt(0)
    v_mfma_f32_32x32x16_bf16 v[68:83], v[52:55], v[136:139], v[68:83]
    ds_read_b128 v[132:135], v150
    ds_read_b64_tr_b16 v[36:37], v164 offset:4096
    ds_read_b64_tr_b16 v[38:39], v164 offset:4608
    v_mfma_f32_32x32x16_bf16 v[84:99], v[56:59], v[136:139], v[84:99]
    ds_read_b64_tr_b16 v[40:41], v165 offset:4096
    ds_read_b64_tr_b16 v[42:43], v165 offset:4608
    ds_read_b64_tr_b16 v[44:45], v164 offset:12288
    v_mfma_f32_32x32x16_bf16 v[100:115], v[60:63], v[136:139], v[100:115]
    ds_read_b64_tr_b16 v[46:47], v164 offset:12800
    ds_read_b64_tr_b16 v[48:49], v165 offset:12288
    ds_read_b64_tr_b16 v[50:51], v165 offset:12800
    v_mfma_f32_32x32x16_bf16 v[116:131], v[64:67], v[136:139], v[116:131]
    s_waitcnt lgkmcnt(0)
    v_mfma_f32_32x32x16_bf16 v[68:83], v[36:39], v[132:135], v[68:83]
    ds_read_b128 v[136:139], v151
    ds_read_b64_tr_b16 v[52:53], v164 offset:6144
    ds_read_b64_tr_b16 v[54:55], v164 offset:6656
    v_mfma_f32_32x32x16_bf16 v[84:99], v[40:43], v[132:135], v[84:99]
    ds_read_b64_tr_b16 v[56:57], v165 offset:6144
    ds_read_b64_tr_b16 v[58:59], v165 offset:6656
    ds_read_b64_tr_b16 v[60:61], v164 offset:14336
    v_mfma_f32_32x32x16_bf16 v[100:115], v[44:47], v[132:135], v[100:115]
    ds_read_b64_tr_b16 v[62:63], v164 offset:14848
    ds_read_b64_tr_b16 v[64:65], v165 offset:14336
    ds_read_b64_tr_b16 v[66:67], v165 offset:14848
    v_mfma_f32_32x32x16_bf16 v[116:131], v[48:51], v[132:135], v[116:131]
    s_waitcnt lgkmcnt(0)
    s_waitcnt vmcnt(6)
    s_barrier
    v_add_u32 v148, 49152, v152
    v_add_u32 v149, 49152, v153
    v_add_u32 v150, 49152, v154
    v_add_u32 v151, 49152, v155
    v_add_u32 v164, 49152, v166
    v_add_u32 v165, 49152, v167
    v_mfma_f32_32x32x16_bf16 v[68:83], v[52:55], v[136:139], v[68:83]
    ds_read_b128 v[132:135], v148
    ds_read_b64_tr_b16 v[36:37], v164 offset:0
    ds_read_b64_tr_b16 v[38:39], v164 offset:512
    v_mfma_f32_32x32x16_bf16 v[84:99], v[56:59], v[136:139], v[84:99]
    ds_read_b64_tr_b16 v[40:41], v165 offset:0
    ds_read_b64_tr_b16 v[42:43], v165 offset:512
    ds_read_b64_tr_b16 v[44:45], v164 offset:8192
    v_mfma_f32_32x32x16_bf16 v[100:115], v[60:63], v[136:139], v[100:115]
    ds_read_b64_tr_b16 v[46:47], v164 offset:8704
    ds_read_b64_tr_b16 v[48:49], v165 offset:8192
    ds_read_b64_tr_b16 v[50:51], v165 offset:8704
    v_mfma_f32_32x32x16_bf16 v[116:131], v[64:67], v[136:139], v[116:131]
    s_mov_b32 s92, 768
    s_mov_b32 s93, 3145728
    s_add_u32 m0, s90, 0
    s_nop 0
    buffer_load_dwordx4 v168, s[8:11], s92 offen lds
    s_add_u32 m0, s90, 1024
    s_nop 0
    buffer_load_dwordx4 v169, s[8:11], s92 offen lds
    s_add_u32 m0, s90, 2048
    s_nop 0
    buffer_load_dwordx4 v170, s[8:11], s92 offen lds
    s_add_u32 m0, s90, 3072
    s_nop 0
    buffer_load_dwordx4 v171, s[8:11], s92 offen lds
    s_add_u32 m0, s91, 0
    s_nop 0
    buffer_load_dwordx4 v172, s[84:87], s93 offen lds
    s_add_u32 m0, s91, 1024
    s_nop 0
    buffer_load_dwordx4 v173, s[84:87], s93 offen lds
    s_waitcnt lgkmcnt(0)
    v_mfma_f32_32x32x16_bf16 v[68:83], v[36:39], v[132:135], v[68:83]
    ds_read_b128 v[136:139], v149
    ds_read_b64_tr_b16 v[52:53], v164 offset:2048
    ds_read_b64_tr_b16 v[54:55], v164 offset:2560
    v_mfma_f32_32x32x16_bf16 v[84:99], v[40:43], v[132:135], v[84:99]
    ds_read_b64_tr_b16 v[56:57], v165 offset:2048
    ds_read_b64_tr_b16 v[58:59], v165 offset:2560
    ds_read_b64_tr_b16 v[60:61], v164 offset:10240
    v_mfma_f32_32x32x16_bf16 v[100:115], v[44:47], v[132:135], v[100:115]
    ds_read_b64_tr_b16 v[62:63], v164 offset:10752
    ds_read_b64_tr_b16 v[64:65], v165 offset:10240
    ds_read_b64_tr_b16 v[66:67], v165 offset:10752
    v_mfma_f32_32x32x16_bf16 v[116:131], v[48:51], v[132:135], v[116:131]
    s_waitcnt lgkmcnt(0)
    v_mfma_f32_32x32x16_bf16 v[68:83], v[52:55], v[136:139], v[68:83]
    ds_read_b128 v[132:135], v150
    ds_read_b64_tr_b16 v[36:37], v164 offset:4096
    ds_read_b64_tr_b16 v[38:39], v164 offset:4608
    v_mfma_f32_32x32x16_bf16 v[84:99], v[56:59], v[136:139], v[84:99]
    ds_read_b64_tr_b16 v[40:41], v165 offset:4096
    ds_read_b64_tr_b16 v[42:43], v165 offset:4608
    ds_read_b64_tr_b16 v[44:45], v164 offset:12288
    v_mfma_f32_32x32x16_bf16 v[100:115], v[60:63], v[136:139], v[100:115]
    ds_read_b64_tr_b16 v[46:47], v164 offset:12800
    ds_read_b64_tr_b16 v[48:49], v165 offset:12288
    ds_read_b64_tr_b16 v[50:51], v165 offset:12800
    v_mfma_f32_32x32x16_bf16 v[116:131], v[64:67], v[136:139], v[116:131]
    s_waitcnt lgkmcnt(0)
    v_mfma_f32_32x32x16_bf16 v[68:83], v[36:39], v[132:135], v[68:83]
    ds_read_b128 v[136:139], v151
    ds_read_b64_tr_b16 v[52:53], v164 offset:6144
    ds_read_b64_tr_b16 v[54:55], v164 offset:6656
    v_mfma_f32_32x32x16_bf16 v[84:99], v[40:43], v[132:135], v[84:99]
    ds_read_b64_tr_b16 v[56:57], v165 offset:6144
    ds_read_b64_tr_b16 v[58:59], v165 offset:6656
    ds_read_b64_tr_b16 v[60:61], v164 offset:14336
    v_mfma_f32_32x32x16_bf16 v[100:115], v[44:47], v[132:135], v[100:115]
    ds_read_b64_tr_b16 v[62:63], v164 offset:14848
    ds_read_b64_tr_b16 v[64:65], v165 offset:14336
    ds_read_b64_tr_b16 v[66:67], v165 offset:14848
    v_mfma_f32_32x32x16_bf16 v[116:131], v[48:51], v[132:135], v[116:131]
    s_waitcnt lgkmcnt(0)
    s_waitcnt vmcnt(6)
    s_barrier
    v_add_u32 v148, 98304, v152
    v_add_u32 v149, 98304, v153
    v_add_u32 v150, 98304, v154
    v_add_u32 v151, 98304, v155
    v_add_u32 v164, 98304, v166
    v_add_u32 v165, 98304, v167
    v_mfma_f32_32x32x16_bf16 v[68:83], v[52:55], v[136:139], v[68:83]
    ds_read_b128 v[132:135], v148
    ds_read_b64_tr_b16 v[36:37], v164 offset:0
    ds_read_b64_tr_b16 v[38:39], v164 offset:512
    v_mfma_f32_32x32x16_bf16 v[84:99], v[56:59], v[136:139], v[84:99]
    ds_read_b64_tr_b16 v[40:41], v165 offset:0
    ds_read_b64_tr_b16 v[42:43], v165 offset:512
    ds_read_b64_tr_b16 v[44:45], v164 offset:8192
    v_mfma_f32_32x32x16_bf16 v[100:115], v[60:63], v[136:139], v[100:115]
    ds_read_b64_tr_b16 v[46:47], v164 offset:8704
    ds_read_b64_tr_b16 v[48:49], v165 offset:8192
    ds_read_b64_tr_b16 v[50:51], v165 offset:8704
    v_mfma_f32_32x32x16_bf16 v[116:131], v[64:67], v[136:139], v[116:131]
    s_mov_b32 s92, 896
    s_mov_b32 s93, 3670016
    s_add_u32 m0, s90, 49152
    s_nop 0
    buffer_load_dwordx4 v168, s[8:11], s92 offen lds
    s_add_u32 m0, s90, 50176
    s_nop 0
    buffer_load_dwordx4 v169, s[8:11], s92 offen lds
    s_add_u32 m0, s90, 51200
    s_nop 0
    buffer_load_dwordx4 v170, s[8:11], s92 offen lds
    s_add_u32 m0, s90, 52224
    s_nop 0
    buffer_load_dwordx4 v171, s[8:11], s92 offen lds
    s_add_u32 m0, s91, 49152
    s_nop 0
    buffer_load_dwordx4 v172, s[84:87], s93 offen lds
    s_add_u32 m0, s91, 50176
    s_nop 0
    buffer_load_dwordx4 v173, s[84:87], s93 offen lds
    s_waitcnt lgkmcnt(0)
    v_mfma_f32_32x32x16_bf16 v[68:83], v[36:39], v[132:135], v[68:83]
    ds_read_b128 v[136:139], v149
    ds_read_b64_tr_b16 v[52:53], v164 offset:2048
    ds_read_b64_tr_b16 v[54:55], v164 offset:2560
    v_mfma_f32_32x32x16_bf16 v[84:99], v[40:43], v[132:135], v[84:99]
    ds_read_b64_tr_b16 v[56:57], v165 offset:2048
    ds_read_b64_tr_b16 v[58:59], v165 offset:2560
    ds_read_b64_tr_b16 v[60:61], v164 offset:10240
    v_mfma_f32_32x32x16_bf16 v[100:115], v[44:47], v[132:135], v[100:115]
    ds_read_b64_tr_b16 v[62:63], v164 offset:10752
    ds_read_b64_tr_b16 v[64:65], v165 offset:10240
    ds_read_b64_tr_b16 v[66:67], v165 offset:10752
    v_mfma_f32_32x32x16_bf16 v[116:131], v[48:51], v[132:135], v[116:131]
    s_waitcnt lgkmcnt(0)
    v_mfma_f32_32x32x16_bf16 v[68:83], v[52:55], v[136:139], v[68:83]
    ds_read_b128 v[132:135], v150
    ds_read_b64_tr_b16 v[36:37], v164 offset:4096
    ds_read_b64_tr_b16 v[38:39], v164 offset:4608
    v_mfma_f32_32x32x16_bf16 v[84:99], v[56:59], v[136:139], v[84:99]
    ds_read_b64_tr_b16 v[40:41], v165 offset:4096
    ds_read_b64_tr_b16 v[42:43], v165 offset:4608
    ds_read_b64_tr_b16 v[44:45], v164 offset:12288
    v_mfma_f32_32x32x16_bf16 v[100:115], v[60:63], v[136:139], v[100:115]
    ds_read_b64_tr_b16 v[46:47], v164 offset:12800
    ds_read_b64_tr_b16 v[48:49], v165 offset:12288
    ds_read_b64_tr_b16 v[50:51], v165 offset:12800
    v_mfma_f32_32x32x16_bf16 v[116:131], v[64:67], v[136:139], v[116:131]
    s_waitcnt lgkmcnt(0)
    v_mfma_f32_32x32x16_bf16 v[68:83], v[36:39], v[132:135], v[68:83]
    ds_read_b128 v[136:139], v151
    ds_read_b64_tr_b16 v[52:53], v164 offset:6144
    ds_read_b64_tr_b16 v[54:55], v164 offset:6656
    v_mfma_f32_32x32x16_bf16 v[84:99], v[40:43], v[132:135], v[84:99]
    ds_read_b64_tr_b16 v[56:57], v165 offset:6144
    ds_read_b64_tr_b16 v[58:59], v165 offset:6656
    ds_read_b64_tr_b16 v[60:61], v164 offset:14336
    v_mfma_f32_32x32x16_bf16 v[100:115], v[44:47], v[132:135], v[100:115]
    ds_read_b64_tr_b16 v[62:63], v164 offset:14848
    ds_read_b64_tr_b16 v[64:65], v165 offset:14336
    ds_read_b64_tr_b16 v[66:67], v165 offset:14848
    v_mfma_f32_32x32x16_bf16 v[116:131], v[48:51], v[132:135], v[116:131]
    s_waitcnt lgkmcnt(0)
    s_waitcnt vmcnt(6)
    s_barrier
    v_add_u32 v148, 0, v152
    v_add_u32 v149, 0, v153
    v_add_u32 v150, 0, v154
    v_add_u32 v151, 0, v155
    v_add_u32 v164, 0, v166
    v_add_u32 v165, 0, v167
    v_mfma_f32_32x32x16_bf16 v[68:83], v[52:55], v[136:139], v[68:83]
    ds_read_b128 v[132:135], v148
    ds_read_b64_tr_b16 v[36:37], v164 offset:0
    ds_read_b64_tr_b16 v[38:39], v164 offset:512
    v_mfma_f32_32x32x16_bf16 v[84:99], v[56:59], v[136:139], v[84:99]
    ds_read_b64_tr_b16 v[40:41], v165 offset:0
    ds_read_b64_tr_b16 v[42:43], v165 offset:512
    ds_read_b64_tr_b16 v[44:45], v164 offset:8192
    v_mfma_f32_32x32x16_bf16 v[100:115], v[60:63], v[136:139], v[100:115]
    ds_read_b64_tr_b16 v[46:47], v164 offset:8704
    ds_read_b64_tr_b16 v[48:49], v165 offset:8192
    ds_read_b64_tr_b16 v[50:51], v165 offset:8704
    v_mfma_f32_32x32x16_bf16 v[116:131], v[64:67], v[136:139], v[116:131]
    s_mov_b32 s92, 1024
    s_mov_b32 s93, 4194304
    s_add_u32 m0, s90, 98304
    s_nop 0
    buffer_load_dwordx4 v168, s[8:11], s92 offen lds
    s_add_u32 m0, s90, 99328
    s_nop 0
    buffer_load_dwordx4 v169, s[8:11], s92 offen lds
    s_add_u32 m0, s90, 100352
    s_nop 0
    buffer_load_dwordx4 v170, s[8:11], s92 offen lds
    s_add_u32 m0, s90, 101376
    s_nop 0
    buffer_load_dwordx4 v171, s[8:11], s92 offen lds
    s_add_u32 m0, s91, 98304
    s_nop 0
    buffer_load_dwordx4 v172, s[84:87], s93 offen lds
    s_add_u32 m0, s91, 99328
    s_nop 0
    buffer_load_dwordx4 v173, s[84:87], s93 offen lds
    s_waitcnt lgkmcnt(0)
    v_mfma_f32_32x32x16_bf16 v[68:83], v[36:39], v[132:135], v[68:83]
    ds_read_b128 v[136:139], v149
    ds_read_b64_tr_b16 v[52:53], v164 offset:2048
    ds_read_b64_tr_b16 v[54:55], v164 offset:2560
    v_mfma_f32_32x32x16_bf16 v[84:99], v[40:43], v[132:135], v[84:99]
    ds_read_b64_tr_b16 v[56:57], v165 offset:2048
    ds_read_b64_tr_b16 v[58:59], v165 offset:2560
    ds_read_b64_tr_b16 v[60:61], v164 offset:10240
    v_mfma_f32_32x32x16_bf16 v[100:115], v[44:47], v[132:135], v[100:115]
    ds_read_b64_tr_b16 v[62:63], v164 offset:10752
    ds_read_b64_tr_b16 v[64:65], v165 offset:10240
    ds_read_b64_tr_b16 v[66:67], v165 offset:10752
    v_mfma_f32_32x32x16_bf16 v[116:131], v[48:51], v[132:135], v[116:131]
    s_waitcnt lgkmcnt(0)
    v_mfma_f32_32x32x16_bf16 v[68:83], v[52:55], v[136:139], v[68:83]
    ds_read_b128 v[132:135], v150
    ds_read_b64_tr_b16 v[36:37], v164 offset:4096
    ds_read_b64_tr_b16 v[38:39], v164 offset:4608
    v_mfma_f32_32x32x16_bf16 v[84:99], v[56:59], v[136:139], v[84:99]
    ds_read_b64_tr_b16 v[40:41], v165 offset:4096
    ds_read_b64_tr_b16 v[42:43], v165 offset:4608
    ds_read_b64_tr_b16 v[44:45], v164 offset:12288
    v_mfma_f32_32x32x16_bf16 v[100:115], v[60:63], v[136:139], v[100:115]
    ds_read_b64_tr_b16 v[46:47], v164 offset:12800
    ds_read_b64_tr_b16 v[48:49], v165 offset:12288
    ds_read_b64_tr_b16 v[50:51], v165 offset:12800
    v_mfma_f32_32x32x16_bf16 v[116:131], v[64:67], v[136:139], v[116:131]
    s_waitcnt lgkmcnt(0)
    v_mfma_f32_32x32x16_bf16 v[68:83], v[36:39], v[132:135], v[68:83]
    ds_read_b128 v[136:139], v151
    ds_read_b64_tr_b16 v[52:53], v164 offset:6144
    ds_read_b64_tr_b16 v[54:55], v164 offset:6656
    v_mfma_f32_32x32x16_bf16 v[84:99], v[40:43], v[132:135], v[84:99]
    ds_read_b64_tr_b16 v[56:57], v165 offset:6144
    ds_read_b64_tr_b16 v[58:59], v165 offset:6656
    ds_read_b64_tr_b16 v[60:61], v164 offset:14336
    v_mfma_f32_32x32x16_bf16 v[100:115], v[44:47], v[132:135], v[100:115]
    ds_read_b64_tr_b16 v[62:63], v164 offset:14848
    ds_read_b64_tr_b16 v[64:65], v165 offset:14336
    ds_read_b64_tr_b16 v[66:67], v165 offset:14848
    v_mfma_f32_32x32x16_bf16 v[116:131], v[48:51], v[132:135], v[116:131]
    s_waitcnt lgkmcnt(0)
    s_waitcnt vmcnt(6)
    s_barrier
    v_add_u32 v148, 49152, v152
    v_add_u32 v149, 49152, v153
    v_add_u32 v150, 49152, v154
    v_add_u32 v151, 49152, v155
    v_add_u32 v164, 49152, v166
    v_add_u32 v165, 49152, v167
    v_mfma_f32_32x32x16_bf16 v[68:83], v[52:55], v[136:139], v[68:83]
    ds_read_b128 v[132:135], v148
    ds_read_b64_tr_b16 v[36:37], v164 offset:0
    ds_read_b64_tr_b16 v[38:39], v164 offset:512
    v_mfma_f32_32x32x16_bf16 v[84:99], v[56:59], v[136:139], v[84:99]
    ds_read_b64_tr_b16 v[40:41], v165 offset:0
    ds_read_b64_tr_b16 v[42:43], v165 offset:512
    ds_read_b64_tr_b16 v[44:45], v164 offset:8192
    v_mfma_f32_32x32x16_bf16 v[100:115], v[60:63], v[136:139], v[100:115]
    ds_read_b64_tr_b16 v[46:47], v164 offset:8704
    ds_read_b64_tr_b16 v[48:49], v165 offset:8192
    ds_read_b64_tr_b16 v[50:51], v165 offset:8704
    v_mfma_f32_32x32x16_bf16 v[116:131], v[64:67], v[136:139], v[116:131]
    s_mov_b32 s92, 1152
    s_mov_b32 s93, 4718592
    s_add_u32 m0, s90, 0
    s_nop 0
    buffer_load_dwordx4 v168, s[8:11], s92 offen lds
    s_add_u32 m0, s90, 1024
    s_nop 0
    buffer_load_dwordx4 v169, s[8:11], s92 offen lds
    s_add_u32 m0, s90, 2048
    s_nop 0
    buffer_load_dwordx4 v170, s[8:11], s92 offen lds
    s_add_u32 m0, s90, 3072
    s_nop 0
    buffer_load_dwordx4 v171, s[8:11], s92 offen lds
    s_add_u32 m0, s91, 0
    s_nop 0
    buffer_load_dwordx4 v172, s[84:87], s93 offen lds
    s_add_u32 m0, s91, 1024
    s_nop 0
    buffer_load_dwordx4 v173, s[84:87], s93 offen lds
    s_waitcnt lgkmcnt(0)
    v_mfma_f32_32x32x16_bf16 v[68:83], v[36:39], v[132:135], v[68:83]
    ds_read_b128 v[136:139], v149
    ds_read_b64_tr_b16 v[52:53], v164 offset:2048
    ds_read_b64_tr_b16 v[54:55], v164 offset:2560
    v_mfma_f32_32x32x16_bf16 v[84:99], v[40:43], v[132:135], v[84:99]
    ds_read_b64_tr_b16 v[56:57], v165 offset:2048
    ds_read_b64_tr_b16 v[58:59], v165 offset:2560
    ds_read_b64_tr_b16 v[60:61], v164 offset:10240
    v_mfma_f32_32x32x16_bf16 v[100:115], v[44:47], v[132:135], v[100:115]
    ds_read_b64_tr_b16 v[62:63], v164 offset:10752
    ds_read_b64_tr_b16 v[64:65], v165 offset:10240
    ds_read_b64_tr_b16 v[66:67], v165 offset:10752
    v_mfma_f32_32x32x16_bf16 v[116:131], v[48:51], v[132:135], v[116:131]
    s_waitcnt lgkmcnt(0)
    v_mfma_f32_32x32x16_bf16 v[68:83], v[52:55], v[136:139], v[68:83]
    ds_read_b128 v[132:135], v150
    ds_read_b64_tr_b16 v[36:37], v164 offset:4096
    ds_read_b64_tr_b16 v[38:39], v164 offset:4608
    v_mfma_f32_32x32x16_bf16 v[84:99], v[56:59], v[136:139], v[84:99]
    ds_read_b64_tr_b16 v[40:41], v165 offset:4096
    ds_read_b64_tr_b16 v[42:43], v165 offset:4608
    ds_read_b64_tr_b16 v[44:45], v164 offset:12288
    v_mfma_f32_32x32x16_bf16 v[100:115], v[60:63], v[136:139], v[100:115]
    ds_read_b64_tr_b16 v[46:47], v164 offset:12800
    ds_read_b64_tr_b16 v[48:49], v165 offset:12288
    ds_read_b64_tr_b16 v[50:51], v165 offset:12800
    v_mfma_f32_32x32x16_bf16 v[116:131], v[64:67], v[136:139], v[116:131]
    s_waitcnt lgkmcnt(0)
    v_mfma_f32_32x32x16_bf16 v[68:83], v[36:39], v[132:135], v[68:83]
    ds_read_b128 v[136:139], v151
    ds_read_b64_tr_b16 v[52:53], v164 offset:6144
    ds_read_b64_tr_b16 v[54:55], v164 offset:6656
    v_mfma_f32_32x32x16_bf16 v[84:99], v[40:43], v[132:135], v[84:99]
    ds_read_b64_tr_b16 v[56:57], v165 offset:6144
    ds_read_b64_tr_b16 v[58:59], v165 offset:6656
    ds_read_b64_tr_b16 v[60:61], v164 offset:14336
    v_mfma_f32_32x32x16_bf16 v[100:115], v[44:47], v[132:135], v[100:115]
    ds_read_b64_tr_b16 v[62:63], v164 offset:14848
    ds_read_b64_tr_b16 v[64:65], v165 offset:14336
    ds_read_b64_tr_b16 v[66:67], v165 offset:14848
    v_mfma_f32_32x32x16_bf16 v[116:131], v[48:51], v[132:135], v[116:131]
    s_waitcnt lgkmcnt(0)
    s_waitcnt vmcnt(6)
    s_barrier
    v_add_u32 v148, 98304, v152
    v_add_u32 v149, 98304, v153
    v_add_u32 v150, 98304, v154
    v_add_u32 v151, 98304, v155
    v_add_u32 v164, 98304, v166
    v_add_u32 v165, 98304, v167
    v_mfma_f32_32x32x16_bf16 v[68:83], v[52:55], v[136:139], v[68:83]
    ds_read_b128 v[132:135], v148
    ds_read_b64_tr_b16 v[36:37], v164 offset:0
    ds_read_b64_tr_b16 v[38:39], v164 offset:512
    v_mfma_f32_32x32x16_bf16 v[84:99], v[56:59], v[136:139], v[84:99]
    ds_read_b64_tr_b16 v[40:41], v165 offset:0
    ds_read_b64_tr_b16 v[42:43], v165 offset:512
    ds_read_b64_tr_b16 v[44:45], v164 offset:8192
    v_mfma_f32_32x32x16_bf16 v[100:115], v[60:63], v[136:139], v[100:115]
    ds_read_b64_tr_b16 v[46:47], v164 offset:8704
    ds_read_b64_tr_b16 v[48:49], v165 offset:8192
    ds_read_b64_tr_b16 v[50:51], v165 offset:8704
    v_mfma_f32_32x32x16_bf16 v[116:131], v[64:67], v[136:139], v[116:131]
    s_mov_b32 s92, 1280
    s_mov_b32 s93, 5242880
    s_add_u32 m0, s90, 49152
    s_nop 0
    buffer_load_dwordx4 v168, s[8:11], s92 offen lds
    s_add_u32 m0, s90, 50176
    s_nop 0
    buffer_load_dwordx4 v169, s[8:11], s92 offen lds
    s_add_u32 m0, s90, 51200
    s_nop 0
    buffer_load_dwordx4 v170, s[8:11], s92 offen lds
    s_add_u32 m0, s90, 52224
    s_nop 0
    buffer_load_dwordx4 v171, s[8:11], s92 offen lds
    s_add_u32 m0, s91, 49152
    s_nop 0
    buffer_load_dwordx4 v172, s[84:87], s93 offen lds
    s_add_u32 m0, s91, 50176
    s_nop 0
    buffer_load_dwordx4 v173, s[84:87], s93 offen lds
    s_waitcnt lgkmcnt(0)
    v_mfma_f32_32x32x16_bf16 v[68:83], v[36:39], v[132:135], v[68:83]
    ds_read_b128 v[136:139], v149
    ds_read_b64_tr_b16 v[52:53], v164 offset:2048
    ds_read_b64_tr_b16 v[54:55], v164 offset:2560
    v_mfma_f32_32x32x16_bf16 v[84:99], v[40:43], v[132:135], v[84:99]
    ds_read_b64_tr_b16 v[56:57], v165 offset:2048
    ds_read_b64_tr_b16 v[58:59], v165 offset:2560
    ds_read_b64_tr_b16 v[60:61], v164 offset:10240
    v_mfma_f32_32x32x16_bf16 v[100:115], v[44:47], v[132:135], v[100:115]
    ds_read_b64_tr_b16 v[62:63], v164 offset:10752
    ds_read_b64_tr_b16 v[64:65], v165 offset:10240
    ds_read_b64_tr_b16 v[66:67], v165 offset:10752
    v_mfma_f32_32x32x16_bf16 v[116:131], v[48:51], v[132:135], v[116:131]
    s_waitcnt lgkmcnt(0)
    v_mfma_f32_32x32x16_bf16 v[68:83], v[52:55], v[136:139], v[68:83]
    ds_read_b128 v[132:135], v150
    ds_read_b64_tr_b16 v[36:37], v164 offset:4096
    ds_read_b64_tr_b16 v[38:39], v164 offset:4608
    v_mfma_f32_32x32x16_bf16 v[84:99], v[56:59], v[136:139], v[84:99]
    ds_read_b64_tr_b16 v[40:41], v165 offset:4096
    ds_read_b64_tr_b16 v[42:43], v165 offset:4608
    ds_read_b64_tr_b16 v[44:45], v164 offset:12288
    v_mfma_f32_32x32x16_bf16 v[100:115], v[60:63], v[136:139], v[100:115]
    ds_read_b64_tr_b16 v[46:47], v164 offset:12800
    ds_read_b64_tr_b16 v[48:49], v165 offset:12288
    ds_read_b64_tr_b16 v[50:51], v165 offset:12800
    v_mfma_f32_32x32x16_bf16 v[116:131], v[64:67], v[136:139], v[116:131]
    s_waitcnt lgkmcnt(0)
    v_mfma_f32_32x32x16_bf16 v[68:83], v[36:39], v[132:135], v[68:83]
    ds_read_b128 v[136:139], v151
    ds_read_b64_tr_b16 v[52:53], v164 offset:6144
    ds_read_b64_tr_b16 v[54:55], v164 offset:6656
    v_mfma_f32_32x32x16_bf16 v[84:99], v[40:43], v[132:135], v[84:99]
    ds_read_b64_tr_b16 v[56:57], v165 offset:6144
    ds_read_b64_tr_b16 v[58:59], v165 offset:6656
    ds_read_b64_tr_b16 v[60:61], v164 offset:14336
    v_mfma_f32_32x32x16_bf16 v[100:115], v[44:47], v[132:135], v[100:115]
    ds_read_b64_tr_b16 v[62:63], v164 offset:14848
    ds_read_b64_tr_b16 v[64:65], v165 offset:14336
    ds_read_b64_tr_b16 v[66:67], v165 offset:14848
    v_mfma_f32_32x32x16_bf16 v[116:131], v[48:51], v[132:135], v[116:131]
    s_waitcnt lgkmcnt(0)
    s_waitcnt vmcnt(6)
    s_barrier
    v_add_u32 v148, 0, v152
    v_add_u32 v149, 0, v153
    v_add_u32 v150, 0, v154
    v_add_u32 v151, 0, v155
    v_add_u32 v164, 0, v166
    v_add_u32 v165, 0, v167
    v_mfma_f32_32x32x16_bf16 v[68:83], v[52:55], v[136:139], v[68:83]
    ds_read_b128 v[132:135], v148
    ds_read_b64_tr_b16 v[36:37], v164 offset:0
    ds_read_b64_tr_b16 v[38:39], v164 offset:512
    v_mfma_f32_32x32x16_bf16 v[84:99], v[56:59], v[136:139], v[84:99]
    ds_read_b64_tr_b16 v[40:41], v165 offset:0
    ds_read_b64_tr_b16 v[42:43], v165 offset:512
    ds_read_b64_tr_b16 v[44:45], v164 offset:8192
    v_mfma_f32_32x32x16_bf16 v[100:115], v[60:63], v[136:139], v[100:115]
    ds_read_b64_tr_b16 v[46:47], v164 offset:8704
    ds_read_b64_tr_b16 v[48:49], v165 offset:8192
    ds_read_b64_tr_b16 v[50:51], v165 offset:8704
    v_mfma_f32_32x32x16_bf16 v[116:131], v[64:67], v[136:139], v[116:131]
    s_mov_b32 s92, 1408
    s_mov_b32 s93, 5767168
    s_add_u32 m0, s90, 98304
    s_nop 0
    buffer_load_dwordx4 v168, s[8:11], s92 offen lds
    s_add_u32 m0, s90, 99328
    s_nop 0
    buffer_load_dwordx4 v169, s[8:11], s92 offen lds
    s_add_u32 m0, s90, 100352
    s_nop 0
    buffer_load_dwordx4 v170, s[8:11], s92 offen lds
    s_add_u32 m0, s90, 101376
    s_nop 0
    buffer_load_dwordx4 v171, s[8:11], s92 offen lds
    s_add_u32 m0, s91, 98304
    s_nop 0
    buffer_load_dwordx4 v172, s[84:87], s93 offen lds
    s_add_u32 m0, s91, 99328
    s_nop 0
    buffer_load_dwordx4 v173, s[84:87], s93 offen lds
    s_waitcnt lgkmcnt(0)
    v_mfma_f32_32x32x16_bf16 v[68:83], v[36:39], v[132:135], v[68:83]
    ds_read_b128 v[136:139], v149
    ds_read_b64_tr_b16 v[52:53], v164 offset:2048
    ds_read_b64_tr_b16 v[54:55], v164 offset:2560
    v_mfma_f32_32x32x16_bf16 v[84:99], v[40:43], v[132:135], v[84:99]
    ds_read_b64_tr_b16 v[56:57], v165 offset:2048
    ds_read_b64_tr_b16 v[58:59], v165 offset:2560
    ds_read_b64_tr_b16 v[60:61], v164 offset:10240
    v_mfma_f32_32x32x16_bf16 v[100:115], v[44:47], v[132:135], v[100:115]
    ds_read_b64_tr_b16 v[62:63], v164 offset:10752
    ds_read_b64_tr_b16 v[64:65], v165 offset:10240
    ds_read_b64_tr_b16 v[66:67], v165 offset:10752
    v_mfma_f32_32x32x16_bf16 v[116:131], v[48:51], v[132:135], v[116:131]
    s_waitcnt lgkmcnt(0)
    v_mfma_f32_32x32x16_bf16 v[68:83], v[52:55], v[136:139], v[68:83]
    ds_read_b128 v[132:135], v150
    ds_read_b64_tr_b16 v[36:37], v164 offset:4096
    ds_read_b64_tr_b16 v[38:39], v164 offset:4608
    v_mfma_f32_32x32x16_bf16 v[84:99], v[56:59], v[136:139], v[84:99]
    ds_read_b64_tr_b16 v[40:41], v165 offset:4096
    ds_read_b64_tr_b16 v[42:43], v165 offset:4608
    ds_read_b64_tr_b16 v[44:45], v164 offset:12288
    v_mfma_f32_32x32x16_bf16 v[100:115], v[60:63], v[136:139], v[100:115]
    ds_read_b64_tr_b16 v[46:47], v164 offset:12800
    ds_read_b64_tr_b16 v[48:49], v165 offset:12288
    ds_read_b64_tr_b16 v[50:51], v165 offset:12800
    v_mfma_f32_32x32x16_bf16 v[116:131], v[64:67], v[136:139], v[116:131]
    s_waitcnt lgkmcnt(0)
    v_mfma_f32_32x32x16_bf16 v[68:83], v[36:39], v[132:135], v[68:83]
    ds_read_b128 v[136:139], v151
    ds_read_b64_tr_b16 v[52:53], v164 offset:6144
    ds_read_b64_tr_b16 v[54:55], v164 offset:6656
    v_mfma_f32_32x32x16_bf16 v[84:99], v[40:43], v[132:135], v[84:99]
    ds_read_b64_tr_b16 v[56:57], v165 offset:6144
    ds_read_b64_tr_b16 v[58:59], v165 offset:6656
    ds_read_b64_tr_b16 v[60:61], v164 offset:14336
    v_mfma_f32_32x32x16_bf16 v[100:115], v[44:47], v[132:135], v[100:115]
    ds_read_b64_tr_b16 v[62:63], v164 offset:14848
    ds_read_b64_tr_b16 v[64:65], v165 offset:14336
    ds_read_b64_tr_b16 v[66:67], v165 offset:14848
    v_mfma_f32_32x32x16_bf16 v[116:131], v[48:51], v[132:135], v[116:131]
    s_waitcnt lgkmcnt(0)
    s_waitcnt vmcnt(6)
    s_barrier
    v_add_u32 v148, 49152, v152
    v_add_u32 v149, 49152, v153
    v_add_u32 v150, 49152, v154
    v_add_u32 v151, 49152, v155
    v_add_u32 v164, 49152, v166
    v_add_u32 v165, 49152, v167
    v_mfma_f32_32x32x16_bf16 v[68:83], v[52:55], v[136:139], v[68:83]
    ds_read_b128 v[132:135], v148
    ds_read_b64_tr_b16 v[36:37], v164 offset:0
    ds_read_b64_tr_b16 v[38:39], v164 offset:512
    v_mfma_f32_32x32x16_bf16 v[84:99], v[56:59], v[136:139], v[84:99]
    ds_read_b64_tr_b16 v[40:41], v165 offset:0
    ds_read_b64_tr_b16 v[42:43], v165 offset:512
    ds_read_b64_tr_b16 v[44:45], v164 offset:8192
    v_mfma_f32_32x32x16_bf16 v[100:115], v[60:63], v[136:139], v[100:115]
    ds_read_b64_tr_b16 v[46:47], v164 offset:8704
    ds_read_b64_tr_b16 v[48:49], v165 offset:8192
    ds_read_b64_tr_b16 v[50:51], v165 offset:8704
    v_mfma_f32_32x32x16_bf16 v[116:131], v[64:67], v[136:139], v[116:131]
    s_mov_b32 s92, 1536
    s_mov_b32 s93, 6291456
    s_add_u32 m0, s90, 0
    s_nop 0
    buffer_load_dwordx4 v168, s[8:11], s92 offen lds
    s_add_u32 m0, s90, 1024
    s_nop 0
    buffer_load_dwordx4 v169, s[8:11], s92 offen lds
    s_add_u32 m0, s90, 2048
    s_nop 0
    buffer_load_dwordx4 v170, s[8:11], s92 offen lds
    s_add_u32 m0, s90, 3072
    s_nop 0
    buffer_load_dwordx4 v171, s[8:11], s92 offen lds
    s_add_u32 m0, s91, 0
    s_nop 0
    buffer_load_dwordx4 v172, s[84:87], s93 offen lds
    s_add_u32 m0, s91, 1024
    s_nop 0
    buffer_load_dwordx4 v173, s[84:87], s93 offen lds
    s_waitcnt lgkmcnt(0)
    v_mfma_f32_32x32x16_bf16 v[68:83], v[36:39], v[132:135], v[68:83]
    ds_read_b128 v[136:139], v149
    ds_read_b64_tr_b16 v[52:53], v164 offset:2048
    ds_read_b64_tr_b16 v[54:55], v164 offset:2560
    v_mfma_f32_32x32x16_bf16 v[84:99], v[40:43], v[132:135], v[84:99]
    ds_read_b64_tr_b16 v[56:57], v165 offset:2048
    ds_read_b64_tr_b16 v[58:59], v165 offset:2560
    ds_read_b64_tr_b16 v[60:61], v164 offset:10240
    v_mfma_f32_32x32x16_bf16 v[100:115], v[44:47], v[132:135], v[100:115]
    ds_read_b64_tr_b16 v[62:63], v164 offset:10752
    ds_read_b64_tr_b16 v[64:65], v165 offset:10240
    ds_read_b64_tr_b16 v[66:67], v165 offset:10752
    v_mfma_f32_32x32x16_bf16 v[116:131], v[48:51], v[132:135], v[116:131]
    s_waitcnt lgkmcnt(0)
    v_mfma_f32_32x32x16_bf16 v[68:83], v[52:55], v[136:139], v[68:83]
    ds_read_b128 v[132:135], v150
    ds_read_b64_tr_b16 v[36:37], v164 offset:4096
    ds_read_b64_tr_b16 v[38:39], v164 offset:4608
    v_mfma_f32_32x32x16_bf16 v[84:99], v[56:59], v[136:139], v[84:99]
    ds_read_b64_tr_b16 v[40:41], v165 offset:4096
    ds_read_b64_tr_b16 v[42:43], v165 offset:4608
    ds_read_b64_tr_b16 v[44:45], v164 offset:12288
    v_mfma_f32_32x32x16_bf16 v[100:115], v[60:63], v[136:139], v[100:115]
    ds_read_b64_tr_b16 v[46:47], v164 offset:12800
    ds_read_b64_tr_b16 v[48:49], v165 offset:12288
    ds_read_b64_tr_b16 v[50:51], v165 offset:12800
    v_mfma_f32_32x32x16_bf16 v[116:131], v[64:67], v[136:139], v[116:131]
    s_waitcnt lgkmcnt(0)
    v_mfma_f32_32x32x16_bf16 v[68:83], v[36:39], v[132:135], v[68:83]
    ds_read_b128 v[136:139], v151
    ds_read_b64_tr_b16 v[52:53], v164 offset:6144
    ds_read_b64_tr_b16 v[54:55], v164 offset:6656
    v_mfma_f32_32x32x16_bf16 v[84:99], v[40:43], v[132:135], v[84:99]
    ds_read_b64_tr_b16 v[56:57], v165 offset:6144
    ds_read_b64_tr_b16 v[58:59], v165 offset:6656
    ds_read_b64_tr_b16 v[60:61], v164 offset:14336
    v_mfma_f32_32x32x16_bf16 v[100:115], v[44:47], v[132:135], v[100:115]
    ds_read_b64_tr_b16 v[62:63], v164 offset:14848
    ds_read_b64_tr_b16 v[64:65], v165 offset:14336
    ds_read_b64_tr_b16 v[66:67], v165 offset:14848
    v_mfma_f32_32x32x16_bf16 v[116:131], v[48:51], v[132:135], v[116:131]
    s_waitcnt lgkmcnt(0)
    s_waitcnt vmcnt(6)
    s_barrier
    v_add_u32 v148, 98304, v152
    v_add_u32 v149, 98304, v153
    v_add_u32 v150, 98304, v154
    v_add_u32 v151, 98304, v155
    v_add_u32 v164, 98304, v166
    v_add_u32 v165, 98304, v167
    v_mfma_f32_32x32x16_bf16 v[68:83], v[52:55], v[136:139], v[68:83]
    ds_read_b128 v[132:135], v148
    ds_read_b64_tr_b16 v[36:37], v164 offset:0
    ds_read_b64_tr_b16 v[38:39], v164 offset:512
    v_mfma_f32_32x32x16_bf16 v[84:99], v[56:59], v[136:139], v[84:99]
    ds_read_b64_tr_b16 v[40:41], v165 offset:0
    ds_read_b64_tr_b16 v[42:43], v165 offset:512
    ds_read_b64_tr_b16 v[44:45], v164 offset:8192
    v_mfma_f32_32x32x16_bf16 v[100:115], v[60:63], v[136:139], v[100:115]
    ds_read_b64_tr_b16 v[46:47], v164 offset:8704
    ds_read_b64_tr_b16 v[48:49], v165 offset:8192
    ds_read_b64_tr_b16 v[50:51], v165 offset:8704
    v_mfma_f32_32x32x16_bf16 v[116:131], v[64:67], v[136:139], v[116:131]
    s_mov_b32 s92, 1664
    s_mov_b32 s93, 6815744
    s_add_u32 m0, s90, 49152
    s_nop 0
    buffer_load_dwordx4 v168, s[8:11], s92 offen lds
    s_add_u32 m0, s90, 50176
    s_nop 0
    buffer_load_dwordx4 v169, s[8:11], s92 offen lds
    s_add_u32 m0, s90, 51200
    s_nop 0
    buffer_load_dwordx4 v170, s[8:11], s92 offen lds
    s_add_u32 m0, s90, 52224
    s_nop 0
    buffer_load_dwordx4 v171, s[8:11], s92 offen lds
    s_add_u32 m0, s91, 49152
    s_nop 0
    buffer_load_dwordx4 v172, s[84:87], s93 offen lds
    s_add_u32 m0, s91, 50176
    s_nop 0
    buffer_load_dwordx4 v173, s[84:87], s93 offen lds
    s_waitcnt lgkmcnt(0)
    v_mfma_f32_32x32x16_bf16 v[68:83], v[36:39], v[132:135], v[68:83]
    ds_read_b128 v[136:139], v149
    ds_read_b64_tr_b16 v[52:53], v164 offset:2048
    ds_read_b64_tr_b16 v[54:55], v164 offset:2560
    v_mfma_f32_32x32x16_bf16 v[84:99], v[40:43], v[132:135], v[84:99]
    ds_read_b64_tr_b16 v[56:57], v165 offset:2048
    ds_read_b64_tr_b16 v[58:59], v165 offset:2560
    ds_read_b64_tr_b16 v[60:61], v164 offset:10240
    v_mfma_f32_32x32x16_bf16 v[100:115], v[44:47], v[132:135], v[100:115]
    ds_read_b64_tr_b16 v[62:63], v164 offset:10752
    ds_read_b64_tr_b16 v[64:65], v165 offset:10240
    ds_read_b64_tr_b16 v[66:67], v165 offset:10752
    v_mfma_f32_32x32x16_bf16 v[116:131], v[48:51], v[132:135], v[116:131]
    s_waitcnt lgkmcnt(0)
    v_mfma_f32_32x32x16_bf16 v[68:83], v[52:55], v[136:139], v[68:83]
    ds_read_b128 v[132:135], v150
    ds_read_b64_tr_b16 v[36:37], v164 offset:4096
    ds_read_b64_tr_b16 v[38:39], v164 offset:4608
    v_mfma_f32_32x32x16_bf16 v[84:99], v[56:59], v[136:139], v[84:99]
    ds_read_b64_tr_b16 v[40:41], v165 offset:4096
    ds_read_b64_tr_b16 v[42:43], v165 offset:4608
    ds_read_b64_tr_b16 v[44:45], v164 offset:12288
    v_mfma_f32_32x32x16_bf16 v[100:115], v[60:63], v[136:139], v[100:115]
    ds_read_b64_tr_b16 v[46:47], v164 offset:12800
    ds_read_b64_tr_b16 v[48:49], v165 offset:12288
    ds_read_b64_tr_b16 v[50:51], v165 offset:12800
    v_mfma_f32_32x32x16_bf16 v[116:131], v[64:67], v[136:139], v[116:131]
    s_waitcnt lgkmcnt(0)
    v_mfma_f32_32x32x16_bf16 v[68:83], v[36:39], v[132:135], v[68:83]
    ds_read_b128 v[136:139], v151
    ds_read_b64_tr_b16 v[52:53], v164 offset:6144
    ds_read_b64_tr_b16 v[54:55], v164 offset:6656
    v_mfma_f32_32x32x16_bf16 v[84:99], v[40:43], v[132:135], v[84:99]
    ds_read_b64_tr_b16 v[56:57], v165 offset:6144
    ds_read_b64_tr_b16 v[58:59], v165 offset:6656
    ds_read_b64_tr_b16 v[60:61], v164 offset:14336
    v_mfma_f32_32x32x16_bf16 v[100:115], v[44:47], v[132:135], v[100:115]
    ds_read_b64_tr_b16 v[62:63], v164 offset:14848
    ds_read_b64_tr_b16 v[64:65], v165 offset:14336
    ds_read_b64_tr_b16 v[66:67], v165 offset:14848
    v_mfma_f32_32x32x16_bf16 v[116:131], v[48:51], v[132:135], v[116:131]
    s_waitcnt lgkmcnt(0)
    s_waitcnt vmcnt(6)
    s_barrier
    v_add_u32 v148, 0, v152
    v_add_u32 v149, 0, v153
    v_add_u32 v150, 0, v154
    v_add_u32 v151, 0, v155
    v_add_u32 v164, 0, v166
    v_add_u32 v165, 0, v167
    v_mfma_f32_32x32x16_bf16 v[68:83], v[52:55], v[136:139], v[68:83]
    ds_read_b128 v[132:135], v148
    ds_read_b64_tr_b16 v[36:37], v164 offset:0
    ds_read_b64_tr_b16 v[38:39], v164 offset:512
    v_mfma_f32_32x32x16_bf16 v[84:99], v[56:59], v[136:139], v[84:99]
    ds_read_b64_tr_b16 v[40:41], v165 offset:0
    ds_read_b64_tr_b16 v[42:43], v165 offset:512
    ds_read_b64_tr_b16 v[44:45], v164 offset:8192
    v_mfma_f32_32x32x16_bf16 v[100:115], v[60:63], v[136:139], v[100:115]
    ds_read_b64_tr_b16 v[46:47], v164 offset:8704
    ds_read_b64_tr_b16 v[48:49], v165 offset:8192
    ds_read_b64_tr_b16 v[50:51], v165 offset:8704
    v_mfma_f32_32x32x16_bf16 v[116:131], v[64:67], v[136:139], v[116:131]
    s_mov_b32 s92, 1792
    s_mov_b32 s93, 7340032
    s_add_u32 m0, s90, 98304
    s_nop 0
    buffer_load_dwordx4 v168, s[8:11], s92 offen lds
    s_add_u32 m0, s90, 99328
    s_nop 0
    buffer_load_dwordx4 v169, s[8:11], s92 offen lds
    s_add_u32 m0, s90, 100352
    s_nop 0
    buffer_load_dwordx4 v170, s[8:11], s92 offen lds
    s_add_u32 m0, s90, 101376
    s_nop 0
    buffer_load_dwordx4 v171, s[8:11], s92 offen lds
    s_add_u32 m0, s91, 98304
    s_nop 0
    buffer_load_dwordx4 v172, s[84:87], s93 offen lds
    s_add_u32 m0, s91, 99328
    s_nop 0
    buffer_load_dwordx4 v173, s[84:87], s93 offen lds
    s_waitcnt lgkmcnt(0)
    v_mfma_f32_32x32x16_bf16 v[68:83], v[36:39], v[132:135], v[68:83]
    ds_read_b128 v[136:139], v149
    ds_read_b64_tr_b16 v[52:53], v164 offset:2048
    ds_read_b64_tr_b16 v[54:55], v164 offset:2560
    v_mfma_f32_32x32x16_bf16 v[84:99], v[40:43], v[132:135], v[84:99]
    ds_read_b64_tr_b16 v[56:57], v165 offset:2048
    ds_read_b64_tr_b16 v[58:59], v165 offset:2560
    ds_read_b64_tr_b16 v[60:61], v164 offset:10240
    v_mfma_f32_32x32x16_bf16 v[100:115], v[44:47], v[132:135], v[100:115]
    ds_read_b64_tr_b16 v[62:63], v164 offset:10752
    ds_read_b64_tr_b16 v[64:65], v165 offset:10240
    ds_read_b64_tr_b16 v[66:67], v165 offset:10752
    v_mfma_f32_32x32x16_bf16 v[116:131], v[48:51], v[132:135], v[116:131]
    s_waitcnt lgkmcnt(0)
    v_mfma_f32_32x32x16_bf16 v[68:83], v[52:55], v[136:139], v[68:83]
    ds_read_b128 v[132:135], v150
    ds_read_b64_tr_b16 v[36:37], v164 offset:4096
    ds_read_b64_tr_b16 v[38:39], v164 offset:4608
    v_mfma_f32_32x32x16_bf16 v[84:99], v[56:59], v[136:139], v[84:99]
    ds_read_b64_tr_b16 v[40:41], v165 offset:4096
    ds_read_b64_tr_b16 v[42:43], v165 offset:4608
    ds_read_b64_tr_b16 v[44:45], v164 offset:12288
    v_mfma_f32_32x32x16_bf16 v[100:115], v[60:63], v[136:139], v[100:115]
    ds_read_b64_tr_b16 v[46:47], v164 offset:12800
    ds_read_b64_tr_b16 v[48:49], v165 offset:12288
    ds_read_b64_tr_b16 v[50:51], v165 offset:12800
    v_mfma_f32_32x32x16_bf16 v[116:131], v[64:67], v[136:139], v[116:131]
    s_waitcnt lgkmcnt(0)
    v_mfma_f32_32x32x16_bf16 v[68:83], v[36:39], v[132:135], v[68:83]
    ds_read_b128 v[136:139], v151
    ds_read_b64_tr_b16 v[52:53], v164 offset:6144
    ds_read_b64_tr_b16 v[54:55], v164 offset:6656
    v_mfma_f32_32x32x16_bf16 v[84:99], v[40:43], v[132:135], v[84:99]
    ds_read_b64_tr_b16 v[56:57], v165 offset:6144
    ds_read_b64_tr_b16 v[58:59], v165 offset:6656
    ds_read_b64_tr_b16 v[60:61], v164 offset:14336
    v_mfma_f32_32x32x16_bf16 v[100:115], v[44:47], v[132:135], v[100:115]
    ds_read_b64_tr_b16 v[62:63], v164 offset:14848
    ds_read_b64_tr_b16 v[64:65], v165 offset:14336
    ds_read_b64_tr_b16 v[66:67], v165 offset:14848
    v_mfma_f32_32x32x16_bf16 v[116:131], v[48:51], v[132:135], v[116:131]
    s_waitcnt lgkmcnt(0)
    s_waitcnt vmcnt(6)
    s_barrier
    v_add_u32 v148, 49152, v152
    v_add_u32 v149, 49152, v153
    v_add_u32 v150, 49152, v154
    v_add_u32 v151, 49152, v155
    v_add_u32 v164, 49152, v166
    v_add_u32 v165, 49152, v167
    v_mfma_f32_32x32x16_bf16 v[68:83], v[52:55], v[136:139], v[68:83]
    ds_read_b128 v[132:135], v148
    ds_read_b64_tr_b16 v[36:37], v164 offset:0
    ds_read_b64_tr_b16 v[38:39], v164 offset:512
    v_mfma_f32_32x32x16_bf16 v[84:99], v[56:59], v[136:139], v[84:99]
    ds_read_b64_tr_b16 v[40:41], v165 offset:0
    ds_read_b64_tr_b16 v[42:43], v165 offset:512
    ds_read_b64_tr_b16 v[44:45], v164 offset:8192
    v_mfma_f32_32x32x16_bf16 v[100:115], v[60:63], v[136:139], v[100:115]
    ds_read_b64_tr_b16 v[46:47], v164 offset:8704
    ds_read_b64_tr_b16 v[48:49], v165 offset:8192
    ds_read_b64_tr_b16 v[50:51], v165 offset:8704
    v_mfma_f32_32x32x16_bf16 v[116:131], v[64:67], v[136:139], v[116:131]
    s_mov_b32 s92, 1920
    s_mov_b32 s93, 7864320
    s_add_u32 m0, s90, 0
    s_nop 0
    buffer_load_dwordx4 v168, s[8:11], s92 offen lds
    s_add_u32 m0, s90, 1024
    s_nop 0
    buffer_load_dwordx4 v169, s[8:11], s92 offen lds
    s_add_u32 m0, s90, 2048
    s_nop 0
    buffer_load_dwordx4 v170, s[8:11], s92 offen lds
    s_add_u32 m0, s90, 3072
    s_nop 0
    buffer_load_dwordx4 v171, s[8:11], s92 offen lds
    s_add_u32 m0, s91, 0
    s_nop 0
    buffer_load_dwordx4 v172, s[84:87], s93 offen lds
    s_add_u32 m0, s91, 1024
    s_nop 0
    buffer_load_dwordx4 v173, s[84:87], s93 offen lds
    s_waitcnt lgkmcnt(0)
    v_mfma_f32_32x32x16_bf16 v[68:83], v[36:39], v[132:135], v[68:83]
    ds_read_b128 v[136:139], v149
    ds_read_b64_tr_b16 v[52:53], v164 offset:2048
    ds_read_b64_tr_b16 v[54:55], v164 offset:2560
    v_mfma_f32_32x32x16_bf16 v[84:99], v[40:43], v[132:135], v[84:99]
    ds_read_b64_tr_b16 v[56:57], v165 offset:2048
    ds_read_b64_tr_b16 v[58:59], v165 offset:2560
    ds_read_b64_tr_b16 v[60:61], v164 offset:10240
    v_mfma_f32_32x32x16_bf16 v[100:115], v[44:47], v[132:135], v[100:115]
    ds_read_b64_tr_b16 v[62:63], v164 offset:10752
    ds_read_b64_tr_b16 v[64:65], v165 offset:10240
    ds_read_b64_tr_b16 v[66:67], v165 offset:10752
    v_mfma_f32_32x32x16_bf16 v[116:131], v[48:51], v[132:135], v[116:131]
    s_waitcnt lgkmcnt(0)
    v_mfma_f32_32x32x16_bf16 v[68:83], v[52:55], v[136:139], v[68:83]
    ds_read_b128 v[132:135], v150
    ds_read_b64_tr_b16 v[36:37], v164 offset:4096
    ds_read_b64_tr_b16 v[38:39], v164 offset:4608
    v_mfma_f32_32x32x16_bf16 v[84:99], v[56:59], v[136:139], v[84:99]
    ds_read_b64_tr_b16 v[40:41], v165 offset:4096
    ds_read_b64_tr_b16 v[42:43], v165 offset:4608
    ds_read_b64_tr_b16 v[44:45], v164 offset:12288
    v_mfma_f32_32x32x16_bf16 v[100:115], v[60:63], v[136:139], v[100:115]
    ds_read_b64_tr_b16 v[46:47], v164 offset:12800
    ds_read_b64_tr_b16 v[48:49], v165 offset:12288
    ds_read_b64_tr_b16 v[50:51], v165 offset:12800
    v_mfma_f32_32x32x16_bf16 v[116:131], v[64:67], v[136:139], v[116:131]
    s_waitcnt lgkmcnt(0)
    v_mfma_f32_32x32x16_bf16 v[68:83], v[36:39], v[132:135], v[68:83]
    ds_read_b128 v[136:139], v151
    ds_read_b64_tr_b16 v[52:53], v164 offset:6144
    ds_read_b64_tr_b16 v[54:55], v164 offset:6656
    v_mfma_f32_32x32x16_bf16 v[84:99], v[40:43], v[132:135], v[84:99]
    ds_read_b64_tr_b16 v[56:57], v165 offset:6144
    ds_read_b64_tr_b16 v[58:59], v165 offset:6656
    ds_read_b64_tr_b16 v[60:61], v164 offset:14336
    v_mfma_f32_32x32x16_bf16 v[100:115], v[44:47], v[132:135], v[100:115]
    ds_read_b64_tr_b16 v[62:63], v164 offset:14848
    ds_read_b64_tr_b16 v[64:65], v165 offset:14336
    ds_read_b64_tr_b16 v[66:67], v165 offset:14848
    v_mfma_f32_32x32x16_bf16 v[116:131], v[48:51], v[132:135], v[116:131]
    s_waitcnt lgkmcnt(0)
    s_waitcnt vmcnt(6)
    s_barrier
    v_add_u32 v148, 98304, v152
    v_add_u32 v149, 98304, v153
    v_add_u32 v150, 98304, v154
    v_add_u32 v151, 98304, v155
    v_add_u32 v164, 98304, v166
    v_add_u32 v165, 98304, v167
    v_mfma_f32_32x32x16_bf16 v[68:83], v[52:55], v[136:139], v[68:83]
    ds_read_b128 v[132:135], v148
    ds_read_b64_tr_b16 v[36:37], v164 offset:0
    ds_read_b64_tr_b16 v[38:39], v164 offset:512
    v_mfma_f32_32x32x16_bf16 v[84:99], v[56:59], v[136:139], v[84:99]
    ds_read_b64_tr_b16 v[40:41], v165 offset:0
    ds_read_b64_tr_b16 v[42:43], v165 offset:512
    ds_read_b64_tr_b16 v[44:45], v164 offset:8192
    v_mfma_f32_32x32x16_bf16 v[100:115], v[60:63], v[136:139], v[100:115]
    ds_read_b64_tr_b16 v[46:47], v164 offset:8704
    ds_read_b64_tr_b16 v[48:49], v165 offset:8192
    ds_read_b64_tr_b16 v[50:51], v165 offset:8704
    v_mfma_f32_32x32x16_bf16 v[116:131], v[64:67], v[136:139], v[116:131]
    s_waitcnt lgkmcnt(0)
    v_mfma_f32_32x32x16_bf16 v[68:83], v[36:39], v[132:135], v[68:83]
    ds_read_b128 v[136:139], v149
    ds_read_b64_tr_b16 v[52:53], v164 offset:2048
    ds_read_b64_tr_b16 v[54:55], v164 offset:2560
    v_mfma_f32_32x32x16_bf16 v[84:99], v[40:43], v[132:135], v[84:99]
    ds_read_b64_tr_b16 v[56:57], v165 offset:2048
    ds_read_b64_tr_b16 v[58:59], v165 offset:2560
    ds_read_b64_tr_b16 v[60:61], v164 offset:10240
    v_mfma_f32_32x32x16_bf16 v[100:115], v[44:47], v[132:135], v[100:115]
    ds_read_b64_tr_b16 v[62:63], v164 offset:10752
    ds_read_b64_tr_b16 v[64:65], v165 offset:10240
    ds_read_b64_tr_b16 v[66:67], v165 offset:10752
    v_mfma_f32_32x32x16_bf16 v[116:131], v[48:51], v[132:135], v[116:131]
    s_waitcnt lgkmcnt(0)
    v_mfma_f32_32x32x16_bf16 v[68:83], v[52:55], v[136:139], v[68:83]
    ds_read_b128 v[132:135], v150
    ds_read_b64_tr_b16 v[36:37], v164 offset:4096
    ds_read_b64_tr_b16 v[38:39], v164 offset:4608
    v_mfma_f32_32x32x16_bf16 v[84:99], v[56:59], v[136:139], v[84:99]
    ds_read_b64_tr_b16 v[40:41], v165 offset:4096
    ds_read_b64_tr_b16 v[42:43], v165 offset:4608
    ds_read_b64_tr_b16 v[44:45], v164 offset:12288
    v_mfma_f32_32x32x16_bf16 v[100:115], v[60:63], v[136:139], v[100:115]
    ds_read_b64_tr_b16 v[46:47], v164 offset:12800
    ds_read_b64_tr_b16 v[48:49], v165 offset:12288
    ds_read_b64_tr_b16 v[50:51], v165 offset:12800
    v_mfma_f32_32x32x16_bf16 v[116:131], v[64:67], v[136:139], v[116:131]
    s_waitcnt lgkmcnt(0)
    v_mfma_f32_32x32x16_bf16 v[68:83], v[36:39], v[132:135], v[68:83]
    ds_read_b128 v[136:139], v151
    ds_read_b64_tr_b16 v[52:53], v164 offset:6144
    ds_read_b64_tr_b16 v[54:55], v164 offset:6656
    v_mfma_f32_32x32x16_bf16 v[84:99], v[40:43], v[132:135], v[84:99]
    ds_read_b64_tr_b16 v[56:57], v165 offset:6144
    ds_read_b64_tr_b16 v[58:59], v165 offset:6656
    ds_read_b64_tr_b16 v[60:61], v164 offset:14336
    v_mfma_f32_32x32x16_bf16 v[100:115], v[44:47], v[132:135], v[100:115]
    ds_read_b64_tr_b16 v[62:63], v164 offset:14848
    ds_read_b64_tr_b16 v[64:65], v165 offset:14336
    ds_read_b64_tr_b16 v[66:67], v165 offset:14848
    v_mfma_f32_32x32x16_bf16 v[116:131], v[48:51], v[132:135], v[116:131]
    s_waitcnt lgkmcnt(0)
    s_waitcnt vmcnt(0)
    s_barrier
    v_add_u32 v148, 0, v152
    v_add_u32 v149, 0, v153
    v_add_u32 v150, 0, v154
    v_add_u32 v151, 0, v155
    v_add_u32 v164, 0, v166
    v_add_u32 v165, 0, v167
    v_mfma_f32_32x32x16_bf16 v[68:83], v[52:55], v[136:139], v[68:83]
    ds_read_b128 v[132:135], v148
    ds_read_b64_tr_b16 v[36:37], v164 offset:0
    ds_read_b64_tr_b16 v[38:39], v164 offset:512
    v_mfma_f32_32x32x16_bf16 v[84:99], v[56:59], v[136:139], v[84:99]
    ds_read_b64_tr_b16 v[40:41], v165 offset:0
    ds_read_b64_tr_b16 v[42:43], v165 offset:512
    ds_read_b64_tr_b16 v[44:45], v164 offset:8192
    v_mfma_f32_32x32x16_bf16 v[100:115], v[60:63], v[136:139], v[100:115]
    ds_read_b64_tr_b16 v[46:47], v164 offset:8704
    ds_read_b64_tr_b16 v[48:49], v165 offset:8192
    ds_read_b64_tr_b16 v[50:51], v165 offset:8704
    v_mfma_f32_32x32x16_bf16 v[116:131], v[64:67], v[136:139], v[116:131]
    s_cmp_eq_u32 s49, 0
    s_cbranch_scc1 L_attn_kernel_gp1
    s_xor_b32 s52, s53, 32768
    s_add_u32 s52, s52, s46
    s_add_u32 m0, s52, 0
    s_nop 0
    buffer_load_dwordx4 v196, s[12:15], s47 offen lds
    s_add_u32 m0, s52, 1024
    s_nop 0
    buffer_load_dwordx4 v197, s[12:15], s47 offen lds
    s_add_u32 m0, s52, 2048
    s_nop 0
    buffer_load_dwordx4 v198, s[12:15], s47 offen lds
    s_add_u32 m0, s52, 3072
    s_nop 0
    buffer_load_dwordx4 v199, s[12:15], s47 offen lds
    s_add_u32 s47, s47, 16384
    s_xor_b32 s52, s53, 49152
    s_add_u32 s52, s52, s46
    s_add_u32 m0, s52, 0
    s_nop 0
    buffer_load_dwordx4 v196, s[12:15], s47 offen lds
    s_add_u32 m0, s52, 1024
    s_nop 0
    buffer_load_dwordx4 v197, s[12:15], s47 offen lds
    s_add_u32 m0, s52, 2048
    s_nop 0
    buffer_load_dwordx4 v198, s[12:15], s47 offen lds
    s_add_u32 m0, s52, 3072
    s_nop 0
    buffer_load_dwordx4 v199, s[12:15], s47 offen lds
    s_add_u32 s47, s47, 16384
    s_xor_b32 s52, s53, 0
    s_add_u32 s52, s52, s46
    s_add_u32 m0, s52, 0
    s_nop 0
    buffer_load_dwordx4 v196, s[12:15], s47 offen lds
    s_add_u32 m0, s52, 1024
    s_nop 0
    buffer_load_dwordx4 v197, s[12:15], s47 offen lds
    s_add_u32 m0, s52, 2048
    s_nop 0
    buffer_load_dwordx4 v198, s[12:15], s47 offen lds
    s_add_u32 m0, s52, 3072
    s_nop 0
    buffer_load_dwordx4 v199, s[12:15], s47 offen lds
    s_add_u32 s47, s47, 16384
    s_branch L_attn_kernel_gp2
L_attn_kernel_gp1:
    s_xor_b32 s52, s53, 16384
    s_add_u32 s52, s52, s46
    s_add_u32 m0, s52, 0
    s_nop 0
    buffer_load_dwordx4 v196, s[12:15], s47 offen lds
    s_add_u32 m0, s52, 1024
    s_nop 0
    buffer_load_dwordx4 v197, s[12:15], s47 offen lds
    s_add_u32 m0, s52, 2048
    s_nop 0
    buffer_load_dwordx4 v198, s[12:15], s47 offen lds
    s_add_u32 m0, s52, 3072
    s_nop 0
    buffer_load_dwordx4 v199, s[12:15], s47 offen lds
    s_add_u32 s47, s47, 16384
    s_xor_b32 s52, s53, 32768
    s_add_u32 s52, s52, s46
    s_add_u32 m0, s52, 0
    s_nop 0
    buffer_load_dwordx4 v196, s[12:15], s47 offen lds
    s_add_u32 m0, s52, 1024
    s_nop 0
    buffer_load_dwordx4 v197, s[12:15], s47 offen lds
    s_add_u32 m0, s52, 2048
    s_nop 0
    buffer_load_dwordx4 v198, s[12:15], s47 offen lds
    s_add_u32 m0, s52, 3072
    s_nop 0
    buffer_load_dwordx4 v199, s[12:15], s47 offen lds
    s_add_u32 s47, s47, 16384
L_attn_kernel_gp2:
    s_waitcnt lgkmcnt(0)
    v_mfma_f32_32x32x16_bf16 v[68:83], v[36:39], v[132:135], v[68:83]
    ds_read_b128 v[136:139], v149
    ds_read_b64_tr_b16 v[52:53], v164 offset:2048
    ds_read_b64_tr_b16 v[54:55], v164 offset:2560
    v_mfma_f32_32x32x16_bf16 v[84:99], v[40:43], v[132:135], v[84:99]
    ds_read_b64_tr_b16 v[56:57], v165 offset:2048
    ds_read_b64_tr_b16 v[58:59], v165 offset:2560
    ds_read_b64_tr_b16 v[60:61], v164 offset:10240
    v_mfma_f32_32x32x16_bf16 v[100:115], v[44:47], v[132:135], v[100:115]
    ds_read_b64_tr_b16 v[62:63], v164 offset:10752
    ds_read_b64_tr_b16 v[64:65], v165 offset:10240
    ds_read_b64_tr_b16 v[66:67], v165 offset:10752
    v_mfma_f32_32x32x16_bf16 v[116:131], v[48:51], v[132:135], v[116:131]
    s_waitcnt lgkmcnt(0)
    v_mfma_f32_32x32x16_bf16 v[68:83], v[52:55], v[136:139], v[68:83]
    ds_read_b128 v[132:135], v150
    ds_read_b64_tr_b16 v[36:37], v164 offset:4096
    ds_read_b64_tr_b16 v[38:39], v164 offset:4608
    v_mfma_f32_32x32x16_bf16 v[84:99], v[56:59], v[136:139], v[84:99]
    ds_read_b64_tr_b16 v[40:41], v165 offset:4096
    ds_read_b64_tr_b16 v[42:43], v165 offset:4608
    ds_read_b64_tr_b16 v[44:45], v164 offset:12288
    v_mfma_f32_32x32x16_bf16 v[100:115], v[60:63], v[136:139], v[100:115]
    ds_read_b64_tr_b16 v[46:47], v164 offset:12800
    ds_read_b64_tr_b16 v[48:49], v165 offset:12288
    ds_read_b64_tr_b16 v[50:51], v165 offset:12800
    v_mfma_f32_32x32x16_bf16 v[116:131], v[64:67], v[136:139], v[116:131]
    s_waitcnt lgkmcnt(0)
    v_mfma_f32_32x32x16_bf16 v[68:83], v[36:39], v[132:135], v[68:83]
    ds_read_b128 v[136:139], v151
    ds_read_b64_tr_b16 v[52:53], v164 offset:6144
    ds_read_b64_tr_b16 v[54:55], v164 offset:6656
    v_mfma_f32_32x32x16_bf16 v[84:99], v[40:43], v[132:135], v[84:99]
    ds_read_b64_tr_b16 v[56:57], v165 offset:6144
    ds_read_b64_tr_b16 v[58:59], v165 offset:6656
    ds_read_b64_tr_b16 v[60:61], v164 offset:14336
    v_mfma_f32_32x32x16_bf16 v[100:115], v[44:47], v[132:135], v[100:115]
    ds_read_b64_tr_b16 v[62:63], v164 offset:14848
    ds_read_b64_tr_b16 v[64:65], v165 offset:14336
    ds_read_b64_tr_b16 v[66:67], v165 offset:14848
    v_mfma_f32_32x32x16_bf16 v[116:131], v[48:51], v[132:135], v[116:131]
    s_waitcnt lgkmcnt(0)
    v_mfma_f32_32x32x16_bf16 v[68:83], v[52:55], v[136:139], v[68:83]
    v_mfma_f32_32x32x16_bf16 v[84:99], v[56:59], v[136:139], v[84:99]
    v_mfma_f32_32x32x16_bf16 v[100:115], v[60:63], v[136:139], v[100:115]
    v_mfma_f32_32x32x16_bf16 v[116:131], v[64:67], v[136:139], v[116:131]
    s_nop 8
    v_cvt_pk_bf16_f32 v4, v68, v69
    v_cvt_pk_bf16_f32 v5, v70, v71
    v_cvt_pk_bf16_f32 v6, v72, v73
    v_cvt_pk_bf16_f32 v7, v74, v75
    v_cvt_pk_bf16_f32 v8, v76, v77
    v_cvt_pk_bf16_f32 v9, v78, v79
    v_cvt_pk_bf16_f32 v10, v80, v81
    v_cvt_pk_bf16_f32 v11, v82, v83
    v_cvt_pk_bf16_f32 v12, v84, v85
    v_cvt_pk_bf16_f32 v13, v86, v87
    v_cvt_pk_bf16_f32 v14, v88, v89
    v_cvt_pk_bf16_f32 v15, v90, v91
    v_cvt_pk_bf16_f32 v16, v92, v93
    v_cvt_pk_bf16_f32 v17, v94, v95
    v_cvt_pk_bf16_f32 v18, v96, v97
    v_cvt_pk_bf16_f32 v19, v98, v99
    v_cvt_pk_bf16_f32 v20, v100, v101
    v_cvt_pk_bf16_f32 v21, v102, v103
    v_cvt_pk_bf16_f32 v22, v104, v105
    v_cvt_pk_bf16_f32 v23, v106, v107
    v_cvt_pk_bf16_f32 v24, v108, v109
    v_cvt_pk_bf16_f32 v25, v110, v111
    v_cvt_pk_bf16_f32 v26, v112, v113
    v_cvt_pk_bf16_f32 v27, v114, v115
    v_cvt_pk_bf16_f32 v28, v116, v117
    v_cvt_pk_bf16_f32 v29, v118, v119
    v_cvt_pk_bf16_f32 v30, v120, v121
    v_cvt_pk_bf16_f32 v31, v122, v123
    v_cvt_pk_bf16_f32 v32, v124, v125
    v_cvt_pk_bf16_f32 v33, v126, v127
    v_cvt_pk_bf16_f32 v34, v128, v129
    v_cvt_pk_bf16_f32 v35, v130, v131
    v_mov_b32 v68, 0
    v_mov_b32 v69, 0
    v_mov_b32 v70, 0
    v_mov_b32 v71, 0
    v_mov_b32 v72, 0
    v_mov_b32 v73, 0
    v_mov_b32 v74, 0
    v_mov_b32 v75, 0
    v_mov_b32 v76, 0
    v_mov_b32 v77, 0
    v_mov_b32 v78, 0
    v_mov_b32 v79, 0
    v_mov_b32 v80, 0
    v_mov_b32 v81, 0
    v_mov_b32 v82, 0
    v_mov_b32 v83, 0
    v_mov_b32 v84, 0
    v_mov_b32 v85, 0
    v_mov_b32 v86, 0
    v_mov_b32 v87, 0
    v_mov_b32 v88, 0
    v_mov_b32 v89, 0
    v_mov_b32 v90, 0
    v_mov_b32 v91, 0
    v_mov_b32 v92, 0
    v_mov_b32 v93, 0
    v_mov_b32 v94, 0
    v_mov_b32 v95, 0
    v_mov_b32 v96, 0
    v_mov_b32 v97, 0
    v_mov_b32 v98, 0
    v_mov_b32 v99, 0
    v_mov_b32 v100, 0
    v_mov_b32 v101, 0
    v_mov_b32 v102, 0
    v_mov_b32 v103, 0
    v_mov_b32 v104, 0
    v_mov_b32 v105, 0
    v_mov_b32 v106, 0
    v_mov_b32 v107, 0
    v_mov_b32 v108, 0
    v_mov_b32 v109, 0
    v_mov_b32 v110, 0
    v_mov_b32 v111, 0
    v_mov_b32 v112, 0
    v_mov_b32 v113, 0
    v_mov_b32 v114, 0
    v_mov_b32 v115, 0
    v_mov_b32 v116, 0
    v_mov_b32 v117, 0
    v_mov_b32 v118, 0
    v_mov_b32 v119, 0
    v_mov_b32 v120, 0
    v_mov_b32 v121, 0
    v_mov_b32 v122, 0
    v_mov_b32 v123, 0
    v_mov_b32 v124, 0
    v_mov_b32 v125, 0
    v_mov_b32 v126, 0
    v_mov_b32 v127, 0
    v_mov_b32 v128, 0
    v_mov_b32 v129, 0
    v_mov_b32 v130, 0
    v_mov_b32 v131, 0
    s_cmp_eq_u32 s49, 0
    s_cbranch_scc1 L_attn_kernel_go
    s_waitcnt vmcnt(8)
    s_barrier
L_attn_kernel_go:
    s_setprio 3
    ds_read_b128 v[148:151], v180 offset:49152
    ds_read_b128 v[152:155], v181 offset:49152
    ds_read_b128 v[156:159], v182 offset:49152
    ds_read_b128 v[160:163], v183 offset:49152
    s_waitcnt lgkmcnt(3)
    v_mfma_f32_32x32x16_bf16 v[36:51], v[148:151], v[4:7], 0
    ds_read_b128 v[148:151], v184 offset:49152
    s_waitcnt lgkmcnt(3)
    v_mfma_f32_32x32x16_bf16 v[36:51], v[152:155], v[8:11], v[36:51]
    ds_read_b128 v[152:155], v185 offset:49152
    s_waitcnt lgkmcnt(3)
    v_mfma_f32_32x32x16_bf16 v[36:51], v[156:159], v[12:15], v[36:51]
    ds_read_b128 v[156:159], v186 offset:49152
    s_waitcnt lgkmcnt(3)
    v_mfma_f32_32x32x16_bf16 v[36:51], v[160:163], v[16:19], v[36:51]
    ds_read_b128 v[160:163], v187 offset:49152
    s_waitcnt lgkmcnt(3)
    v_mfma_f32_32x32x16_bf16 v[36:51], v[148:151], v[20:23], v[36:51]
    ds_read_b128 v[148:151], v180 offset:57344
    s_waitcnt lgkmcnt(3)
    v_mfma_f32_32x32x16_bf16 v[36:51], v[152:155], v[24:27], v[36:51]
    ds_read_b128 v[152:155], v181 offset:57344
    s_waitcnt lgkmcnt(3)
    v_mfma_f32_32x32x16_bf16 v[36:51], v[156:159], v[28:31], v[36:51]
    ds_read_b128 v[156:159], v182 offset:57344
    s_waitcnt lgkmcnt(3)
    v_mfma_f32_32x32x16_bf16 v[36:51], v[160:163], v[32:35], v[36:51]
    ds_read_b128 v[160:163], v183 offset:57344
    s_waitcnt lgkmcnt(3)
    v_mfma_f32_32x32x16_bf16 v[52:67], v[148:151], v[4:7], 0
    ds_read_b128 v[148:151], v184 offset:57344
    s_waitcnt lgkmcnt(3)
    v_mfma_f32_32x32x16_bf16 v[52:67], v[152:155], v[8:11], v[52:67]
    ds_read_b128 v[152:155], v185 offset:57344
    s_waitcnt lgkmcnt(3)
    v_mfma_f32_32x32x16_bf16 v[52:67], v[156:159], v[12:15], v[52:67]
    ds_read_b128 v[156:159], v186 offset:57344
    s_waitcnt lgkmcnt(3)
    v_mfma_f32_32x32x16_bf16 v[52:67], v[160:163], v[16:19], v[52:67]
    ds_read_b128 v[160:163], v187 offset:57344
    s_waitcnt lgkmcnt(3)
    v_mfma_f32_32x32x16_bf16 v[52:67], v[148:151], v[20:23], v[52:67]
    s_waitcnt lgkmcnt(2)
    v_mfma_f32_32x32x16_bf16 v[52:67], v[152:155], v[24:27], v[52:67]
    s_waitcnt lgkmcnt(1)
    v_mfma_f32_32x32x16_bf16 v[52:67], v[156:159], v[28:31], v[52:67]
    s_waitcnt lgkmcnt(0)
    v_mfma_f32_32x32x16_bf16 v[52:67], v[160:163], v[32:35], v[52:67]
    v_cvt_pk_bf16_f32 v36, 0, v36
    v_cvt_pk_bf16_f32 v37, 0, v37
    v_cvt_pk_bf16_f32 v38, 0, v38
    v_cvt_pk_bf16_f32 v39, 0, v39
    v_cvt_pk_bf16_f32 v40, 0, v40
    v_cvt_pk_bf16_f32 v41, 0, v41
    v_cvt_pk_bf16_f32 v42, 0, v42
    v_cvt_pk_bf16_f32 v43, 0, v43
    v_mul_f32 v36, v217, v36
    v_mul_f32 v37, v217, v37
    v_mul_f32 v38, v217, v38
    v_mul_f32 v39, v217, v39
    v_mul_f32 v40, v217, v40
    v_mul_f32 v41, v217, v41
    v_mul_f32 v42, v217, v42
    v_mul_f32 v43, v217, v43
    v_cvt_pk_bf16_f32 v36, 0, v36
    v_cvt_pk_bf16_f32 v37, 0, v37
    v_cvt_pk_bf16_f32 v38, 0, v38
    v_cvt_pk_bf16_f32 v39, 0, v39
    v_cvt_pk_bf16_f32 v40, 0, v40
    v_cvt_pk_bf16_f32 v41, 0, v41
    v_cvt_pk_bf16_f32 v42, 0, v42
    v_cvt_pk_bf16_f32 v43, 0, v43
    v_cvt_pk_bf16_f32 v44, 0, v44
    v_cvt_pk_bf16_f32 v45, 0, v45
    v_cvt_pk_bf16_f32 v46, 0, v46
    v_cvt_pk_bf16_f32 v47, 0, v47
    v_cvt_pk_bf16_f32 v48, 0, v48
    v_cvt_pk_bf16_f32 v49, 0, v49
    v_cvt_pk_bf16_f32 v50, 0, v50
    v_cvt_pk_bf16_f32 v51, 0, v51
    v_mul_f32 v44, v217, v44
    v_mul_f32 v45, v217, v45
    v_mul_f32 v46, v217, v46
    v_mul_f32 v47, v217, v47
    v_mul_f32 v48, v217, v48
    v_mul_f32 v49, v217, v49
    v_mul_f32 v50, v217, v50
    v_mul_f32 v51, v217, v51
    v_cvt_pk_bf16_f32 v44, 0, v44
    v_cvt_pk_bf16_f32 v45, 0, v45
    v_cvt_pk_bf16_f32 v46, 0, v46
    v_cvt_pk_bf16_f32 v47, 0, v47
    v_cvt_pk_bf16_f32 v48, 0, v48
    v_cvt_pk_bf16_f32 v49, 0, v49
    v_cvt_pk_bf16_f32 v50, 0, v50
    v_cvt_pk_bf16_f32 v51, 0, v51
    v_cvt_pk_bf16_f32 v52, 0, v52
    v_cvt_pk_bf16_f32 v53, 0, v53
    v_cvt_pk_bf16_f32 v54, 0, v54
    v_cvt_pk_bf16_f32 v55, 0, v55
    v_cvt_pk_bf16_f32 v56, 0, v56
    v_cvt_pk_bf16_f32 v57, 0, v57
    v_cvt_pk_bf16_f32 v58, 0, v58
    v_cvt_pk_bf16_f32 v59, 0, v59
    v_mul_f32 v52, v217, v52
    v_mul_f32 v53, v217, v53
    v_mul_f32 v54, v217, v54
    v_mul_f32 v55, v217, v55
    v_mul_f32 v56, v217, v56
    v_mul_f32 v57, v217, v57
    v_mul_f32 v58, v217, v58
    v_mul_f32 v59, v217, v59
    v_cvt_pk_bf16_f32 v52, 0, v52
    v_cvt_pk_bf16_f32 v53, 0, v53
    v_cvt_pk_bf16_f32 v54, 0, v54
    v_cvt_pk_bf16_f32 v55, 0, v55
    v_cvt_pk_bf16_f32 v56, 0, v56
    v_cvt_pk_bf16_f32 v57, 0, v57
    v_cvt_pk_bf16_f32 v58, 0, v58
    v_cvt_pk_bf16_f32 v59, 0, v59
    v_cvt_pk_bf16_f32 v60, 0, v60
    v_cvt_pk_bf16_f32 v61, 0, v61
    v_cvt_pk_bf16_f32 v62, 0, v62
    v_cvt_pk_bf16_f32 v63, 0, v63
    v_cvt_pk_bf16_f32 v64, 0, v64
    v_cvt_pk_bf16_f32 v65, 0, v65
    v_cvt_pk_bf16_f32 v66, 0, v66
    v_cvt_pk_bf16_f32 v67, 0, v67
    v_mul_f32 v60, v217, v60
    v_mul_f32 v61, v217, v61
    v_mul_f32 v62, v217, v62
    v_mul_f32 v63, v217, v63
    v_mul_f32 v64, v217, v64
    v_mul_f32 v65, v217, v65
    v_mul_f32 v66, v217, v66
    v_mul_f32 v67, v217, v67
    v_cvt_pk_bf16_f32 v60, 0, v60
    v_cvt_pk_bf16_f32 v61, 0, v61
    v_cvt_pk_bf16_f32 v62, 0, v62
    v_cvt_pk_bf16_f32 v63, 0, v63
    v_cvt_pk_bf16_f32 v64, 0, v64
    v_cvt_pk_bf16_f32 v65, 0, v65
    v_cvt_pk_bf16_f32 v66, 0, v66
    v_cvt_pk_bf16_f32 v67, 0, v67
    v_max3_f32 v204, v36, v37, v38
    v_max3_f32 v205, v44, v45, v46
    v_max3_f32 v206, v52, v53, v54
    v_max3_f32 v207, v60, v61, v62
    v_max3_f32 v204, v204, v39, v40
    v_max3_f32 v205, v205, v47, v48
    v_max3_f32 v206, v206, v55, v56
    v_max3_f32 v207, v207, v63, v64
    v_max3_f32 v204, v204, v41, v42
    v_max3_f32 v205, v205, v49, v50
    v_max3_f32 v206, v206, v57, v58
    v_max3_f32 v207, v207, v65, v66
    v_max3_f32 v204, v204, v43, v51
    v_max3_f32 v206, v206, v59, v67
    v_max3_f32 v204, v204, v205, v206
    v_max_f32 v204, v204, v207
    s_setprio 0
    s_barrier
    v_mov_b32 v205, v204
    s_nop 1
    v_permlane32_swap_b32 v204, v205
    v_max_f32 v204, v204, v205
    v_sub_f32 v205, v204, v200
    v_cmp_lt_f32 vcc, v218, v205
    s_cbranch_vccz L_attn_kernel_nr1
    v_max_f32 v204, v204, v200
    v_mul_f32 v203, v216, v204
    v_fma_f32 v205, v200, v216, -v203
    v_exp_f32 v202, v205
    v_mov_b32 v200, v204
    v_mul_f32 v201, v202, v201
    v_mul_f32 v68, v202, v68
    v_mul_f32 v69, v202, v69
    v_mul_f32 v70, v202, v70
    v_mul_f32 v71, v202, v71
    v_mul_f32 v72, v202, v72
    v_mul_f32 v73, v202, v73
    v_mul_f32 v74, v202, v74
    v_mul_f32 v75, v202, v75
    v_mul_f32 v76, v202, v76
    v_mul_f32 v77, v202, v77
    v_mul_f32 v78, v202, v78
    v_mul_f32 v79, v202, v79
    v_mul_f32 v80, v202, v80
    v_mul_f32 v81, v202, v81
    v_mul_f32 v82, v202, v82
    v_mul_f32 v83, v202, v83
    v_mul_f32 v84, v202, v84
    v_mul_f32 v85, v202, v85
    v_mul_f32 v86, v202, v86
    v_mul_f32 v87, v202, v87
    v_mul_f32 v88, v202, v88
    v_mul_f32 v89, v202, v89
    v_mul_f32 v90, v202, v90
    v_mul_f32 v91, v202, v91
    v_mul_f32 v92, v202, v92
    v_mul_f32 v93, v202, v93
    v_mul_f32 v94, v202, v94
    v_mul_f32 v95, v202, v95
    v_mul_f32 v96, v202, v96
    v_mul_f32 v97, v202, v97
    v_mul_f32 v98, v202, v98
    v_mul_f32 v99, v202, v99
    v_mul_f32 v100, v202, v100
    v_mul_f32 v101, v202, v101
    v_mul_f32 v102, v202, v102
    v_mul_f32 v103, v202, v103
    v_mul_f32 v104, v202, v104
    v_mul_f32 v105, v202, v105
    v_mul_f32 v106, v202, v106
    v_mul_f32 v107, v202, v107
    v_mul_f32 v108, v202, v108
    v_mul_f32 v109, v202, v109
    v_mul_f32 v110, v202, v110
    v_mul_f32 v111, v202, v111
    v_mul_f32 v112, v202, v112
    v_mul_f32 v113, v202, v113
    v_mul_f32 v114, v202, v114
    v_mul_f32 v115, v202, v115
    v_mul_f32 v116, v202, v116
    v_mul_f32 v117, v202, v117
    v_mul_f32 v118, v202, v118
    v_mul_f32 v119, v202, v119
    v_mul_f32 v120, v202, v120
    v_mul_f32 v121, v202, v121
    v_mul_f32 v122, v202, v122
    v_mul_f32 v123, v202, v123
    v_mul_f32 v124, v202, v124
    v_mul_f32 v125, v202, v125
    v_mul_f32 v126, v202, v126
    v_mul_f32 v127, v202, v127
    v_mul_f32 v128, v202, v128
    v_mul_f32 v129, v202, v129
    v_mul_f32 v130, v202, v130
    v_mul_f32 v131, v202, v131
L_attn_kernel_nr1:
    v_fma_f32 v36, v36, v216, -v203
    v_fma_f32 v37, v37, v216, -v203
    v_fma_f32 v38, v38, v216, -v203
    v_fma_f32 v39, v39, v216, -v203
    v_fma_f32 v40, v40, v216, -v203
    v_fma_f32 v41, v41, v216, -v203
    v_fma_f32 v42, v42, v216, -v203
    v_fma_f32 v43, v43, v216, -v203
    v_exp_f32 v36, v36
    v_exp_f32 v37, v37
    v_exp_f32 v38, v38
    v_exp_f32 v39, v39
    v_exp_f32 v40, v40
    v_exp_f32 v41, v41
    v_exp_f32 v42, v42
    v_exp_f32 v43, v43
    v_fma_f32 v44, v44, v216, -v203
    v_fma_f32 v45, v45, v216, -v203
    v_fma_f32 v46, v46, v216, -v203
    v_fma_f32 v47, v47, v216, -v203
    v_fma_f32 v48, v48, v216, -v203
    v_fma_f32 v49, v49, v216, -v203
    v_fma_f32 v50, v50, v216, -v203
    v_fma_f32 v51, v51, v216, -v203
    v_exp_f32 v44, v44
    v_exp_f32 v45, v45
    v_exp_f32 v46, v46
    v_exp_f32 v47, v47
    v_exp_f32 v48, v48
    v_exp_f32 v49, v49
    v_exp_f32 v50, v50
    v_exp_f32 v51, v51
    v_mov_b32 v212, v36
    v_mov_b32 v213, v37
    v_mov_b32 v214, v38
    v_mov_b32 v215, v39
    v_add_f32 v212, v212, v40
    v_add_f32 v213, v213, v41
    v_add_f32 v214, v214, v42
    v_add_f32 v215, v215, v43
    v_cvt_pk_bf16_f32 v132, v36, v37
    v_cvt_pk_bf16_f32 v133, v38, v39
    v_cvt_pk_bf16_f32 v134, v40, v41
    v_cvt_pk_bf16_f32 v135, v42, v43
    v_fma_f32 v52, v52, v216, -v203
    v_fma_f32 v53, v53, v216, -v203
    v_fma_f32 v54, v54, v216, -v203
    v_fma_f32 v55, v55, v216, -v203
    v_fma_f32 v56, v56, v216, -v203
    v_fma_f32 v57, v57, v216, -v203
    v_fma_f32 v58, v58, v216, -v203
    v_fma_f32 v59, v59, v216, -v203
    v_exp_f32 v52, v52
    v_exp_f32 v53, v53
    v_exp_f32 v54, v54
    v_exp_f32 v55, v55
    v_exp_f32 v56, v56
    v_exp_f32 v57, v57
    v_exp_f32 v58, v58
    v_exp_f32 v59, v59
    v_add_f32 v212, v212, v44
    v_add_f32 v213, v213, v45
    v_add_f32 v214, v214, v46
    v_add_f32 v215, v215, v47
    v_add_f32 v212, v212, v48
    v_add_f32 v213, v213, v49
    v_add_f32 v214, v214, v50
    v_add_f32 v215, v215, v51
    v_cvt_pk_bf16_f32 v136, v44, v45
    v_cvt_pk_bf16_f32 v137, v46, v47
    v_cvt_pk_bf16_f32 v138, v48, v49
    v_cvt_pk_bf16_f32 v139, v50, v51
    v_fma_f32 v60, v60, v216, -v203
    v_fma_f32 v61, v61, v216, -v203
    v_fma_f32 v62, v62, v216, -v203
    v_fma_f32 v63, v63, v216, -v203
    v_fma_f32 v64, v64, v216, -v203
    v_fma_f32 v65, v65, v216, -v203
    v_fma_f32 v66, v66, v216, -v203
    v_fma_f32 v67, v67, v216, -v203
    v_exp_f32 v60, v60
    v_exp_f32 v61, v61
    v_exp_f32 v62, v62
    v_exp_f32 v63, v63
    v_exp_f32 v64, v64
    v_exp_f32 v65, v65
    v_exp_f32 v66, v66
    v_exp_f32 v67, v67
    v_add_f32 v212, v212, v52
    v_add_f32 v213, v213, v53
    v_add_f32 v214, v214, v54
    v_add_f32 v215, v215, v55
    v_add_f32 v212, v212, v56
    v_add_f32 v213, v213, v57
    v_add_f32 v214, v214, v58
    v_add_f32 v215, v215, v59
    v_cvt_pk_bf16_f32 v140, v52, v53
    v_cvt_pk_bf16_f32 v141, v54, v55
    v_cvt_pk_bf16_f32 v142, v56, v57
    v_cvt_pk_bf16_f32 v143, v58, v59
    v_add_f32 v212, v212, v60
    v_add_f32 v213, v213, v61
    v_add_f32 v214, v214, v62
    v_add_f32 v215, v215, v63
    v_add_f32 v212, v212, v64
    v_add_f32 v213, v213, v65
    v_add_f32 v214, v214, v66
    v_add_f32 v215, v215, v67
    v_cvt_pk_bf16_f32 v144, v60, v61
    v_cvt_pk_bf16_f32 v145, v62, v63
    v_cvt_pk_bf16_f32 v146, v64, v65
    v_cvt_pk_bf16_f32 v147, v66, v67
    v_add_f32 v212, v212, v213
    v_add_f32 v214, v214, v215
    v_add_f32 v212, v212, v214
    v_add_f32 v201, v201, v212
    ds_read_b128 v[148:151], v180 offset:0
    ds_read_b128 v[152:155], v181 offset:0
    ds_read_b128 v[156:159], v182 offset:0
    ds_read_b128 v[160:163], v183 offset:0
    s_waitcnt vmcnt(4)
    s_barrier
    s_mov_b32 s35, 0
L_attn_kernel_loop:
    s_setprio 3
    s_waitcnt lgkmcnt(3)
    v_mfma_f32_32x32x16_bf16 v[36:51], v[148:151], v[4:7], 0
    ds_read_b128 v[148:151], v184 offset:0
    s_waitcnt lgkmcnt(3)
    v_mfma_f32_32x32x16_bf16 v[36:51], v[152:155], v[8:11], v[36:51]
    ds_read_b128 v[152:155], v185 offset:0
    s_add_u32 s52, s46, 49152
    s_add_u32 m0, s52, 0
    s_nop 0
    buffer_load_dwordx4 v196, s[12:15], s47 offen lds
    s_waitcnt lgkmcnt(3)
    v_mfma_f32_32x32x16_bf16 v[36:51], v[156:159], v[12:15], v[36:51]
    ds_read_b128 v[156:159], v186 offset:0
    s_waitcnt lgkmcnt(3)
    v_mfma_f32_32x32x16_bf16 v[36:51], v[160:163], v[16:19], v[36:51]
    ds_read_b128 v[160:163], v187 offset:0
    s_waitcnt lgkmcnt(3)
    v_mfma_f32_32x32x16_bf16 v[36:51], v[148:151], v[20:23], v[36:51]
    ds_read_b128 v[148:151], v180 offset:8192
    s_waitcnt lgkmcnt(3)
    v_mfma_f32_32x32x16_bf16 v[36:51], v[152:155], v[24:27], v[36:51]
    ds_read_b128 v[152:155], v181 offset:8192
    s_add_u32 m0, s52, 1024
    s_nop 0
    buffer_load_dwordx4 v197, s[12:15], s47 offen lds
    s_waitcnt lgkmcnt(3)
    v_mfma_f32_32x32x16_bf16 v[36:51], v[156:159], v[28:31], v[36:51]
    ds_read_b128 v[156:159], v182 offset:8192
    s_waitcnt lgkmcnt(3)
    v_mfma_f32_32x32x16_bf16 v[36:51], v[160:163], v[32:35], v[36:51]
    ds_read_b128 v[160:163], v183 offset:8192
    s_waitcnt lgkmcnt(3)
    v_mfma_f32_32x32x16_bf16 v[52:67], v[148:151], v[4:7], 0
    ds_read_b128 v[148:151], v184 offset:8192
    s_waitcnt lgkmcnt(3)
    v_mfma_f32_32x32x16_bf16 v[52:67], v[152:155], v[8:11], v[52:67]
    ds_read_b128 v[152:155], v185 offset:8192
    s_add_u32 m0, s52, 2048
    s_nop 0
    buffer_load_dwordx4 v198, s[12:15], s47 offen lds
    s_waitcnt lgkmcnt(3)
    v_mfma_f32_32x32x16_bf16 v[52:67], v[156:159], v[12:15], v[52:67]
    ds_read_b128 v[156:159], v186 offset:8192
    s_waitcnt lgkmcnt(3)
    v_mfma_f32_32x32x16_bf16 v[52:67], v[160:163], v[16:19], v[52:67]
    ds_read_b128 v[160:163], v187 offset:8192
    s_waitcnt lgkmcnt(3)
    v_mfma_f32_32x32x16_bf16 v[52:67], v[148:151], v[20:23], v[52:67]
    ds_read_b64_tr_b16 v[164:165], v188 offset:16384
    ds_read_b64_tr_b16 v[166:167], v188 offset:18432
    s_waitcnt lgkmcnt(4)
    v_mfma_f32_32x32x16_bf16 v[52:67], v[152:155], v[24:27], v[52:67]
    ds_read_b64_tr_b16 v[168:169], v188 offset:20480
    ds_read_b64_tr_b16 v[170:171], v188 offset:22528
    s_add_u32 m0, s52, 3072
    s_nop 0
    buffer_load_dwordx4 v199, s[12:15], s47 offen lds
    s_add_u32 s47, s47, 16384
    s_cmp_lg_u32 s35, 0
    s_cbranch_scc1 L_attn_kernel_pf1
    buffer_load_dword v220, v219, s[16:19], 0 offen offset:0
    v_add_u32 v219, 4096, v219
L_attn_kernel_pf1:
    s_waitcnt lgkmcnt(5)
    v_mfma_f32_32x32x16_bf16 v[52:67], v[156:159], v[28:31], v[52:67]
    ds_read_b64_tr_b16 v[172:173], v188 offset:24576
    ds_read_b64_tr_b16 v[174:175], v188 offset:26624
    s_waitcnt lgkmcnt(6)
    v_mfma_f32_32x32x16_bf16 v[52:67], v[160:163], v[32:35], v[52:67]
    ds_read_b64_tr_b16 v[176:177], v188 offset:28672
    ds_read_b64_tr_b16 v[178:179], v188 offset:30720
    s_waitcnt lgkmcnt(6)
    v_mfma_f32_32x32x16_bf16 v[68:83], v[164:167], v[132:135], v[68:83]
    ds_read_b64_tr_b16 v[164:165], v189 offset:16384
    ds_read_b64_tr_b16 v[166:167], v189 offset:18432
    v_cvt_pk_bf16_f32 v36, 0, v36
    v_cvt_pk_bf16_f32 v37, 0, v37
    v_cvt_pk_bf16_f32 v38, 0, v38
    v_cvt_pk_bf16_f32 v39, 0, v39
    v_cvt_pk_bf16_f32 v40, 0, v40
    v_cvt_pk_bf16_f32 v41, 0, v41
    v_cvt_pk_bf16_f32 v42, 0, v42
    s_waitcnt lgkmcnt(6)
    v_mfma_f32_32x32x16_bf16 v[68:83], v[168:171], v[136:139], v[68:83]
    ds_read_b64_tr_b16 v[168:169], v189 offset:20480
    ds_read_b64_tr_b16 v[170:171], v189 offset:22528
    v_cvt_pk_bf16_f32 v43, 0, v43
    v_mul_f32 v36, v217, v36
    v_mul_f32 v37, v217, v37
    v_mul_f32 v38, v217, v38
    v_mul_f32 v39, v217, v39
    v_mul_f32 v40, v217, v40
    v_mul_f32 v41, v217, v41
    s_waitcnt lgkmcnt(6)
    v_mfma_f32_32x32x16_bf16 v[68:83], v[172:175], v[140:143], v[68:83]
    ds_read_b64_tr_b16 v[172:173], v189 offset:24576
    ds_read_b64_tr_b16 v[174:175], v189 offset:26624
    v_mul_f32 v42, v217, v42
    v_mul_f32 v43, v217, v43
    v_cvt_pk_bf16_f32 v36, 0, v36
    v_cvt_pk_bf16_f32 v37, 0, v37
    v_cvt_pk_bf16_f32 v38, 0, v38
    v_cvt_pk_bf16_f32 v39, 0, v39
    v_cvt_pk_bf16_f32 v40, 0, v40
    s_waitcnt lgkmcnt(6)
    v_mfma_f32_32x32x16_bf16 v[68:83], v[176:179], v[144:147], v[68:83]
    ds_read_b64_tr_b16 v[176:177], v189 offset:28672
    ds_read_b64_tr_b16 v[178:179], v189 offset:30720
    v_cvt_pk_bf16_f32 v41, 0, v41
    v_cvt_pk_bf16_f32 v42, 0, v42
    v_cvt_pk_bf16_f32 v43, 0, v43
    v_cvt_pk_bf16_f32 v44, 0, v44
    v_cvt_pk_bf16_f32 v45, 0, v45
    v_cvt_pk_bf16_f32 v46, 0, v46
    v_cvt_pk_bf16_f32 v47, 0, v47
    s_waitcnt lgkmcnt(6)
    v_mfma_f32_32x32x16_bf16 v[84:99], v[164:167], v[132:135], v[84:99]
    ds_read_b64_tr_b16 v[164:165], v190 offset:16384
    ds_read_b64_tr_b16 v[166:167], v190 offset:18432
    v_cvt_pk_bf16_f32 v48, 0, v48
    v_cvt_pk_bf16_f32 v49, 0, v49
    v_cvt_pk_bf16_f32 v50, 0, v50
    v_cvt_pk_bf16_f32 v51, 0, v51
    v_mul_f32 v44, v217, v44
    v_mul_f32 v45, v217, v45
    v_mul_f32 v46, v217, v46
    s_waitcnt lgkmcnt(6)
    v_mfma_f32_32x32x16_bf16 v[84:99], v[168:171], v[136:139], v[84:99]
    ds_read_b64_tr_b16 v[168:169], v190 offset:20480
    ds_read_b64_tr_b16 v[170:171], v190 offset:22528
    v_mul_f32 v47, v217, v47
    v_mul_f32 v48, v217, v48
    v_mul_f32 v49, v217, v49
    v_mul_f32 v50, v217, v50
    v_mul_f32 v51, v217, v51
    v_cvt_pk_bf16_f32 v44, 0, v44
    v_cvt_pk_bf16_f32 v45, 0, v45
    s_waitcnt lgkmcnt(6)
    v_mfma_f32_32x32x16_bf16 v[84:99], v[172:175], v[140:143], v[84:99]
    ds_read_b64_tr_b16 v[172:173], v190 offset:24576
    ds_read_b64_tr_b16 v[174:175], v190 offset:26624
    v_cvt_pk_bf16_f32 v46, 0, v46
    v_cvt_pk_bf16_f32 v47, 0, v47
    v_cvt_pk_bf16_f32 v48, 0, v48
    v_cvt_pk_bf16_f32 v49, 0, v49
    v_cvt_pk_bf16_f32 v50, 0, v50
    v_cvt_pk_bf16_f32 v51, 0, v51
    v_cvt_pk_bf16_f32 v52, 0, v52
    s_waitcnt lgkmcnt(6)
    v_mfma_f32_32x32x16_bf16 v[84:99], v[176:179], v[144:147], v[84:99]
    ds_read_b64_tr_b16 v[176:177], v190 offset:28672
    ds_read_b64_tr_b16 v[178:179], v190 offset:30720
    v_cvt_pk_bf16_f32 v53, 0, v53
    v_cvt_pk_bf16_f32 v54, 0, v54
    v_cvt_pk_bf16_f32 v55, 0, v55
    v_cvt_pk_bf16_f32 v56, 0, v56
    v_cvt_pk_bf16_f32 v57, 0, v57
    v_cvt_pk_bf16_f32 v58, 0, v58
    v_cvt_pk_bf16_f32 v59, 0, v59
    s_waitcnt lgkmcnt(6)
    v_mfma_f32_32x32x16_bf16 v[100:115], v[164:167], v[132:135], v[100:115]
    ds_read_b64_tr_b16 v[164:165], v191 offset:16384
    ds_read_b64_tr_b16 v[166:167], v191 offset:18432
    v_mul_f32 v52, v217, v52
    v_mul_f32 v53, v217, v53
    v_mul_f32 v54, v217, v54
    v_mul_f32 v55, v217, v55
    v_mul_f32 v56, v217, v56
    v_mul_f32 v57, v217, v57
    v_mul_f32 v58, v217, v58
    s_waitcnt lgkmcnt(6)
    v_mfma_f32_32x32x16_bf16 v[100:115], v[168:171], v[136:139], v[100:115]
    ds_read_b64_tr_b16 v[168:169], v191 offset:20480
    ds_read_b64_tr_b16 v[170:171], v191 offset:22528
    v_mul_f32 v59, v217, v59
    v_cvt_pk_bf16_f32 v52, 0, v52
    v_cvt_pk_bf16_f32 v53, 0, v53
    v_cvt_pk_bf16_f32 v54, 0, v54
    v_cvt_pk_bf16_f32 v55, 0, v55
    v_cvt_pk_bf16_f32 v56, 0, v56
    v_cvt_pk_bf16_f32 v57, 0, v57
    s_waitcnt lgkmcnt(6)
    v_mfma_f32_32x32x16_bf16 v[100:115], v[172:175], v[140:143], v[100:115]
    ds_read_b64_tr_b16 v[172:173], v191 offset:24576
    ds_read_b64_tr_b16 v[174:175], v191 offset:26624
    v_cvt_pk_bf16_f32 v58, 0, v58
    v_cvt_pk_bf16_f32 v59, 0, v59
    v_cvt_pk_bf16_f32 v60, 0, v60
    v_cvt_pk_bf16_f32 v61, 0, v61
    v_cvt_pk_bf16_f32 v62, 0, v62
    v_cvt_pk_bf16_f32 v63, 0, v63
    v_cvt_pk_bf16_f32 v64, 0, v64
    s_waitcnt lgkmcnt(6)
    v_mfma_f32_32x32x16_bf16 v[100:115], v[176:179], v[144:147], v[100:115]
    ds_read_b64_tr_b16 v[176:177], v191 offset:28672
    ds_read_b64_tr_b16 v[178:179], v191 offset:30720
    v_cvt_pk_bf16_f32 v65, 0, v65
    v_cvt_pk_bf16_f32 v66, 0, v66
    v_cvt_pk_bf16_f32 v67, 0, v67
    v_mul_f32 v60, v217, v60
    v_mul_f32 v61, v217, v61
    v_mul_f32 v62, v217, v62
    v_mul_f32 v63, v217, v63
    s_waitcnt lgkmcnt(6)
    v_mfma_f32_32x32x16_bf16 v[116:131], v[164:167], v[132:135], v[116:131]
    v_mul_f32 v64, v217, v64
    v_mul_f32 v65, v217, v65
    v_mul_f32 v66, v217, v66
    v_mul_f32 v67, v217, v67
    v_cvt_pk_bf16_f32 v60, 0, v60
    v_cvt_pk_bf16_f32 v61, 0, v61
    v_cvt_pk_bf16_f32 v62, 0, v62
    s_waitcnt lgkmcnt(4)
    v_mfma_f32_32x32x16_bf16 v[116:131], v[168:171], v[136:139], v[116:131]
    v_cvt_pk_bf16_f32 v63, 0, v63
    v_cvt_pk_bf16_f32 v64, 0, v64
    v_cvt_pk_bf16_f32 v65, 0, v65
    v_cvt_pk_bf16_f32 v66, 0, v66
    v_cvt_pk_bf16_f32 v67, 0, v67
    v_max3_f32 v204, v36, v37, v38
    v_max3_f32 v205, v44, v45, v46
    s_waitcnt lgkmcnt(2)
    v_mfma_f32_32x32x16_bf16 v[116:131], v[172:175], v[140:143], v[116:131]
    v_max3_f32 v206, v52, v53, v54
    v_max3_f32 v207, v60, v61, v62
    v_max3_f32 v204, v204, v39, v40
    v_max3_f32 v205, v205, v47, v48
    v_max3_f32 v206, v206, v55, v56
    v_max3_f32 v207, v207, v63, v64
    v_max3_f32 v204, v204, v41, v42
    s_waitcnt lgkmcnt(0)
    v_mfma_f32_32x32x16_bf16 v[116:131], v[176:179], v[144:147], v[116:131]
    v_max3_f32 v205, v205, v49, v50
    v_max3_f32 v206, v206, v57, v58
    v_max3_f32 v207, v207, v65, v66
    v_max3_f32 v204, v204, v43, v51
    v_max3_f32 v206, v206, v59, v67
    v_max3_f32 v204, v204, v205, v206
    v_max_f32 v204, v204, v207
    s_setprio 0
    s_barrier
    v_mov_b32 v205, v204
    s_nop 1
    v_permlane32_swap_b32 v204, v205
    v_max_f32 v204, v204, v205
    v_sub_f32 v205, v204, v200
    v_cmp_lt_f32 vcc, v218, v205
    s_cbranch_vccz L_attn_kernel_nr2
    v_max_f32 v204, v204, v200
    v_mul_f32 v203, v216, v204
    v_fma_f32 v205, v200, v216, -v203
    v_exp_f32 v202, v205
    v_mov_b32 v200, v204
    v_mul_f32 v201, v202, v201
    v_mul_f32 v68, v202, v68
    v_mul_f32 v69, v202, v69
    v_mul_f32 v70, v202, v70
    v_mul_f32 v71, v202, v71
    v_mul_f32 v72, v202, v72
    v_mul_f32 v73, v202, v73
    v_mul_f32 v74, v202, v74
    v_mul_f32 v75, v202, v75
    v_mul_f32 v76, v202, v76
    v_mul_f32 v77, v202, v77
    v_mul_f32 v78, v202, v78
    v_mul_f32 v79, v202, v79
    v_mul_f32 v80, v202, v80
    v_mul_f32 v81, v202, v81
    v_mul_f32 v82, v202, v82
    v_mul_f32 v83, v202, v83
    v_mul_f32 v84, v202, v84
    v_mul_f32 v85, v202, v85
    v_mul_f32 v86, v202, v86
    v_mul_f32 v87, v202, v87
    v_mul_f32 v88, v202, v88
    v_mul_f32 v89, v202, v89
    v_mul_f32 v90, v202, v90
    v_mul_f32 v91, v202, v91
    v_mul_f32 v92, v202, v92
    v_mul_f32 v93, v202, v93
    v_mul_f32 v94, v202, v94
    v_mul_f32 v95, v202, v95
    v_mul_f32 v96, v202, v96
    v_mul_f32 v97, v202, v97
    v_mul_f32 v98, v202, v98
    v_mul_f32 v99, v202, v99
    v_mul_f32 v100, v202, v100
    v_mul_f32 v101, v202, v101
    v_mul_f32 v102, v202, v102
    v_mul_f32 v103, v202, v103
    v_mul_f32 v104, v202, v104
    v_mul_f32 v105, v202, v105
    v_mul_f32 v106, v202, v106
    v_mul_f32 v107, v202, v107
    v_mul_f32 v108, v202, v108
    v_mul_f32 v109, v202, v109
    v_mul_f32 v110, v202, v110
    v_mul_f32 v111, v202, v111
    v_mul_f32 v112, v202, v112
    v_mul_f32 v113, v202, v113
    v_mul_f32 v114, v202, v114
    v_mul_f32 v115, v202, v115
    v_mul_f32 v116, v202, v116
    v_mul_f32 v117, v202, v117
    v_mul_f32 v118, v202, v118
    v_mul_f32 v119, v202, v119
    v_mul_f32 v120, v202, v120
    v_mul_f32 v121, v202, v121
    v_mul_f32 v122, v202, v122
    v_mul_f32 v123, v202, v123
    v_mul_f32 v124, v202, v124
    v_mul_f32 v125, v202, v125
    v_mul_f32 v126, v202, v126
    v_mul_f32 v127, v202, v127
    v_mul_f32 v128, v202, v128
    v_mul_f32 v129, v202, v129
    v_mul_f32 v130, v202, v130
    v_mul_f32 v131, v202, v131
L_attn_kernel_nr2:
    v_fma_f32 v36, v36, v216, -v203
    v_fma_f32 v37, v37, v216, -v203
    v_fma_f32 v38, v38, v216, -v203
    v_fma_f32 v39, v39, v216, -v203
    v_fma_f32 v40, v40, v216, -v203
    v_fma_f32 v41, v41, v216, -v203
    v_fma_f32 v42, v42, v216, -v203
    v_fma_f32 v43, v43, v216, -v203
    v_exp_f32 v36, v36
    v_exp_f32 v37, v37
    v_exp_f32 v38, v38
    v_exp_f32 v39, v39
    v_exp_f32 v40, v40
    v_exp_f32 v41, v41
    v_exp_f32 v42, v42
    v_exp_f32 v43, v43
    v_fma_f32 v44, v44, v216, -v203
    v_fma_f32 v45, v45, v216, -v203
    v_fma_f32 v46, v46, v216, -v203
    v_fma_f32 v47, v47, v216, -v203
    v_fma_f32 v48, v48, v216, -v203
    v_fma_f32 v49, v49, v216, -v203
    v_fma_f32 v50, v50, v216, -v203
    v_fma_f32 v51, v51, v216, -v203
    v_exp_f32 v44, v44
    v_exp_f32 v45, v45
    v_exp_f32 v46, v46
    v_exp_f32 v47, v47
    v_exp_f32 v48, v48
    v_exp_f32 v49, v49
    v_exp_f32 v50, v50
    v_exp_f32 v51, v51
    v_mov_b32 v212, v36
    v_mov_b32 v213, v37
    v_mov_b32 v214, v38
    v_mov_b32 v215, v39
    v_add_f32 v212, v212, v40
    v_add_f32 v213, v213, v41
    v_add_f32 v214, v214, v42
    v_add_f32 v215, v215, v43
    v_cvt_pk_bf16_f32 v132, v36, v37
    v_cvt_pk_bf16_f32 v133, v38, v39
    v_cvt_pk_bf16_f32 v134, v40, v41
    v_cvt_pk_bf16_f32 v135, v42, v43
    v_fma_f32 v52, v52, v216, -v203
    v_fma_f32 v53, v53, v216, -v203
    v_fma_f32 v54, v54, v216, -v203
    v_fma_f32 v55, v55, v216, -v203
    v_fma_f32 v56, v56, v216, -v203
    v_fma_f32 v57, v57, v216, -v203
    v_fma_f32 v58, v58, v216, -v203
    v_fma_f32 v59, v59, v216, -v203
    v_exp_f32 v52, v52
    v_exp_f32 v53, v53
    v_exp_f32 v54, v54
    v_exp_f32 v55, v55
    v_exp_f32 v56, v56
    v_exp_f32 v57, v57
    v_exp_f32 v58, v58
    v_exp_f32 v59, v59
    v_add_f32 v212, v212, v44
    v_add_f32 v213, v213, v45
    v_add_f32 v214, v214, v46
    v_add_f32 v215, v215, v47
    v_add_f32 v212, v212, v48
    v_add_f32 v213, v213, v49
    v_add_f32 v214, v214, v50
    v_add_f32 v215, v215, v51
    v_cvt_pk_bf16_f32 v136, v44, v45
    v_cvt_pk_bf16_f32 v137, v46, v47
    v_cvt_pk_bf16_f32 v138, v48, v49
    v_cvt_pk_bf16_f32 v139, v50, v51
    v_fma_f32 v60, v60, v216, -v203
    v_fma_f32 v61, v61, v216, -v203
    v_fma_f32 v62, v62, v216, -v203
    v_fma_f32 v63, v63, v216, -v203
    v_fma_f32 v64, v64, v216, -v203
    v_fma_f32 v65, v65, v216, -v203
    v_fma_f32 v66, v66, v216, -v203
    v_fma_f32 v67, v67, v216, -v203
    v_exp_f32 v60, v60
    v_exp_f32 v61, v61
    v_exp_f32 v62, v62
    v_exp_f32 v63, v63
    v_exp_f32 v64, v64
    v_exp_f32 v65, v65
    v_exp_f32 v66, v66
    v_exp_f32 v67, v67
    v_add_f32 v212, v212, v52
    v_add_f32 v213, v213, v53
    v_add_f32 v214, v214, v54
    v_add_f32 v215, v215, v55
    v_add_f32 v212, v212, v56
    v_add_f32 v213, v213, v57
    v_add_f32 v214, v214, v58
    v_add_f32 v215, v215, v59
    v_cvt_pk_bf16_f32 v140, v52, v53
    v_cvt_pk_bf16_f32 v141, v54, v55
    v_cvt_pk_bf16_f32 v142, v56, v57
    v_cvt_pk_bf16_f32 v143, v58, v59
    v_add_f32 v212, v212, v60
    v_add_f32 v213, v213, v61
    v_add_f32 v214, v214, v62
    v_add_f32 v215, v215, v63
    v_add_f32 v212, v212, v64
    v_add_f32 v213, v213, v65
    v_add_f32 v214, v214, v66
    v_add_f32 v215, v215, v67
    v_cvt_pk_bf16_f32 v144, v60, v61
    v_cvt_pk_bf16_f32 v145, v62, v63
    v_cvt_pk_bf16_f32 v146, v64, v65
    v_cvt_pk_bf16_f32 v147, v66, v67
    v_add_f32 v212, v212, v213
    v_add_f32 v214, v214, v215
    v_add_f32 v212, v212, v214
    v_add_f32 v201, v201, v212
    ds_read_b128 v[148:151], v180 offset:16384
    ds_read_b128 v[152:155], v181 offset:16384
    ds_read_b128 v[156:159], v182 offset:16384
    ds_read_b128 v[160:163], v183 offset:16384
    s_waitcnt vmcnt(4)
    s_barrier
    s_setprio 3
    s_waitcnt lgkmcnt(3)
    v_mfma_f32_32x32x16_bf16 v[36:51], v[148:151], v[4:7], 0
    ds_read_b128 v[148:151], v184 offset:16384
    s_waitcnt lgkmcnt(3)
    v_mfma_f32_32x32x16_bf16 v[36:51], v[152:155], v[8:11], v[36:51]
    ds_read_b128 v[152:155], v185 offset:16384
    s_add_u32 s52, s46, 0
    s_add_u32 m0, s52, 0
    s_nop 0
    buffer_load_dwordx4 v196, s[12:15], s47 offen lds
    s_waitcnt lgkmcnt(3)
    v_mfma_f32_32x32x16_bf16 v[36:51], v[156:159], v[12:15], v[36:51]
    ds_read_b128 v[156:159], v186 offset:16384
    s_waitcnt lgkmcnt(3)
    v_mfma_f32_32x32x16_bf16 v[36:51], v[160:163], v[16:19], v[36:51]
    ds_read_b128 v[160:163], v187 offset:16384
    s_waitcnt lgkmcnt(3)
    v_mfma_f32_32x32x16_bf16 v[36:51], v[148:151], v[20:23], v[36:51]
    ds_read_b128 v[148:151], v180 offset:24576
    s_waitcnt lgkmcnt(3)
    v_mfma_f32_32x32x16_bf16 v[36:51], v[152:155], v[24:27], v[36:51]
    ds_read_b128 v[152:155], v181 offset:24576
    s_add_u32 m0, s52, 1024
    s_nop 0
    buffer_load_dwordx4 v197, s[12:15], s47 offen lds
    s_waitcnt lgkmcnt(3)
    v_mfma_f32_32x32x16_bf16 v[36:51], v[156:159], v[28:31], v[36:51]
    ds_read_b128 v[156:159], v182 offset:24576
    s_waitcnt lgkmcnt(3)
    v_mfma_f32_32x32x16_bf16 v[36:51], v[160:163], v[32:35], v[36:51]
    ds_read_b128 v[160:163], v183 offset:24576
    s_waitcnt lgkmcnt(3)
    v_mfma_f32_32x32x16_bf16 v[52:67], v[148:151], v[4:7], 0
    ds_read_b128 v[148:151], v184 offset:24576
    s_waitcnt lgkmcnt(3)
    v_mfma_f32_32x32x16_bf16 v[52:67], v[152:155], v[8:11], v[52:67]
    ds_read_b128 v[152:155], v185 offset:24576
    s_add_u32 m0, s52, 2048
    s_nop 0
    buffer_load_dwordx4 v198, s[12:15], s47 offen lds
    s_waitcnt lgkmcnt(3)
    v_mfma_f32_32x32x16_bf16 v[52:67], v[156:159], v[12:15], v[52:67]
    ds_read_b128 v[156:159], v186 offset:24576
    s_waitcnt lgkmcnt(3)
    v_mfma_f32_32x32x16_bf16 v[52:67], v[160:163], v[16:19], v[52:67]
    ds_read_b128 v[160:163], v187 offset:24576
    s_waitcnt lgkmcnt(3)
    v_mfma_f32_32x32x16_bf16 v[52:67], v[148:151], v[20:23], v[52:67]
    ds_read_b64_tr_b16 v[164:165], v188 offset:32768
    ds_read_b64_tr_b16 v[166:167], v188 offset:34816
    s_waitcnt lgkmcnt(4)
    v_mfma_f32_32x32x16_bf16 v[52:67], v[152:155], v[24:27], v[52:67]
    ds_read_b64_tr_b16 v[168:169], v188 offset:36864
    ds_read_b64_tr_b16 v[170:171], v188 offset:38912
    s_add_u32 m0, s52, 3072
    s_nop 0
    buffer_load_dwordx4 v199, s[12:15], s47 offen lds
    s_add_u32 s47, s47, 16384
    s_cmp_lg_u32 s35, 0
    s_cbranch_scc1 L_attn_kernel_pf2
    buffer_load_dword v220, v219, s[16:19], 0 offen offset:0
    v_add_u32 v219, 4096, v219
L_attn_kernel_pf2:
    s_waitcnt lgkmcnt(5)
    v_mfma_f32_32x32x16_bf16 v[52:67], v[156:159], v[28:31], v[52:67]
    ds_read_b64_tr_b16 v[172:173], v188 offset:40960
    ds_read_b64_tr_b16 v[174:175], v188 offset:43008
    s_waitcnt lgkmcnt(6)
    v_mfma_f32_32x32x16_bf16 v[52:67], v[160:163], v[32:35], v[52:67]
    ds_read_b64_tr_b16 v[176:177], v188 offset:45056
    ds_read_b64_tr_b16 v[178:179], v188 offset:47104
    s_waitcnt lgkmcnt(6)
    v_mfma_f32_32x32x16_bf16 v[68:83], v[164:167], v[132:135], v[68:83]
    ds_read_b64_tr_b16 v[164:165], v189 offset:32768
    ds_read_b64_tr_b16 v[166:167], v189 offset:34816
    v_cvt_pk_bf16_f32 v36, 0, v36
    v_cvt_pk_bf16_f32 v37, 0, v37
    v_cvt_pk_bf16_f32 v38, 0, v38
    v_cvt_pk_bf16_f32 v39, 0, v39
    v_cvt_pk_bf16_f32 v40, 0, v40
    v_cvt_pk_bf16_f32 v41, 0, v41
    v_cvt_pk_bf16_f32 v42, 0, v42
    s_waitcnt lgkmcnt(6)
    v_mfma_f32_32x32x16_bf16 v[68:83], v[168:171], v[136:139], v[68:83]
    ds_read_b64_tr_b16 v[168:169], v189 offset:36864
    ds_read_b64_tr_b16 v[170:171], v189 offset:38912
    v_cvt_pk_bf16_f32 v43, 0, v43
    v_mul_f32 v36, v217, v36
    v_mul_f32 v37, v217, v37
    v_mul_f32 v38, v217, v38
    v_mul_f32 v39, v217, v39
    v_mul_f32 v40, v217, v40
    v_mul_f32 v41, v217, v41
    s_waitcnt lgkmcnt(6)
    v_mfma_f32_32x32x16_bf16 v[68:83], v[172:175], v[140:143], v[68:83]
    ds_read_b64_tr_b16 v[172:173], v189 offset:40960
    ds_read_b64_tr_b16 v[174:175], v189 offset:43008
    v_mul_f32 v42, v217, v42
    v_mul_f32 v43, v217, v43
    v_cvt_pk_bf16_f32 v36, 0, v36
    v_cvt_pk_bf16_f32 v37, 0, v37
    v_cvt_pk_bf16_f32 v38, 0, v38
    v_cvt_pk_bf16_f32 v39, 0, v39
    v_cvt_pk_bf16_f32 v40, 0, v40
    s_waitcnt lgkmcnt(6)
    v_mfma_f32_32x32x16_bf16 v[68:83], v[176:179], v[144:147], v[68:83]
    ds_read_b64_tr_b16 v[176:177], v189 offset:45056
    ds_read_b64_tr_b16 v[178:179], v189 offset:47104
    v_cvt_pk_bf16_f32 v41, 0, v41
    v_cvt_pk_bf16_f32 v42, 0, v42
    v_cvt_pk_bf16_f32 v43, 0, v43
    v_cvt_pk_bf16_f32 v44, 0, v44
    v_cvt_pk_bf16_f32 v45, 0, v45
    v_cvt_pk_bf16_f32 v46, 0, v46
    v_cvt_pk_bf16_f32 v47, 0, v47
    s_waitcnt lgkmcnt(6)
    v_mfma_f32_32x32x16_bf16 v[84:99], v[164:167], v[132:135], v[84:99]
    ds_read_b64_tr_b16 v[164:165], v190 offset:32768
    ds_read_b64_tr_b16 v[166:167], v190 offset:34816
    v_cvt_pk_bf16_f32 v48, 0, v48
    v_cvt_pk_bf16_f32 v49, 0, v49
    v_cvt_pk_bf16_f32 v50, 0, v50
    v_cvt_pk_bf16_f32 v51, 0, v51
    v_mul_f32 v44, v217, v44
    v_mul_f32 v45, v217, v45
    v_mul_f32 v46, v217, v46
    s_waitcnt lgkmcnt(6)
    v_mfma_f32_32x32x16_bf16 v[84:99], v[168:171], v[136:139], v[84:99]
    ds_read_b64_tr_b16 v[168:169], v190 offset:36864
    ds_read_b64_tr_b16 v[170:171], v190 offset:38912
    v_mul_f32 v47, v217, v47
    v_mul_f32 v48, v217, v48
    v_mul_f32 v49, v217, v49
    v_mul_f32 v50, v217, v50
    v_mul_f32 v51, v217, v51
    v_cvt_pk_bf16_f32 v44, 0, v44
    v_cvt_pk_bf16_f32 v45, 0, v45
    s_waitcnt lgkmcnt(6)
    v_mfma_f32_32x32x16_bf16 v[84:99], v[172:175], v[140:143], v[84:99]
    ds_read_b64_tr_b16 v[172:173], v190 offset:40960
    ds_read_b64_tr_b16 v[174:175], v190 offset:43008
    v_cvt_pk_bf16_f32 v46, 0, v46
    v_cvt_pk_bf16_f32 v47, 0, v47
    v_cvt_pk_bf16_f32 v48, 0, v48
    v_cvt_pk_bf16_f32 v49, 0, v49
    v_cvt_pk_bf16_f32 v50, 0, v50
    v_cvt_pk_bf16_f32 v51, 0, v51
    v_cvt_pk_bf16_f32 v52, 0, v52
    s_waitcnt lgkmcnt(6)
    v_mfma_f32_32x32x16_bf16 v[84:99], v[176:179], v[144:147], v[84:99]
    ds_read_b64_tr_b16 v[176:177], v190 offset:45056
    ds_read_b64_tr_b16 v[178:179], v190 offset:47104
    v_cvt_pk_bf16_f32 v53, 0, v53
    v_cvt_pk_bf16_f32 v54, 0, v54
    v_cvt_pk_bf16_f32 v55, 0, v55
    v_cvt_pk_bf16_f32 v56, 0, v56
    v_cvt_pk_bf16_f32 v57, 0, v57
    v_cvt_pk_bf16_f32 v58, 0, v58
    v_cvt_pk_bf16_f32 v59, 0, v59
    s_waitcnt lgkmcnt(6)
    v_mfma_f32_32x32x16_bf16 v[100:115], v[164:167], v[132:135], v[100:115]
    ds_read_b64_tr_b16 v[164:165], v191 offset:32768
    ds_read_b64_tr_b16 v[166:167], v191 offset:34816
    v_mul_f32 v52, v217, v52
    v_mul_f32 v53, v217, v53
    v_mul_f32 v54, v217, v54
    v_mul_f32 v55, v217, v55
    v_mul_f32 v56, v217, v56
    v_mul_f32 v57, v217, v57
    v_mul_f32 v58, v217, v58
    s_waitcnt lgkmcnt(6)
    v_mfma_f32_32x32x16_bf16 v[100:115], v[168:171], v[136:139], v[100:115]
    ds_read_b64_tr_b16 v[168:169], v191 offset:36864
    ds_read_b64_tr_b16 v[170:171], v191 offset:38912
    v_mul_f32 v59, v217, v59
    v_cvt_pk_bf16_f32 v52, 0, v52
    v_cvt_pk_bf16_f32 v53, 0, v53
    v_cvt_pk_bf16_f32 v54, 0, v54
    v_cvt_pk_bf16_f32 v55, 0, v55
    v_cvt_pk_bf16_f32 v56, 0, v56
    v_cvt_pk_bf16_f32 v57, 0, v57
    s_waitcnt lgkmcnt(6)
    v_mfma_f32_32x32x16_bf16 v[100:115], v[172:175], v[140:143], v[100:115]
    ds_read_b64_tr_b16 v[172:173], v191 offset:40960
    ds_read_b64_tr_b16 v[174:175], v191 offset:43008
    v_cvt_pk_bf16_f32 v58, 0, v58
    v_cvt_pk_bf16_f32 v59, 0, v59
    v_cvt_pk_bf16_f32 v60, 0, v60
    v_cvt_pk_bf16_f32 v61, 0, v61
    v_cvt_pk_bf16_f32 v62, 0, v62
    v_cvt_pk_bf16_f32 v63, 0, v63
    v_cvt_pk_bf16_f32 v64, 0, v64
    s_waitcnt lgkmcnt(6)
    v_mfma_f32_32x32x16_bf16 v[100:115], v[176:179], v[144:147], v[100:115]
    ds_read_b64_tr_b16 v[176:177], v191 offset:45056
    ds_read_b64_tr_b16 v[178:179], v191 offset:47104
    v_cvt_pk_bf16_f32 v65, 0, v65
    v_cvt_pk_bf16_f32 v66, 0, v66
    v_cvt_pk_bf16_f32 v67, 0, v67
    v_mul_f32 v60, v217, v60
    v_mul_f32 v61, v217, v61
    v_mul_f32 v62, v217, v62
    v_mul_f32 v63, v217, v63
    s_waitcnt lgkmcnt(6)
    v_mfma_f32_32x32x16_bf16 v[116:131], v[164:167], v[132:135], v[116:131]
    v_mul_f32 v64, v217, v64
    v_mul_f32 v65, v217, v65
    v_mul_f32 v66, v217, v66
    v_mul_f32 v67, v217, v67
    v_cvt_pk_bf16_f32 v60, 0, v60
    v_cvt_pk_bf16_f32 v61, 0, v61
    v_cvt_pk_bf16_f32 v62, 0, v62
    s_waitcnt lgkmcnt(4)
    v_mfma_f32_32x32x16_bf16 v[116:131], v[168:171], v[136:139], v[116:131]
    v_cvt_pk_bf16_f32 v63, 0, v63
    v_cvt_pk_bf16_f32 v64, 0, v64
    v_cvt_pk_bf16_f32 v65, 0, v65
    v_cvt_pk_bf16_f32 v66, 0, v66
    v_cvt_pk_bf16_f32 v67, 0, v67
    v_max3_f32 v204, v36, v37, v38
    v_max3_f32 v205, v44, v45, v46
    s_waitcnt lgkmcnt(2)
    v_mfma_f32_32x32x16_bf16 v[116:131], v[172:175], v[140:143], v[116:131]
    v_max3_f32 v206, v52, v53, v54
    v_max3_f32 v207, v60, v61, v62
    v_max3_f32 v204, v204, v39, v40
    v_max3_f32 v205, v205, v47, v48
    v_max3_f32 v206, v206, v55, v56
    v_max3_f32 v207, v207, v63, v64
    v_max3_f32 v204, v204, v41, v42
    s_waitcnt lgkmcnt(0)
    v_mfma_f32_32x32x16_bf16 v[116:131], v[176:179], v[144:147], v[116:131]
    v_max3_f32 v205, v205, v49, v50
    v_max3_f32 v206, v206, v57, v58
    v_max3_f32 v207, v207, v65, v66
    v_max3_f32 v204, v204, v43, v51
    v_max3_f32 v206, v206, v59, v67
    v_max3_f32 v204, v204, v205, v206
    v_max_f32 v204, v204, v207
    s_setprio 0
    s_barrier
    v_mov_b32 v205, v204
    s_nop 1
    v_permlane32_swap_b32 v204, v205
    v_max_f32 v204, v204, v205
    v_sub_f32 v205, v204, v200
    v_cmp_lt_f32 vcc, v218, v205
    s_cbranch_vccz L_attn_kernel_nr3
    v_max_f32 v204, v204, v200
    v_mul_f32 v203, v216, v204
    v_fma_f32 v205, v200, v216, -v203
    v_exp_f32 v202, v205
    v_mov_b32 v200, v204
    v_mul_f32 v201, v202, v201
    v_mul_f32 v68, v202, v68
    v_mul_f32 v69, v202, v69
    v_mul_f32 v70, v202, v70
    v_mul_f32 v71, v202, v71
    v_mul_f32 v72, v202, v72
    v_mul_f32 v73, v202, v73
    v_mul_f32 v74, v202, v74
    v_mul_f32 v75, v202, v75
    v_mul_f32 v76, v202, v76
    v_mul_f32 v77, v202, v77
    v_mul_f32 v78, v202, v78
    v_mul_f32 v79, v202, v79
    v_mul_f32 v80, v202, v80
    v_mul_f32 v81, v202, v81
    v_mul_f32 v82, v202, v82
    v_mul_f32 v83, v202, v83
    v_mul_f32 v84, v202, v84
    v_mul_f32 v85, v202, v85
    v_mul_f32 v86, v202, v86
    v_mul_f32 v87, v202, v87
    v_mul_f32 v88, v202, v88
    v_mul_f32 v89, v202, v89
    v_mul_f32 v90, v202, v90
    v_mul_f32 v91, v202, v91
    v_mul_f32 v92, v202, v92
    v_mul_f32 v93, v202, v93
    v_mul_f32 v94, v202, v94
    v_mul_f32 v95, v202, v95
    v_mul_f32 v96, v202, v96
    v_mul_f32 v97, v202, v97
    v_mul_f32 v98, v202, v98
    v_mul_f32 v99, v202, v99
    v_mul_f32 v100, v202, v100
    v_mul_f32 v101, v202, v101
    v_mul_f32 v102, v202, v102
    v_mul_f32 v103, v202, v103
    v_mul_f32 v104, v202, v104
    v_mul_f32 v105, v202, v105
    v_mul_f32 v106, v202, v106
    v_mul_f32 v107, v202, v107
    v_mul_f32 v108, v202, v108
    v_mul_f32 v109, v202, v109
    v_mul_f32 v110, v202, v110
    v_mul_f32 v111, v202, v111
    v_mul_f32 v112, v202, v112
    v_mul_f32 v113, v202, v113
    v_mul_f32 v114, v202, v114
    v_mul_f32 v115, v202, v115
    v_mul_f32 v116, v202, v116
    v_mul_f32 v117, v202, v117
    v_mul_f32 v118, v202, v118
    v_mul_f32 v119, v202, v119
    v_mul_f32 v120, v202, v120
    v_mul_f32 v121, v202, v121
    v_mul_f32 v122, v202, v122
    v_mul_f32 v123, v202, v123
    v_mul_f32 v124, v202, v124
    v_mul_f32 v125, v202, v125
    v_mul_f32 v126, v202, v126
    v_mul_f32 v127, v202, v127
    v_mul_f32 v128, v202, v128
    v_mul_f32 v129, v202, v129
    v_mul_f32 v130, v202, v130
    v_mul_f32 v131, v202, v131
L_attn_kernel_nr3:
    v_fma_f32 v36, v36, v216, -v203
    v_fma_f32 v37, v37, v216, -v203
    v_fma_f32 v38, v38, v216, -v203
    v_fma_f32 v39, v39, v216, -v203
    v_fma_f32 v40, v40, v216, -v203
    v_fma_f32 v41, v41, v216, -v203
    v_fma_f32 v42, v42, v216, -v203
    v_fma_f32 v43, v43, v216, -v203
    v_exp_f32 v36, v36
    v_exp_f32 v37, v37
    v_exp_f32 v38, v38
    v_exp_f32 v39, v39
    v_exp_f32 v40, v40
    v_exp_f32 v41, v41
    v_exp_f32 v42, v42
    v_exp_f32 v43, v43
    v_fma_f32 v44, v44, v216, -v203
    v_fma_f32 v45, v45, v216, -v203
    v_fma_f32 v46, v46, v216, -v203
    v_fma_f32 v47, v47, v216, -v203
    v_fma_f32 v48, v48, v216, -v203
    v_fma_f32 v49, v49, v216, -v203
    v_fma_f32 v50, v50, v216, -v203
    v_fma_f32 v51, v51, v216, -v203
    v_exp_f32 v44, v44
    v_exp_f32 v45, v45
    v_exp_f32 v46, v46
    v_exp_f32 v47, v47
    v_exp_f32 v48, v48
    v_exp_f32 v49, v49
    v_exp_f32 v50, v50
    v_exp_f32 v51, v51
    v_mov_b32 v212, v36
    v_mov_b32 v213, v37
    v_mov_b32 v214, v38
    v_mov_b32 v215, v39
    v_add_f32 v212, v212, v40
    v_add_f32 v213, v213, v41
    v_add_f32 v214, v214, v42
    v_add_f32 v215, v215, v43
    v_cvt_pk_bf16_f32 v132, v36, v37
    v_cvt_pk_bf16_f32 v133, v38, v39
    v_cvt_pk_bf16_f32 v134, v40, v41
    v_cvt_pk_bf16_f32 v135, v42, v43
    v_fma_f32 v52, v52, v216, -v203
    v_fma_f32 v53, v53, v216, -v203
    v_fma_f32 v54, v54, v216, -v203
    v_fma_f32 v55, v55, v216, -v203
    v_fma_f32 v56, v56, v216, -v203
    v_fma_f32 v57, v57, v216, -v203
    v_fma_f32 v58, v58, v216, -v203
    v_fma_f32 v59, v59, v216, -v203
    v_exp_f32 v52, v52
    v_exp_f32 v53, v53
    v_exp_f32 v54, v54
    v_exp_f32 v55, v55
    v_exp_f32 v56, v56
    v_exp_f32 v57, v57
    v_exp_f32 v58, v58
    v_exp_f32 v59, v59
    v_add_f32 v212, v212, v44
    v_add_f32 v213, v213, v45
    v_add_f32 v214, v214, v46
    v_add_f32 v215, v215, v47
    v_add_f32 v212, v212, v48
    v_add_f32 v213, v213, v49
    v_add_f32 v214, v214, v50
    v_add_f32 v215, v215, v51
    v_cvt_pk_bf16_f32 v136, v44, v45
    v_cvt_pk_bf16_f32 v137, v46, v47
    v_cvt_pk_bf16_f32 v138, v48, v49
    v_cvt_pk_bf16_f32 v139, v50, v51
    v_fma_f32 v60, v60, v216, -v203
    v_fma_f32 v61, v61, v216, -v203
    v_fma_f32 v62, v62, v216, -v203
    v_fma_f32 v63, v63, v216, -v203
    v_fma_f32 v64, v64, v216, -v203
    v_fma_f32 v65, v65, v216, -v203
    v_fma_f32 v66, v66, v216, -v203
    v_fma_f32 v67, v67, v216, -v203
    v_exp_f32 v60, v60
    v_exp_f32 v61, v61
    v_exp_f32 v62, v62
    v_exp_f32 v63, v63
    v_exp_f32 v64, v64
    v_exp_f32 v65, v65
    v_exp_f32 v66, v66
    v_exp_f32 v67, v67
    v_add_f32 v212, v212, v52
    v_add_f32 v213, v213, v53
    v_add_f32 v214, v214, v54
    v_add_f32 v215, v215, v55
    v_add_f32 v212, v212, v56
    v_add_f32 v213, v213, v57
    v_add_f32 v214, v214, v58
    v_add_f32 v215, v215, v59
    v_cvt_pk_bf16_f32 v140, v52, v53
    v_cvt_pk_bf16_f32 v141, v54, v55
    v_cvt_pk_bf16_f32 v142, v56, v57
    v_cvt_pk_bf16_f32 v143, v58, v59
    v_add_f32 v212, v212, v60
    v_add_f32 v213, v213, v61
    v_add_f32 v214, v214, v62
    v_add_f32 v215, v215, v63
    v_add_f32 v212, v212, v64
    v_add_f32 v213, v213, v65
    v_add_f32 v214, v214, v66
    v_add_f32 v215, v215, v67
    v_cvt_pk_bf16_f32 v144, v60, v61
    v_cvt_pk_bf16_f32 v145, v62, v63
    v_cvt_pk_bf16_f32 v146, v64, v65
    v_cvt_pk_bf16_f32 v147, v66, v67
    v_add_f32 v212, v212, v213
    v_add_f32 v214, v214, v215
    v_add_f32 v212, v212, v214
    v_add_f32 v201, v201, v212
    ds_read_b128 v[148:151], v180 offset:32768
    ds_read_b128 v[152:155], v181 offset:32768
    ds_read_b128 v[156:159], v182 offset:32768
    ds_read_b128 v[160:163], v183 offset:32768
    s_waitcnt vmcnt(4)
    s_barrier
    s_setprio 3
    s_waitcnt lgkmcnt(3)
    v_mfma_f32_32x32x16_bf16 v[36:51], v[148:151], v[4:7], 0
    ds_read_b128 v[148:151], v184 offset:32768
    s_waitcnt lgkmcnt(3)
    v_mfma_f32_32x32x16_bf16 v[36:51], v[152:155], v[8:11], v[36:51]
    ds_read_b128 v[152:155], v185 offset:32768
    s_add_u32 s52, s46, 16384
    s_add_u32 m0, s52, 0
    s_nop 0
    buffer_load_dwordx4 v196, s[12:15], s47 offen lds
    s_waitcnt lgkmcnt(3)
    v_mfma_f32_32x32x16_bf16 v[36:51], v[156:159], v[12:15], v[36:51]
    ds_read_b128 v[156:159], v186 offset:32768
    s_waitcnt lgkmcnt(3)
    v_mfma_f32_32x32x16_bf16 v[36:51], v[160:163], v[16:19], v[36:51]
    ds_read_b128 v[160:163], v187 offset:32768
    s_waitcnt lgkmcnt(3)
    v_mfma_f32_32x32x16_bf16 v[36:51], v[148:151], v[20:23], v[36:51]
    ds_read_b128 v[148:151], v180 offset:40960
    s_waitcnt lgkmcnt(3)
    v_mfma_f32_32x32x16_bf16 v[36:51], v[152:155], v[24:27], v[36:51]
    ds_read_b128 v[152:155], v181 offset:40960
    s_add_u32 m0, s52, 1024
    s_nop 0
    buffer_load_dwordx4 v197, s[12:15], s47 offen lds
    s_waitcnt lgkmcnt(3)
    v_mfma_f32_32x32x16_bf16 v[36:51], v[156:159], v[28:31], v[36:51]
    ds_read_b128 v[156:159], v182 offset:40960
    s_waitcnt lgkmcnt(3)
    v_mfma_f32_32x32x16_bf16 v[36:51], v[160:163], v[32:35], v[36:51]
    ds_read_b128 v[160:163], v183 offset:40960
    s_waitcnt lgkmcnt(3)
    v_mfma_f32_32x32x16_bf16 v[52:67], v[148:151], v[4:7], 0
    ds_read_b128 v[148:151], v184 offset:40960
    s_waitcnt lgkmcnt(3)
    v_mfma_f32_32x32x16_bf16 v[52:67], v[152:155], v[8:11], v[52:67]
    ds_read_b128 v[152:155], v185 offset:40960
    s_add_u32 m0, s52, 2048
    s_nop 0
    buffer_load_dwordx4 v198, s[12:15], s47 offen lds
    s_waitcnt lgkmcnt(3)
    v_mfma_f32_32x32x16_bf16 v[52:67], v[156:159], v[12:15], v[52:67]
    ds_read_b128 v[156:159], v186 offset:40960
    s_waitcnt lgkmcnt(3)
    v_mfma_f32_32x32x16_bf16 v[52:67], v[160:163], v[16:19], v[52:67]
    ds_read_b128 v[160:163], v187 offset:40960
    s_waitcnt lgkmcnt(3)
    v_mfma_f32_32x32x16_bf16 v[52:67], v[148:151], v[20:23], v[52:67]
    ds_read_b64_tr_b16 v[164:165], v188 offset:49152
    ds_read_b64_tr_b16 v[166:167], v188 offset:51200
    s_waitcnt lgkmcnt(4)
    v_mfma_f32_32x32x16_bf16 v[52:67], v[152:155], v[24:27], v[52:67]
    ds_read_b64_tr_b16 v[168:169], v188 offset:53248
    ds_read_b64_tr_b16 v[170:171], v188 offset:55296
    s_add_u32 m0, s52, 3072
    s_nop 0
    buffer_load_dwordx4 v199, s[12:15], s47 offen lds
    s_add_u32 s47, s47, 16384
    s_cmp_lg_u32 s35, 0
    s_cbranch_scc1 L_attn_kernel_pf3
    buffer_load_dword v220, v219, s[16:19], 0 offen offset:0
    v_add_u32 v219, 4096, v219
L_attn_kernel_pf3:
    s_waitcnt lgkmcnt(5)
    v_mfma_f32_32x32x16_bf16 v[52:67], v[156:159], v[28:31], v[52:67]
    ds_read_b64_tr_b16 v[172:173], v188 offset:57344
    ds_read_b64_tr_b16 v[174:175], v188 offset:59392
    s_waitcnt lgkmcnt(6)
    v_mfma_f32_32x32x16_bf16 v[52:67], v[160:163], v[32:35], v[52:67]
    ds_read_b64_tr_b16 v[176:177], v188 offset:61440
    ds_read_b64_tr_b16 v[178:179], v188 offset:63488
    s_waitcnt lgkmcnt(6)
    v_mfma_f32_32x32x16_bf16 v[68:83], v[164:167], v[132:135], v[68:83]
    ds_read_b64_tr_b16 v[164:165], v189 offset:49152
    ds_read_b64_tr_b16 v[166:167], v189 offset:51200
    v_cvt_pk_bf16_f32 v36, 0, v36
    v_cvt_pk_bf16_f32 v37, 0, v37
    v_cvt_pk_bf16_f32 v38, 0, v38
    v_cvt_pk_bf16_f32 v39, 0, v39
    v_cvt_pk_bf16_f32 v40, 0, v40
    v_cvt_pk_bf16_f32 v41, 0, v41
    v_cvt_pk_bf16_f32 v42, 0, v42
    s_waitcnt lgkmcnt(6)
    v_mfma_f32_32x32x16_bf16 v[68:83], v[168:171], v[136:139], v[68:83]
    ds_read_b64_tr_b16 v[168:169], v189 offset:53248
    ds_read_b64_tr_b16 v[170:171], v189 offset:55296
    v_cvt_pk_bf16_f32 v43, 0, v43
    v_mul_f32 v36, v217, v36
    v_mul_f32 v37, v217, v37
    v_mul_f32 v38, v217, v38
    v_mul_f32 v39, v217, v39
    v_mul_f32 v40, v217, v40
    v_mul_f32 v41, v217, v41
    s_waitcnt lgkmcnt(6)
    v_mfma_f32_32x32x16_bf16 v[68:83], v[172:175], v[140:143], v[68:83]
    ds_read_b64_tr_b16 v[172:173], v189 offset:57344
    ds_read_b64_tr_b16 v[174:175], v189 offset:59392
    v_mul_f32 v42, v217, v42
    v_mul_f32 v43, v217, v43
    v_cvt_pk_bf16_f32 v36, 0, v36
    v_cvt_pk_bf16_f32 v37, 0, v37
    v_cvt_pk_bf16_f32 v38, 0, v38
    v_cvt_pk_bf16_f32 v39, 0, v39
    v_cvt_pk_bf16_f32 v40, 0, v40
    s_waitcnt lgkmcnt(6)
    v_mfma_f32_32x32x16_bf16 v[68:83], v[176:179], v[144:147], v[68:83]
    ds_read_b64_tr_b16 v[176:177], v189 offset:61440
    ds_read_b64_tr_b16 v[178:179], v189 offset:63488
    v_cvt_pk_bf16_f32 v41, 0, v41
    v_cvt_pk_bf16_f32 v42, 0, v42
    v_cvt_pk_bf16_f32 v43, 0, v43
    v_cvt_pk_bf16_f32 v44, 0, v44
    v_cvt_pk_bf16_f32 v45, 0, v45
    v_cvt_pk_bf16_f32 v46, 0, v46
    v_cvt_pk_bf16_f32 v47, 0, v47
    s_waitcnt lgkmcnt(6)
    v_mfma_f32_32x32x16_bf16 v[84:99], v[164:167], v[132:135], v[84:99]
    ds_read_b64_tr_b16 v[164:165], v190 offset:49152
    ds_read_b64_tr_b16 v[166:167], v190 offset:51200
    v_cvt_pk_bf16_f32 v48, 0, v48
    v_cvt_pk_bf16_f32 v49, 0, v49
    v_cvt_pk_bf16_f32 v50, 0, v50
    v_cvt_pk_bf16_f32 v51, 0, v51
    v_mul_f32 v44, v217, v44
    v_mul_f32 v45, v217, v45
    v_mul_f32 v46, v217, v46
    s_waitcnt lgkmcnt(6)
    v_mfma_f32_32x32x16_bf16 v[84:99], v[168:171], v[136:139], v[84:99]
    ds_read_b64_tr_b16 v[168:169], v190 offset:53248
    ds_read_b64_tr_b16 v[170:171], v190 offset:55296
    v_mul_f32 v47, v217, v47
    v_mul_f32 v48, v217, v48
    v_mul_f32 v49, v217, v49
    v_mul_f32 v50, v217, v50
    v_mul_f32 v51, v217, v51
    v_cvt_pk_bf16_f32 v44, 0, v44
    v_cvt_pk_bf16_f32 v45, 0, v45
    s_waitcnt lgkmcnt(6)
    v_mfma_f32_32x32x16_bf16 v[84:99], v[172:175], v[140:143], v[84:99]
    ds_read_b64_tr_b16 v[172:173], v190 offset:57344
    ds_read_b64_tr_b16 v[174:175], v190 offset:59392
    v_cvt_pk_bf16_f32 v46, 0, v46
    v_cvt_pk_bf16_f32 v47, 0, v47
    v_cvt_pk_bf16_f32 v48, 0, v48
    v_cvt_pk_bf16_f32 v49, 0, v49
    v_cvt_pk_bf16_f32 v50, 0, v50
    v_cvt_pk_bf16_f32 v51, 0, v51
    v_cvt_pk_bf16_f32 v52, 0, v52
    s_waitcnt lgkmcnt(6)
    v_mfma_f32_32x32x16_bf16 v[84:99], v[176:179], v[144:147], v[84:99]
    ds_read_b64_tr_b16 v[176:177], v190 offset:61440
    ds_read_b64_tr_b16 v[178:179], v190 offset:63488
    v_cvt_pk_bf16_f32 v53, 0, v53
    v_cvt_pk_bf16_f32 v54, 0, v54
    v_cvt_pk_bf16_f32 v55, 0, v55
    v_cvt_pk_bf16_f32 v56, 0, v56
    v_cvt_pk_bf16_f32 v57, 0, v57
    v_cvt_pk_bf16_f32 v58, 0, v58
    v_cvt_pk_bf16_f32 v59, 0, v59
    s_waitcnt lgkmcnt(6)
    v_mfma_f32_32x32x16_bf16 v[100:115], v[164:167], v[132:135], v[100:115]
    ds_read_b64_tr_b16 v[164:165], v191 offset:49152
    ds_read_b64_tr_b16 v[166:167], v191 offset:51200
    v_mul_f32 v52, v217, v52
    v_mul_f32 v53, v217, v53
    v_mul_f32 v54, v217, v54
    v_mul_f32 v55, v217, v55
    v_mul_f32 v56, v217, v56
    v_mul_f32 v57, v217, v57
    v_mul_f32 v58, v217, v58
    s_waitcnt lgkmcnt(6)
    v_mfma_f32_32x32x16_bf16 v[100:115], v[168:171], v[136:139], v[100:115]
    ds_read_b64_tr_b16 v[168:169], v191 offset:53248
    ds_read_b64_tr_b16 v[170:171], v191 offset:55296
    v_mul_f32 v59, v217, v59
    v_cvt_pk_bf16_f32 v52, 0, v52
    v_cvt_pk_bf16_f32 v53, 0, v53
    v_cvt_pk_bf16_f32 v54, 0, v54
    v_cvt_pk_bf16_f32 v55, 0, v55
    v_cvt_pk_bf16_f32 v56, 0, v56
    v_cvt_pk_bf16_f32 v57, 0, v57
    s_waitcnt lgkmcnt(6)
    v_mfma_f32_32x32x16_bf16 v[100:115], v[172:175], v[140:143], v[100:115]
    ds_read_b64_tr_b16 v[172:173], v191 offset:57344
    ds_read_b64_tr_b16 v[174:175], v191 offset:59392
    v_cvt_pk_bf16_f32 v58, 0, v58
    v_cvt_pk_bf16_f32 v59, 0, v59
    v_cvt_pk_bf16_f32 v60, 0, v60
    v_cvt_pk_bf16_f32 v61, 0, v61
    v_cvt_pk_bf16_f32 v62, 0, v62
    v_cvt_pk_bf16_f32 v63, 0, v63
    v_cvt_pk_bf16_f32 v64, 0, v64
    s_waitcnt lgkmcnt(6)
    v_mfma_f32_32x32x16_bf16 v[100:115], v[176:179], v[144:147], v[100:115]
    ds_read_b64_tr_b16 v[176:177], v191 offset:61440
    ds_read_b64_tr_b16 v[178:179], v191 offset:63488
    v_cvt_pk_bf16_f32 v65, 0, v65
    v_cvt_pk_bf16_f32 v66, 0, v66
    v_cvt_pk_bf16_f32 v67, 0, v67
    v_mul_f32 v60, v217, v60
    v_mul_f32 v61, v217, v61
    v_mul_f32 v62, v217, v62
    v_mul_f32 v63, v217, v63
    s_waitcnt lgkmcnt(6)
    v_mfma_f32_32x32x16_bf16 v[116:131], v[164:167], v[132:135], v[116:131]
    v_mul_f32 v64, v217, v64
    v_mul_f32 v65, v217, v65
    v_mul_f32 v66, v217, v66
    v_mul_f32 v67, v217, v67
    v_cvt_pk_bf16_f32 v60, 0, v60
    v_cvt_pk_bf16_f32 v61, 0, v61
    v_cvt_pk_bf16_f32 v62, 0, v62
    s_waitcnt lgkmcnt(4)
    v_mfma_f32_32x32x16_bf16 v[116:131], v[168:171], v[136:139], v[116:131]
    v_cvt_pk_bf16_f32 v63, 0, v63
    v_cvt_pk_bf16_f32 v64, 0, v64
    v_cvt_pk_bf16_f32 v65, 0, v65
    v_cvt_pk_bf16_f32 v66, 0, v66
    v_cvt_pk_bf16_f32 v67, 0, v67
    v_max3_f32 v204, v36, v37, v38
    v_max3_f32 v205, v44, v45, v46
    s_waitcnt lgkmcnt(2)
    v_mfma_f32_32x32x16_bf16 v[116:131], v[172:175], v[140:143], v[116:131]
    v_max3_f32 v206, v52, v53, v54
    v_max3_f32 v207, v60, v61, v62
    v_max3_f32 v204, v204, v39, v40
    v_max3_f32 v205, v205, v47, v48
    v_max3_f32 v206, v206, v55, v56
    v_max3_f32 v207, v207, v63, v64
    v_max3_f32 v204, v204, v41, v42
    s_waitcnt lgkmcnt(0)
    v_mfma_f32_32x32x16_bf16 v[116:131], v[176:179], v[144:147], v[116:131]
    v_max3_f32 v205, v205, v49, v50
    v_max3_f32 v206, v206, v57, v58
    v_max3_f32 v207, v207, v65, v66
    v_max3_f32 v204, v204, v43, v51
    v_max3_f32 v206, v206, v59, v67
    v_max3_f32 v204, v204, v205, v206
    v_max_f32 v204, v204, v207
    s_setprio 0
    s_barrier
    v_mov_b32 v205, v204
    s_nop 1
    v_permlane32_swap_b32 v204, v205
    v_max_f32 v204, v204, v205
    v_sub_f32 v205, v204, v200
    v_cmp_lt_f32 vcc, v218, v205
    s_cbranch_vccz L_attn_kernel_nr4
    v_max_f32 v204, v204, v200
    v_mul_f32 v203, v216, v204
    v_fma_f32 v205, v200, v216, -v203
    v_exp_f32 v202, v205
    v_mov_b32 v200, v204
    v_mul_f32 v201, v202, v201
    v_mul_f32 v68, v202, v68
    v_mul_f32 v69, v202, v69
    v_mul_f32 v70, v202, v70
    v_mul_f32 v71, v202, v71
    v_mul_f32 v72, v202, v72
    v_mul_f32 v73, v202, v73
    v_mul_f32 v74, v202, v74
    v_mul_f32 v75, v202, v75
    v_mul_f32 v76, v202, v76
    v_mul_f32 v77, v202, v77
    v_mul_f32 v78, v202, v78
    v_mul_f32 v79, v202, v79
    v_mul_f32 v80, v202, v80
    v_mul_f32 v81, v202, v81
    v_mul_f32 v82, v202, v82
    v_mul_f32 v83, v202, v83
    v_mul_f32 v84, v202, v84
    v_mul_f32 v85, v202, v85
    v_mul_f32 v86, v202, v86
    v_mul_f32 v87, v202, v87
    v_mul_f32 v88, v202, v88
    v_mul_f32 v89, v202, v89
    v_mul_f32 v90, v202, v90
    v_mul_f32 v91, v202, v91
    v_mul_f32 v92, v202, v92
    v_mul_f32 v93, v202, v93
    v_mul_f32 v94, v202, v94
    v_mul_f32 v95, v202, v95
    v_mul_f32 v96, v202, v96
    v_mul_f32 v97, v202, v97
    v_mul_f32 v98, v202, v98
    v_mul_f32 v99, v202, v99
    v_mul_f32 v100, v202, v100
    v_mul_f32 v101, v202, v101
    v_mul_f32 v102, v202, v102
    v_mul_f32 v103, v202, v103
    v_mul_f32 v104, v202, v104
    v_mul_f32 v105, v202, v105
    v_mul_f32 v106, v202, v106
    v_mul_f32 v107, v202, v107
    v_mul_f32 v108, v202, v108
    v_mul_f32 v109, v202, v109
    v_mul_f32 v110, v202, v110
    v_mul_f32 v111, v202, v111
    v_mul_f32 v112, v202, v112
    v_mul_f32 v113, v202, v113
    v_mul_f32 v114, v202, v114
    v_mul_f32 v115, v202, v115
    v_mul_f32 v116, v202, v116
    v_mul_f32 v117, v202, v117
    v_mul_f32 v118, v202, v118
    v_mul_f32 v119, v202, v119
    v_mul_f32 v120, v202, v120
    v_mul_f32 v121, v202, v121
    v_mul_f32 v122, v202, v122
    v_mul_f32 v123, v202, v123
    v_mul_f32 v124, v202, v124
    v_mul_f32 v125, v202, v125
    v_mul_f32 v126, v202, v126
    v_mul_f32 v127, v202, v127
    v_mul_f32 v128, v202, v128
    v_mul_f32 v129, v202, v129
    v_mul_f32 v130, v202, v130
    v_mul_f32 v131, v202, v131
L_attn_kernel_nr4:
    v_fma_f32 v36, v36, v216, -v203
    v_fma_f32 v37, v37, v216, -v203
    v_fma_f32 v38, v38, v216, -v203
    v_fma_f32 v39, v39, v216, -v203
    v_fma_f32 v40, v40, v216, -v203
    v_fma_f32 v41, v41, v216, -v203
    v_fma_f32 v42, v42, v216, -v203
    v_fma_f32 v43, v43, v216, -v203
    v_exp_f32 v36, v36
    v_exp_f32 v37, v37
    v_exp_f32 v38, v38
    v_exp_f32 v39, v39
    v_exp_f32 v40, v40
    v_exp_f32 v41, v41
    v_exp_f32 v42, v42
    v_exp_f32 v43, v43
    v_fma_f32 v44, v44, v216, -v203
    v_fma_f32 v45, v45, v216, -v203
    v_fma_f32 v46, v46, v216, -v203
    v_fma_f32 v47, v47, v216, -v203
    v_fma_f32 v48, v48, v216, -v203
    v_fma_f32 v49, v49, v216, -v203
    v_fma_f32 v50, v50, v216, -v203
    v_fma_f32 v51, v51, v216, -v203
    v_exp_f32 v44, v44
    v_exp_f32 v45, v45
    v_exp_f32 v46, v46
    v_exp_f32 v47, v47
    v_exp_f32 v48, v48
    v_exp_f32 v49, v49
    v_exp_f32 v50, v50
    v_exp_f32 v51, v51
    v_mov_b32 v212, v36
    v_mov_b32 v213, v37
    v_mov_b32 v214, v38
    v_mov_b32 v215, v39
    v_add_f32 v212, v212, v40
    v_add_f32 v213, v213, v41
    v_add_f32 v214, v214, v42
    v_add_f32 v215, v215, v43
    v_cvt_pk_bf16_f32 v132, v36, v37
    v_cvt_pk_bf16_f32 v133, v38, v39
    v_cvt_pk_bf16_f32 v134, v40, v41
    v_cvt_pk_bf16_f32 v135, v42, v43
    v_fma_f32 v52, v52, v216, -v203
    v_fma_f32 v53, v53, v216, -v203
    v_fma_f32 v54, v54, v216, -v203
    v_fma_f32 v55, v55, v216, -v203
    v_fma_f32 v56, v56, v216, -v203
    v_fma_f32 v57, v57, v216, -v203
    v_fma_f32 v58, v58, v216, -v203
    v_fma_f32 v59, v59, v216, -v203
    v_exp_f32 v52, v52
    v_exp_f32 v53, v53
    v_exp_f32 v54, v54
    v_exp_f32 v55, v55
    v_exp_f32 v56, v56
    v_exp_f32 v57, v57
    v_exp_f32 v58, v58
    v_exp_f32 v59, v59
    v_add_f32 v212, v212, v44
    v_add_f32 v213, v213, v45
    v_add_f32 v214, v214, v46
    v_add_f32 v215, v215, v47
    v_add_f32 v212, v212, v48
    v_add_f32 v213, v213, v49
    v_add_f32 v214, v214, v50
    v_add_f32 v215, v215, v51
    v_cvt_pk_bf16_f32 v136, v44, v45
    v_cvt_pk_bf16_f32 v137, v46, v47
    v_cvt_pk_bf16_f32 v138, v48, v49
    v_cvt_pk_bf16_f32 v139, v50, v51
    v_fma_f32 v60, v60, v216, -v203
    v_fma_f32 v61, v61, v216, -v203
    v_fma_f32 v62, v62, v216, -v203
    v_fma_f32 v63, v63, v216, -v203
    v_fma_f32 v64, v64, v216, -v203
    v_fma_f32 v65, v65, v216, -v203
    v_fma_f32 v66, v66, v216, -v203
    v_fma_f32 v67, v67, v216, -v203
    v_exp_f32 v60, v60
    v_exp_f32 v61, v61
    v_exp_f32 v62, v62
    v_exp_f32 v63, v63
    v_exp_f32 v64, v64
    v_exp_f32 v65, v65
    v_exp_f32 v66, v66
    v_exp_f32 v67, v67
    v_add_f32 v212, v212, v52
    v_add_f32 v213, v213, v53
    v_add_f32 v214, v214, v54
    v_add_f32 v215, v215, v55
    v_add_f32 v212, v212, v56
    v_add_f32 v213, v213, v57
    v_add_f32 v214, v214, v58
    v_add_f32 v215, v215, v59
    v_cvt_pk_bf16_f32 v140, v52, v53
    v_cvt_pk_bf16_f32 v141, v54, v55
    v_cvt_pk_bf16_f32 v142, v56, v57
    v_cvt_pk_bf16_f32 v143, v58, v59
    v_add_f32 v212, v212, v60
    v_add_f32 v213, v213, v61
    v_add_f32 v214, v214, v62
    v_add_f32 v215, v215, v63
    v_add_f32 v212, v212, v64
    v_add_f32 v213, v213, v65
    v_add_f32 v214, v214, v66
    v_add_f32 v215, v215, v67
    v_cvt_pk_bf16_f32 v144, v60, v61
    v_cvt_pk_bf16_f32 v145, v62, v63
    v_cvt_pk_bf16_f32 v146, v64, v65
    v_cvt_pk_bf16_f32 v147, v66, v67
    v_add_f32 v212, v212, v213
    v_add_f32 v214, v214, v215
    v_add_f32 v212, v212, v214
    v_add_f32 v201, v201, v212
    ds_read_b128 v[148:151], v180 offset:49152
    ds_read_b128 v[152:155], v181 offset:49152
    ds_read_b128 v[156:159], v182 offset:49152
    ds_read_b128 v[160:163], v183 offset:49152
    s_waitcnt vmcnt(4)
    s_barrier
    s_setprio 3
    s_waitcnt lgkmcnt(3)
    v_mfma_f32_32x32x16_bf16 v[36:51], v[148:151], v[4:7], 0
    ds_read_b128 v[148:151], v184 offset:49152
    s_waitcnt lgkmcnt(3)
    v_mfma_f32_32x32x16_bf16 v[36:51], v[152:155], v[8:11], v[36:51]
    ds_read_b128 v[152:155], v185 offset:49152
    s_add_u32 s52, s46, 32768
    s_add_u32 m0, s52, 0
    s_nop 0
    buffer_load_dwordx4 v196, s[12:15], s47 offen lds
    s_waitcnt lgkmcnt(3)
    v_mfma_f32_32x32x16_bf16 v[36:51], v[156:159], v[12:15], v[36:51]
    ds_read_b128 v[156:159], v186 offset:49152
    s_waitcnt lgkmcnt(3)
    v_mfma_f32_32x32x16_bf16 v[36:51], v[160:163], v[16:19], v[36:51]
    ds_read_b128 v[160:163], v187 offset:49152
    s_waitcnt lgkmcnt(3)
    v_mfma_f32_32x32x16_bf16 v[36:51], v[148:151], v[20:23], v[36:51]
    ds_read_b128 v[148:151], v180 offset:57344
    s_waitcnt lgkmcnt(3)
    v_mfma_f32_32x32x16_bf16 v[36:51], v[152:155], v[24:27], v[36:51]
    ds_read_b128 v[152:155], v181 offset:57344
    s_add_u32 m0, s52, 1024
    s_nop 0
    buffer_load_dwordx4 v197, s[12:15], s47 offen lds
    s_waitcnt lgkmcnt(3)
    v_mfma_f32_32x32x16_bf16 v[36:51], v[156:159], v[28:31], v[36:51]
    ds_read_b128 v[156:159], v182 offset:57344
    s_waitcnt lgkmcnt(3)
    v_mfma_f32_32x32x16_bf16 v[36:51], v[160:163], v[32:35], v[36:51]
    ds_read_b128 v[160:163], v183 offset:57344
    s_waitcnt lgkmcnt(3)
    v_mfma_f32_32x32x16_bf16 v[52:67], v[148:151], v[4:7], 0
    ds_read_b128 v[148:151], v184 offset:57344
    s_waitcnt lgkmcnt(3)
    v_mfma_f32_32x32x16_bf16 v[52:67], v[152:155], v[8:11], v[52:67]
    ds_read_b128 v[152:155], v185 offset:57344
    s_add_u32 m0, s52, 2048
    s_nop 0
    buffer_load_dwordx4 v198, s[12:15], s47 offen lds
    s_waitcnt lgkmcnt(3)
    v_mfma_f32_32x32x16_bf16 v[52:67], v[156:159], v[12:15], v[52:67]
    ds_read_b128 v[156:159], v186 offset:57344
    s_waitcnt lgkmcnt(3)
    v_mfma_f32_32x32x16_bf16 v[52:67], v[160:163], v[16:19], v[52:67]
    ds_read_b128 v[160:163], v187 offset:57344
    s_waitcnt lgkmcnt(3)
    v_mfma_f32_32x32x16_bf16 v[52:67], v[148:151], v[20:23], v[52:67]
    ds_read_b64_tr_b16 v[164:165], v188 offset:0
    ds_read_b64_tr_b16 v[166:167], v188 offset:2048
    s_waitcnt lgkmcnt(4)
    v_mfma_f32_32x32x16_bf16 v[52:67], v[152:155], v[24:27], v[52:67]
    ds_read_b64_tr_b16 v[168:169], v188 offset:4096
    ds_read_b64_tr_b16 v[170:171], v188 offset:6144
    s_add_u32 m0, s52, 3072
    s_nop 0
    buffer_load_dwordx4 v199, s[12:15], s47 offen lds
    s_add_u32 s47, s47, 16384
    s_cmp_lg_u32 s35, 0
    s_cbranch_scc1 L_attn_kernel_pf4
    buffer_load_dword v220, v219, s[16:19], 0 offen offset:0
    v_add_u32 v219, 4096, v219
L_attn_kernel_pf4:
    s_waitcnt lgkmcnt(5)
    v_mfma_f32_32x32x16_bf16 v[52:67], v[156:159], v[28:31], v[52:67]
    ds_read_b64_tr_b16 v[172:173], v188 offset:8192
    ds_read_b64_tr_b16 v[174:175], v188 offset:10240
    s_waitcnt lgkmcnt(6)
    v_mfma_f32_32x32x16_bf16 v[52:67], v[160:163], v[32:35], v[52:67]
    ds_read_b64_tr_b16 v[176:177], v188 offset:12288
    ds_read_b64_tr_b16 v[178:179], v188 offset:14336
    s_waitcnt lgkmcnt(6)
    v_mfma_f32_32x32x16_bf16 v[68:83], v[164:167], v[132:135], v[68:83]
    ds_read_b64_tr_b16 v[164:165], v189 offset:0
    ds_read_b64_tr_b16 v[166:167], v189 offset:2048
    v_cvt_pk_bf16_f32 v36, 0, v36
    v_cvt_pk_bf16_f32 v37, 0, v37
    v_cvt_pk_bf16_f32 v38, 0, v38
    v_cvt_pk_bf16_f32 v39, 0, v39
    v_cvt_pk_bf16_f32 v40, 0, v40
    v_cvt_pk_bf16_f32 v41, 0, v41
    v_cvt_pk_bf16_f32 v42, 0, v42
    s_waitcnt lgkmcnt(6)
    v_mfma_f32_32x32x16_bf16 v[68:83], v[168:171], v[136:139], v[68:83]
    ds_read_b64_tr_b16 v[168:169], v189 offset:4096
    ds_read_b64_tr_b16 v[170:171], v189 offset:6144
    v_cvt_pk_bf16_f32 v43, 0, v43
    v_mul_f32 v36, v217, v36
    v_mul_f32 v37, v217, v37
    v_mul_f32 v38, v217, v38
    v_mul_f32 v39, v217, v39
    v_mul_f32 v40, v217, v40
    v_mul_f32 v41, v217, v41
    s_waitcnt lgkmcnt(6)
    v_mfma_f32_32x32x16_bf16 v[68:83], v[172:175], v[140:143], v[68:83]
    ds_read_b64_tr_b16 v[172:173], v189 offset:8192
    ds_read_b64_tr_b16 v[174:175], v189 offset:10240
    v_mul_f32 v42, v217, v42
    v_mul_f32 v43, v217, v43
    v_cvt_pk_bf16_f32 v36, 0, v36
    v_cvt_pk_bf16_f32 v37, 0, v37
    v_cvt_pk_bf16_f32 v38, 0, v38
    v_cvt_pk_bf16_f32 v39, 0, v39
    v_cvt_pk_bf16_f32 v40, 0, v40
    s_waitcnt lgkmcnt(6)
    v_mfma_f32_32x32x16_bf16 v[68:83], v[176:179], v[144:147], v[68:83]
    ds_read_b64_tr_b16 v[176:177], v189 offset:12288
    ds_read_b64_tr_b16 v[178:179], v189 offset:14336
    v_cvt_pk_bf16_f32 v41, 0, v41
    v_cvt_pk_bf16_f32 v42, 0, v42
    v_cvt_pk_bf16_f32 v43, 0, v43
    v_cvt_pk_bf16_f32 v44, 0, v44
    v_cvt_pk_bf16_f32 v45, 0, v45
    v_cvt_pk_bf16_f32 v46, 0, v46
    v_cvt_pk_bf16_f32 v47, 0, v47
    s_waitcnt lgkmcnt(6)
    v_mfma_f32_32x32x16_bf16 v[84:99], v[164:167], v[132:135], v[84:99]
    ds_read_b64_tr_b16 v[164:165], v190 offset:0
    ds_read_b64_tr_b16 v[166:167], v190 offset:2048
    v_cvt_pk_bf16_f32 v48, 0, v48
    v_cvt_pk_bf16_f32 v49, 0, v49
    v_cvt_pk_bf16_f32 v50, 0, v50
    v_cvt_pk_bf16_f32 v51, 0, v51
    v_mul_f32 v44, v217, v44
    v_mul_f32 v45, v217, v45
    v_mul_f32 v46, v217, v46
    s_waitcnt lgkmcnt(6)
    v_mfma_f32_32x32x16_bf16 v[84:99], v[168:171], v[136:139], v[84:99]
    ds_read_b64_tr_b16 v[168:169], v190 offset:4096
    ds_read_b64_tr_b16 v[170:171], v190 offset:6144
    v_mul_f32 v47, v217, v47
    v_mul_f32 v48, v217, v48
    v_mul_f32 v49, v217, v49
    v_mul_f32 v50, v217, v50
    v_mul_f32 v51, v217, v51
    v_cvt_pk_bf16_f32 v44, 0, v44
    v_cvt_pk_bf16_f32 v45, 0, v45
    s_waitcnt lgkmcnt(6)
    v_mfma_f32_32x32x16_bf16 v[84:99], v[172:175], v[140:143], v[84:99]
    ds_read_b64_tr_b16 v[172:173], v190 offset:8192
    ds_read_b64_tr_b16 v[174:175], v190 offset:10240
    v_cvt_pk_bf16_f32 v46, 0, v46
    v_cvt_pk_bf16_f32 v47, 0, v47
    v_cvt_pk_bf16_f32 v48, 0, v48
    v_cvt_pk_bf16_f32 v49, 0, v49
    v_cvt_pk_bf16_f32 v50, 0, v50
    v_cvt_pk_bf16_f32 v51, 0, v51
    v_cvt_pk_bf16_f32 v52, 0, v52
    s_waitcnt lgkmcnt(6)
    v_mfma_f32_32x32x16_bf16 v[84:99], v[176:179], v[144:147], v[84:99]
    ds_read_b64_tr_b16 v[176:177], v190 offset:12288
    ds_read_b64_tr_b16 v[178:179], v190 offset:14336
    v_cvt_pk_bf16_f32 v53, 0, v53
    v_cvt_pk_bf16_f32 v54, 0, v54
    v_cvt_pk_bf16_f32 v55, 0, v55
    v_cvt_pk_bf16_f32 v56, 0, v56
    v_cvt_pk_bf16_f32 v57, 0, v57
    v_cvt_pk_bf16_f32 v58, 0, v58
    v_cvt_pk_bf16_f32 v59, 0, v59
    s_waitcnt lgkmcnt(6)
    v_mfma_f32_32x32x16_bf16 v[100:115], v[164:167], v[132:135], v[100:115]
    ds_read_b64_tr_b16 v[164:165], v191 offset:0
    ds_read_b64_tr_b16 v[166:167], v191 offset:2048
    v_mul_f32 v52, v217, v52
    v_mul_f32 v53, v217, v53
    v_mul_f32 v54, v217, v54
    v_mul_f32 v55, v217, v55
    v_mul_f32 v56, v217, v56
    v_mul_f32 v57, v217, v57
    v_mul_f32 v58, v217, v58
    s_waitcnt lgkmcnt(6)
    v_mfma_f32_32x32x16_bf16 v[100:115], v[168:171], v[136:139], v[100:115]
    ds_read_b64_tr_b16 v[168:169], v191 offset:4096
    ds_read_b64_tr_b16 v[170:171], v191 offset:6144
    v_mul_f32 v59, v217, v59
    v_cvt_pk_bf16_f32 v52, 0, v52
    v_cvt_pk_bf16_f32 v53, 0, v53
    v_cvt_pk_bf16_f32 v54, 0, v54
    v_cvt_pk_bf16_f32 v55, 0, v55
    v_cvt_pk_bf16_f32 v56, 0, v56
    v_cvt_pk_bf16_f32 v57, 0, v57
    s_waitcnt lgkmcnt(6)
    v_mfma_f32_32x32x16_bf16 v[100:115], v[172:175], v[140:143], v[100:115]
    ds_read_b64_tr_b16 v[172:173], v191 offset:8192
    ds_read_b64_tr_b16 v[174:175], v191 offset:10240
    v_cvt_pk_bf16_f32 v58, 0, v58
    v_cvt_pk_bf16_f32 v59, 0, v59
    v_cvt_pk_bf16_f32 v60, 0, v60
    v_cvt_pk_bf16_f32 v61, 0, v61
    v_cvt_pk_bf16_f32 v62, 0, v62
    v_cvt_pk_bf16_f32 v63, 0, v63
    v_cvt_pk_bf16_f32 v64, 0, v64
    s_waitcnt lgkmcnt(6)
    v_mfma_f32_32x32x16_bf16 v[100:115], v[176:179], v[144:147], v[100:115]
    ds_read_b64_tr_b16 v[176:177], v191 offset:12288
    ds_read_b64_tr_b16 v[178:179], v191 offset:14336
    v_cvt_pk_bf16_f32 v65, 0, v65
    v_cvt_pk_bf16_f32 v66, 0, v66
    v_cvt_pk_bf16_f32 v67, 0, v67
    v_mul_f32 v60, v217, v60
    v_mul_f32 v61, v217, v61
    v_mul_f32 v62, v217, v62
    v_mul_f32 v63, v217, v63
    s_waitcnt lgkmcnt(6)
    v_mfma_f32_32x32x16_bf16 v[116:131], v[164:167], v[132:135], v[116:131]
    v_mul_f32 v64, v217, v64
    v_mul_f32 v65, v217, v65
    v_mul_f32 v66, v217, v66
    v_mul_f32 v67, v217, v67
    v_cvt_pk_bf16_f32 v60, 0, v60
    v_cvt_pk_bf16_f32 v61, 0, v61
    v_cvt_pk_bf16_f32 v62, 0, v62
    s_waitcnt lgkmcnt(4)
    v_mfma_f32_32x32x16_bf16 v[116:131], v[168:171], v[136:139], v[116:131]
    v_cvt_pk_bf16_f32 v63, 0, v63
    v_cvt_pk_bf16_f32 v64, 0, v64
    v_cvt_pk_bf16_f32 v65, 0, v65
    v_cvt_pk_bf16_f32 v66, 0, v66
    v_cvt_pk_bf16_f32 v67, 0, v67
    v_max3_f32 v204, v36, v37, v38
    v_max3_f32 v205, v44, v45, v46
    s_waitcnt lgkmcnt(2)
    v_mfma_f32_32x32x16_bf16 v[116:131], v[172:175], v[140:143], v[116:131]
    v_max3_f32 v206, v52, v53, v54
    v_max3_f32 v207, v60, v61, v62
    v_max3_f32 v204, v204, v39, v40
    v_max3_f32 v205, v205, v47, v48
    v_max3_f32 v206, v206, v55, v56
    v_max3_f32 v207, v207, v63, v64
    v_max3_f32 v204, v204, v41, v42
    s_waitcnt lgkmcnt(0)
    v_mfma_f32_32x32x16_bf16 v[116:131], v[176:179], v[144:147], v[116:131]
    v_max3_f32 v205, v205, v49, v50
    v_max3_f32 v206, v206, v57, v58
    v_max3_f32 v207, v207, v65, v66
    v_max3_f32 v204, v204, v43, v51
    v_max3_f32 v206, v206, v59, v67
    v_max3_f32 v204, v204, v205, v206
    v_max_f32 v204, v204, v207
    s_setprio 0
    s_barrier
    v_mov_b32 v205, v204
    s_nop 1
    v_permlane32_swap_b32 v204, v205
    v_max_f32 v204, v204, v205
    v_sub_f32 v205, v204, v200
    v_cmp_lt_f32 vcc, v218, v205
    s_cbranch_vccz L_attn_kernel_nr5
    v_max_f32 v204, v204, v200
    v_mul_f32 v203, v216, v204
    v_fma_f32 v205, v200, v216, -v203
    v_exp_f32 v202, v205
    v_mov_b32 v200, v204
    v_mul_f32 v201, v202, v201
    v_mul_f32 v68, v202, v68
    v_mul_f32 v69, v202, v69
    v_mul_f32 v70, v202, v70
    v_mul_f32 v71, v202, v71
    v_mul_f32 v72, v202, v72
    v_mul_f32 v73, v202, v73
    v_mul_f32 v74, v202, v74
    v_mul_f32 v75, v202, v75
    v_mul_f32 v76, v202, v76
    v_mul_f32 v77, v202, v77
    v_mul_f32 v78, v202, v78
    v_mul_f32 v79, v202, v79
    v_mul_f32 v80, v202, v80
    v_mul_f32 v81, v202, v81
    v_mul_f32 v82, v202, v82
    v_mul_f32 v83, v202, v83
    v_mul_f32 v84, v202, v84
    v_mul_f32 v85, v202, v85
    v_mul_f32 v86, v202, v86
    v_mul_f32 v87, v202, v87
    v_mul_f32 v88, v202, v88
    v_mul_f32 v89, v202, v89
    v_mul_f32 v90, v202, v90
    v_mul_f32 v91, v202, v91
    v_mul_f32 v92, v202, v92
    v_mul_f32 v93, v202, v93
    v_mul_f32 v94, v202, v94
    v_mul_f32 v95, v202, v95
    v_mul_f32 v96, v202, v96
    v_mul_f32 v97, v202, v97
    v_mul_f32 v98, v202, v98
    v_mul_f32 v99, v202, v99
    v_mul_f32 v100, v202, v100
    v_mul_f32 v101, v202, v101
    v_mul_f32 v102, v202, v102
    v_mul_f32 v103, v202, v103
    v_mul_f32 v104, v202, v104
    v_mul_f32 v105, v202, v105
    v_mul_f32 v106, v202, v106
    v_mul_f32 v107, v202, v107
    v_mul_f32 v108, v202, v108
    v_mul_f32 v109, v202, v109
    v_mul_f32 v110, v202, v110
    v_mul_f32 v111, v202, v111
    v_mul_f32 v112, v202, v112
    v_mul_f32 v113, v202, v113
    v_mul_f32 v114, v202, v114
    v_mul_f32 v115, v202, v115
    v_mul_f32 v116, v202, v116
    v_mul_f32 v117, v202, v117
    v_mul_f32 v118, v202, v118
    v_mul_f32 v119, v202, v119
    v_mul_f32 v120, v202, v120
    v_mul_f32 v121, v202, v121
    v_mul_f32 v122, v202, v122
    v_mul_f32 v123, v202, v123
    v_mul_f32 v124, v202, v124
    v_mul_f32 v125, v202, v125
    v_mul_f32 v126, v202, v126
    v_mul_f32 v127, v202, v127
    v_mul_f32 v128, v202, v128
    v_mul_f32 v129, v202, v129
    v_mul_f32 v130, v202, v130
    v_mul_f32 v131, v202, v131
L_attn_kernel_nr5:
    v_fma_f32 v36, v36, v216, -v203
    v_fma_f32 v37, v37, v216, -v203
    v_fma_f32 v38, v38, v216, -v203
    v_fma_f32 v39, v39, v216, -v203
    v_fma_f32 v40, v40, v216, -v203
    v_fma_f32 v41, v41, v216, -v203
    v_fma_f32 v42, v42, v216, -v203
    v_fma_f32 v43, v43, v216, -v203
    v_exp_f32 v36, v36
    v_exp_f32 v37, v37
    v_exp_f32 v38, v38
    v_exp_f32 v39, v39
    v_exp_f32 v40, v40
    v_exp_f32 v41, v41
    v_exp_f32 v42, v42
    v_exp_f32 v43, v43
    v_fma_f32 v44, v44, v216, -v203
    v_fma_f32 v45, v45, v216, -v203
    v_fma_f32 v46, v46, v216, -v203
    v_fma_f32 v47, v47, v216, -v203
    v_fma_f32 v48, v48, v216, -v203
    v_fma_f32 v49, v49, v216, -v203
    v_fma_f32 v50, v50, v216, -v203
    v_fma_f32 v51, v51, v216, -v203
    v_exp_f32 v44, v44
    v_exp_f32 v45, v45
    v_exp_f32 v46, v46
    v_exp_f32 v47, v47
    v_exp_f32 v48, v48
    v_exp_f32 v49, v49
    v_exp_f32 v50, v50
    v_exp_f32 v51, v51
    v_mov_b32 v212, v36
    v_mov_b32 v213, v37
    v_mov_b32 v214, v38
    v_mov_b32 v215, v39
    v_add_f32 v212, v212, v40
    v_add_f32 v213, v213, v41
    v_add_f32 v214, v214, v42
    v_add_f32 v215, v215, v43
    v_cvt_pk_bf16_f32 v132, v36, v37
    v_cvt_pk_bf16_f32 v133, v38, v39
    v_cvt_pk_bf16_f32 v134, v40, v41
    v_cvt_pk_bf16_f32 v135, v42, v43
    v_fma_f32 v52, v52, v216, -v203
    v_fma_f32 v53, v53, v216, -v203
    v_fma_f32 v54, v54, v216, -v203
    v_fma_f32 v55, v55, v216, -v203
    v_fma_f32 v56, v56, v216, -v203
    v_fma_f32 v57, v57, v216, -v203
    v_fma_f32 v58, v58, v216, -v203
    v_fma_f32 v59, v59, v216, -v203
    v_exp_f32 v52, v52
    v_exp_f32 v53, v53
    v_exp_f32 v54, v54
    v_exp_f32 v55, v55
    v_exp_f32 v56, v56
    v_exp_f32 v57, v57
    v_exp_f32 v58, v58
    v_exp_f32 v59, v59
    v_add_f32 v212, v212, v44
    v_add_f32 v213, v213, v45
    v_add_f32 v214, v214, v46
    v_add_f32 v215, v215, v47
    v_add_f32 v212, v212, v48
    v_add_f32 v213, v213, v49
    v_add_f32 v214, v214, v50
    v_add_f32 v215, v215, v51
    v_cvt_pk_bf16_f32 v136, v44, v45
    v_cvt_pk_bf16_f32 v137, v46, v47
    v_cvt_pk_bf16_f32 v138, v48, v49
    v_cvt_pk_bf16_f32 v139, v50, v51
    v_fma_f32 v60, v60, v216, -v203
    v_fma_f32 v61, v61, v216, -v203
    v_fma_f32 v62, v62, v216, -v203
    v_fma_f32 v63, v63, v216, -v203
    v_fma_f32 v64, v64, v216, -v203
    v_fma_f32 v65, v65, v216, -v203
    v_fma_f32 v66, v66, v216, -v203
    v_fma_f32 v67, v67, v216, -v203
    v_exp_f32 v60, v60
    v_exp_f32 v61, v61
    v_exp_f32 v62, v62
    v_exp_f32 v63, v63
    v_exp_f32 v64, v64
    v_exp_f32 v65, v65
    v_exp_f32 v66, v66
    v_exp_f32 v67, v67
    v_add_f32 v212, v212, v52
    v_add_f32 v213, v213, v53
    v_add_f32 v214, v214, v54
    v_add_f32 v215, v215, v55
    v_add_f32 v212, v212, v56
    v_add_f32 v213, v213, v57
    v_add_f32 v214, v214, v58
    v_add_f32 v215, v215, v59
    v_cvt_pk_bf16_f32 v140, v52, v53
    v_cvt_pk_bf16_f32 v141, v54, v55
    v_cvt_pk_bf16_f32 v142, v56, v57
    v_cvt_pk_bf16_f32 v143, v58, v59
    v_add_f32 v212, v212, v60
    v_add_f32 v213, v213, v61
    v_add_f32 v214, v214, v62
    v_add_f32 v215, v215, v63
    v_add_f32 v212, v212, v64
    v_add_f32 v213, v213, v65
    v_add_f32 v214, v214, v66
    v_add_f32 v215, v215, v67
    v_cvt_pk_bf16_f32 v144, v60, v61
    v_cvt_pk_bf16_f32 v145, v62, v63
    v_cvt_pk_bf16_f32 v146, v64, v65
    v_cvt_pk_bf16_f32 v147, v66, v67
    v_add_f32 v212, v212, v213
    v_add_f32 v214, v214, v215
    v_add_f32 v212, v212, v214
    v_add_f32 v201, v201, v212
    ds_read_b128 v[148:151], v180 offset:0
    ds_read_b128 v[152:155], v181 offset:0
    ds_read_b128 v[156:159], v182 offset:0
    ds_read_b128 v[160:163], v183 offset:0
    s_waitcnt vmcnt(4)
    s_barrier
    s_add_u32 s35, s35, 1
    s_cmp_lt_u32 s35, 7
    s_cbranch_scc1 L_attn_kernel_loop
    s_setprio 3
    s_waitcnt lgkmcnt(3)
    v_mfma_f32_32x32x16_bf16 v[36:51], v[148:151], v[4:7], 0
    ds_read_b128 v[148:151], v184 offset:0
    s_waitcnt lgkmcnt(3)
    v_mfma_f32_32x32x16_bf16 v[36:51], v[152:155], v[8:11], v[36:51]
    ds_read_b128 v[152:155], v185 offset:0
    s_add_u32 s52, s46, 49152
    s_add_u32 m0, s52, 0
    s_nop 0
    buffer_load_dwordx4 v196, s[12:15], s47 offen lds
    s_waitcnt lgkmcnt(3)
    v_mfma_f32_32x32x16_bf16 v[36:51], v[156:159], v[12:15], v[36:51]
    ds_read_b128 v[156:159], v186 offset:0
    s_waitcnt lgkmcnt(3)
    v_mfma_f32_32x32x16_bf16 v[36:51], v[160:163], v[16:19], v[36:51]
    ds_read_b128 v[160:163], v187 offset:0
    s_waitcnt lgkmcnt(3)
    v_mfma_f32_32x32x16_bf16 v[36:51], v[148:151], v[20:23], v[36:51]
    ds_read_b128 v[148:151], v180 offset:8192
    s_waitcnt lgkmcnt(3)
    v_mfma_f32_32x32x16_bf16 v[36:51], v[152:155], v[24:27], v[36:51]
    ds_read_b128 v[152:155], v181 offset:8192
    s_add_u32 m0, s52, 1024
    s_nop 0
    buffer_load_dwordx4 v197, s[12:15], s47 offen lds
    s_waitcnt lgkmcnt(3)
    v_mfma_f32_32x32x16_bf16 v[36:51], v[156:159], v[28:31], v[36:51]
    ds_read_b128 v[156:159], v182 offset:8192
    s_waitcnt lgkmcnt(3)
    v_mfma_f32_32x32x16_bf16 v[36:51], v[160:163], v[32:35], v[36:51]
    ds_read_b128 v[160:163], v183 offset:8192
    s_waitcnt lgkmcnt(3)
    v_mfma_f32_32x32x16_bf16 v[52:67], v[148:151], v[4:7], 0
    ds_read_b128 v[148:151], v184 offset:8192
    s_waitcnt lgkmcnt(3)
    v_mfma_f32_32x32x16_bf16 v[52:67], v[152:155], v[8:11], v[52:67]
    ds_read_b128 v[152:155], v185 offset:8192
    s_add_u32 m0, s52, 2048
    s_nop 0
    buffer_load_dwordx4 v198, s[12:15], s47 offen lds
    s_waitcnt lgkmcnt(3)
    v_mfma_f32_32x32x16_bf16 v[52:67], v[156:159], v[12:15], v[52:67]
    ds_read_b128 v[156:159], v186 offset:8192
    s_waitcnt lgkmcnt(3)
    v_mfma_f32_32x32x16_bf16 v[52:67], v[160:163], v[16:19], v[52:67]
    ds_read_b128 v[160:163], v187 offset:8192
    s_waitcnt lgkmcnt(3)
    v_mfma_f32_32x32x16_bf16 v[52:67], v[148:151], v[20:23], v[52:67]
    ds_read_b64_tr_b16 v[164:165], v188 offset:16384
    ds_read_b64_tr_b16 v[166:167], v188 offset:18432
    s_waitcnt lgkmcnt(4)
    v_mfma_f32_32x32x16_bf16 v[52:67], v[152:155], v[24:27], v[52:67]
    ds_read_b64_tr_b16 v[168:169], v188 offset:20480
    ds_read_b64_tr_b16 v[170:171], v188 offset:22528
    s_add_u32 m0, s52, 3072
    s_nop 0
    buffer_load_dwordx4 v199, s[12:15], s47 offen lds
    s_add_u32 s47, s47, 16384
    s_waitcnt lgkmcnt(5)
    v_mfma_f32_32x32x16_bf16 v[52:67], v[156:159], v[28:31], v[52:67]
    ds_read_b64_tr_b16 v[172:173], v188 offset:24576
    ds_read_b64_tr_b16 v[174:175], v188 offset:26624
    s_waitcnt lgkmcnt(6)
    v_mfma_f32_32x32x16_bf16 v[52:67], v[160:163], v[32:35], v[52:67]
    ds_read_b64_tr_b16 v[176:177], v188 offset:28672
    ds_read_b64_tr_b16 v[178:179], v188 offset:30720
    s_waitcnt lgkmcnt(6)
    v_mfma_f32_32x32x16_bf16 v[68:83], v[164:167], v[132:135], v[68:83]
    ds_read_b64_tr_b16 v[164:165], v189 offset:16384
    ds_read_b64_tr_b16 v[166:167], v189 offset:18432
    v_cvt_pk_bf16_f32 v36, 0, v36
    v_cvt_pk_bf16_f32 v37, 0, v37
    v_cvt_pk_bf16_f32 v38, 0, v38
    v_cvt_pk_bf16_f32 v39, 0, v39
    v_cvt_pk_bf16_f32 v40, 0, v40
    v_cvt_pk_bf16_f32 v41, 0, v41
    v_cvt_pk_bf16_f32 v42, 0, v42
    s_waitcnt lgkmcnt(6)
    v_mfma_f32_32x32x16_bf16 v[68:83], v[168:171], v[136:139], v[68:83]
    ds_read_b64_tr_b16 v[168:169], v189 offset:20480
    ds_read_b64_tr_b16 v[170:171], v189 offset:22528
    v_cvt_pk_bf16_f32 v43, 0, v43
    v_mul_f32 v36, v217, v36
    v_mul_f32 v37, v217, v37
    v_mul_f32 v38, v217, v38
    v_mul_f32 v39, v217, v39
    v_mul_f32 v40, v217, v40
    v_mul_f32 v41, v217, v41
    s_waitcnt lgkmcnt(6)
    v_mfma_f32_32x32x16_bf16 v[68:83], v[172:175], v[140:143], v[68:83]
    ds_read_b64_tr_b16 v[172:173], v189 offset:24576
    ds_read_b64_tr_b16 v[174:175], v189 offset:26624
    v_mul_f32 v42, v217, v42
    v_mul_f32 v43, v217, v43
    v_cvt_pk_bf16_f32 v36, 0, v36
    v_cvt_pk_bf16_f32 v37, 0, v37
    v_cvt_pk_bf16_f32 v38, 0, v38
    v_cvt_pk_bf16_f32 v39, 0, v39
    v_cvt_pk_bf16_f32 v40, 0, v40
    s_waitcnt lgkmcnt(6)
    v_mfma_f32_32x32x16_bf16 v[68:83], v[176:179], v[144:147], v[68:83]
    ds_read_b64_tr_b16 v[176:177], v189 offset:28672
    ds_read_b64_tr_b16 v[178:179], v189 offset:30720
    v_cvt_pk_bf16_f32 v41, 0, v41
    v_cvt_pk_bf16_f32 v42, 0, v42
    v_cvt_pk_bf16_f32 v43, 0, v43
    v_cvt_pk_bf16_f32 v44, 0, v44
    v_cvt_pk_bf16_f32 v45, 0, v45
    v_cvt_pk_bf16_f32 v46, 0, v46
    v_cvt_pk_bf16_f32 v47, 0, v47
    s_waitcnt lgkmcnt(6)
    v_mfma_f32_32x32x16_bf16 v[84:99], v[164:167], v[132:135], v[84:99]
    ds_read_b64_tr_b16 v[164:165], v190 offset:16384
    ds_read_b64_tr_b16 v[166:167], v190 offset:18432
    v_cvt_pk_bf16_f32 v48, 0, v48
    v_cvt_pk_bf16_f32 v49, 0, v49
    v_cvt_pk_bf16_f32 v50, 0, v50
    v_cvt_pk_bf16_f32 v51, 0, v51
    v_mul_f32 v44, v217, v44
    v_mul_f32 v45, v217, v45
    v_mul_f32 v46, v217, v46
    s_waitcnt lgkmcnt(6)
    v_mfma_f32_32x32x16_bf16 v[84:99], v[168:171], v[136:139], v[84:99]
    ds_read_b64_tr_b16 v[168:169], v190 offset:20480
    ds_read_b64_tr_b16 v[170:171], v190 offset:22528
    v_mul_f32 v47, v217, v47
    v_mul_f32 v48, v217, v48
    v_mul_f32 v49, v217, v49
    v_mul_f32 v50, v217, v50
    v_mul_f32 v51, v217, v51
    v_cvt_pk_bf16_f32 v44, 0, v44
    v_cvt_pk_bf16_f32 v45, 0, v45
    s_waitcnt lgkmcnt(6)
    v_mfma_f32_32x32x16_bf16 v[84:99], v[172:175], v[140:143], v[84:99]
    ds_read_b64_tr_b16 v[172:173], v190 offset:24576
    ds_read_b64_tr_b16 v[174:175], v190 offset:26624
    v_cvt_pk_bf16_f32 v46, 0, v46
    v_cvt_pk_bf16_f32 v47, 0, v47
    v_cvt_pk_bf16_f32 v48, 0, v48
    v_cvt_pk_bf16_f32 v49, 0, v49
    v_cvt_pk_bf16_f32 v50, 0, v50
    v_cvt_pk_bf16_f32 v51, 0, v51
    v_cvt_pk_bf16_f32 v52, 0, v52
    s_waitcnt lgkmcnt(6)
    v_mfma_f32_32x32x16_bf16 v[84:99], v[176:179], v[144:147], v[84:99]
    ds_read_b64_tr_b16 v[176:177], v190 offset:28672
    ds_read_b64_tr_b16 v[178:179], v190 offset:30720
    v_cvt_pk_bf16_f32 v53, 0, v53
    v_cvt_pk_bf16_f32 v54, 0, v54
    v_cvt_pk_bf16_f32 v55, 0, v55
    v_cvt_pk_bf16_f32 v56, 0, v56
    v_cvt_pk_bf16_f32 v57, 0, v57
    v_cvt_pk_bf16_f32 v58, 0, v58
    v_cvt_pk_bf16_f32 v59, 0, v59
    s_waitcnt lgkmcnt(6)
    v_mfma_f32_32x32x16_bf16 v[100:115], v[164:167], v[132:135], v[100:115]
    ds_read_b64_tr_b16 v[164:165], v191 offset:16384
    ds_read_b64_tr_b16 v[166:167], v191 offset:18432
    v_mul_f32 v52, v217, v52
    v_mul_f32 v53, v217, v53
    v_mul_f32 v54, v217, v54
    v_mul_f32 v55, v217, v55
    v_mul_f32 v56, v217, v56
    v_mul_f32 v57, v217, v57
    v_mul_f32 v58, v217, v58
    s_waitcnt lgkmcnt(6)
    v_mfma_f32_32x32x16_bf16 v[100:115], v[168:171], v[136:139], v[100:115]
    ds_read_b64_tr_b16 v[168:169], v191 offset:20480
    ds_read_b64_tr_b16 v[170:171], v191 offset:22528
    v_mul_f32 v59, v217, v59
    v_cvt_pk_bf16_f32 v52, 0, v52
    v_cvt_pk_bf16_f32 v53, 0, v53
    v_cvt_pk_bf16_f32 v54, 0, v54
    v_cvt_pk_bf16_f32 v55, 0, v55
    v_cvt_pk_bf16_f32 v56, 0, v56
    v_cvt_pk_bf16_f32 v57, 0, v57
    s_waitcnt lgkmcnt(6)
    v_mfma_f32_32x32x16_bf16 v[100:115], v[172:175], v[140:143], v[100:115]
    ds_read_b64_tr_b16 v[172:173], v191 offset:24576
    ds_read_b64_tr_b16 v[174:175], v191 offset:26624
    v_cvt_pk_bf16_f32 v58, 0, v58
    v_cvt_pk_bf16_f32 v59, 0, v59
    v_cvt_pk_bf16_f32 v60, 0, v60
    v_cvt_pk_bf16_f32 v61, 0, v61
    v_cvt_pk_bf16_f32 v62, 0, v62
    v_cvt_pk_bf16_f32 v63, 0, v63
    v_cvt_pk_bf16_f32 v64, 0, v64
    s_waitcnt lgkmcnt(6)
    v_mfma_f32_32x32x16_bf16 v[100:115], v[176:179], v[144:147], v[100:115]
    ds_read_b64_tr_b16 v[176:177], v191 offset:28672
    ds_read_b64_tr_b16 v[178:179], v191 offset:30720
    v_cvt_pk_bf16_f32 v65, 0, v65
    v_cvt_pk_bf16_f32 v66, 0, v66
    v_cvt_pk_bf16_f32 v67, 0, v67
    v_mul_f32 v60, v217, v60
    v_mul_f32 v61, v217, v61
    v_mul_f32 v62, v217, v62
    v_mul_f32 v63, v217, v63
    s_waitcnt lgkmcnt(6)
    v_mfma_f32_32x32x16_bf16 v[116:131], v[164:167], v[132:135], v[116:131]
    v_mul_f32 v64, v217, v64
    v_mul_f32 v65, v217, v65
    v_mul_f32 v66, v217, v66
    v_mul_f32 v67, v217, v67
    v_cvt_pk_bf16_f32 v60, 0, v60
    v_cvt_pk_bf16_f32 v61, 0, v61
    v_cvt_pk_bf16_f32 v62, 0, v62
    s_waitcnt lgkmcnt(4)
    v_mfma_f32_32x32x16_bf16 v[116:131], v[168:171], v[136:139], v[116:131]
    v_cvt_pk_bf16_f32 v63, 0, v63
    v_cvt_pk_bf16_f32 v64, 0, v64
    v_cvt_pk_bf16_f32 v65, 0, v65
    v_cvt_pk_bf16_f32 v66, 0, v66
    v_cvt_pk_bf16_f32 v67, 0, v67
    v_max3_f32 v204, v36, v37, v38
    v_max3_f32 v205, v44, v45, v46
    s_waitcnt lgkmcnt(2)
    v_mfma_f32_32x32x16_bf16 v[116:131], v[172:175], v[140:143], v[116:131]
    v_max3_f32 v206, v52, v53, v54
    v_max3_f32 v207, v60, v61, v62
    v_max3_f32 v204, v204, v39, v40
    v_max3_f32 v205, v205, v47, v48
    v_max3_f32 v206, v206, v55, v56
    v_max3_f32 v207, v207, v63, v64
    v_max3_f32 v204, v204, v41, v42
    s_waitcnt lgkmcnt(0)
    v_mfma_f32_32x32x16_bf16 v[116:131], v[176:179], v[144:147], v[116:131]
    v_max3_f32 v205, v205, v49, v50
    v_max3_f32 v206, v206, v57, v58
    v_max3_f32 v207, v207, v65, v66
    v_max3_f32 v204, v204, v43, v51
    v_max3_f32 v206, v206, v59, v67
    v_max3_f32 v204, v204, v205, v206
    v_max_f32 v204, v204, v207
    s_setprio 0
    s_barrier
    v_mov_b32 v205, v204
    s_nop 1
    v_permlane32_swap_b32 v204, v205
    v_max_f32 v204, v204, v205
    v_sub_f32 v205, v204, v200
    v_cmp_lt_f32 vcc, v218, v205
    s_cbranch_vccz L_attn_kernel_nr6
    v_max_f32 v204, v204, v200
    v_mul_f32 v203, v216, v204
    v_fma_f32 v205, v200, v216, -v203
    v_exp_f32 v202, v205
    v_mov_b32 v200, v204
    v_mul_f32 v201, v202, v201
    v_mul_f32 v68, v202, v68
    v_mul_f32 v69, v202, v69
    v_mul_f32 v70, v202, v70
    v_mul_f32 v71, v202, v71
    v_mul_f32 v72, v202, v72
    v_mul_f32 v73, v202, v73
    v_mul_f32 v74, v202, v74
    v_mul_f32 v75, v202, v75
    v_mul_f32 v76, v202, v76
    v_mul_f32 v77, v202, v77
    v_mul_f32 v78, v202, v78
    v_mul_f32 v79, v202, v79
    v_mul_f32 v80, v202, v80
    v_mul_f32 v81, v202, v81
    v_mul_f32 v82, v202, v82
    v_mul_f32 v83, v202, v83
    v_mul_f32 v84, v202, v84
    v_mul_f32 v85, v202, v85
    v_mul_f32 v86, v202, v86
    v_mul_f32 v87, v202, v87
    v_mul_f32 v88, v202, v88
    v_mul_f32 v89, v202, v89
    v_mul_f32 v90, v202, v90
    v_mul_f32 v91, v202, v91
    v_mul_f32 v92, v202, v92
    v_mul_f32 v93, v202, v93
    v_mul_f32 v94, v202, v94
    v_mul_f32 v95, v202, v95
    v_mul_f32 v96, v202, v96
    v_mul_f32 v97, v202, v97
    v_mul_f32 v98, v202, v98
    v_mul_f32 v99, v202, v99
    v_mul_f32 v100, v202, v100
    v_mul_f32 v101, v202, v101
    v_mul_f32 v102, v202, v102
    v_mul_f32 v103, v202, v103
    v_mul_f32 v104, v202, v104
    v_mul_f32 v105, v202, v105
    v_mul_f32 v106, v202, v106
    v_mul_f32 v107, v202, v107
    v_mul_f32 v108, v202, v108
    v_mul_f32 v109, v202, v109
    v_mul_f32 v110, v202, v110
    v_mul_f32 v111, v202, v111
    v_mul_f32 v112, v202, v112
    v_mul_f32 v113, v202, v113
    v_mul_f32 v114, v202, v114
    v_mul_f32 v115, v202, v115
    v_mul_f32 v116, v202, v116
    v_mul_f32 v117, v202, v117
    v_mul_f32 v118, v202, v118
    v_mul_f32 v119, v202, v119
    v_mul_f32 v120, v202, v120
    v_mul_f32 v121, v202, v121
    v_mul_f32 v122, v202, v122
    v_mul_f32 v123, v202, v123
    v_mul_f32 v124, v202, v124
    v_mul_f32 v125, v202, v125
    v_mul_f32 v126, v202, v126
    v_mul_f32 v127, v202, v127
    v_mul_f32 v128, v202, v128
    v_mul_f32 v129, v202, v129
    v_mul_f32 v130, v202, v130
    v_mul_f32 v131, v202, v131
L_attn_kernel_nr6:
    v_fma_f32 v36, v36, v216, -v203
    v_fma_f32 v37, v37, v216, -v203
    v_fma_f32 v38, v38, v216, -v203
    v_fma_f32 v39, v39, v216, -v203
    v_fma_f32 v40, v40, v216, -v203
    v_fma_f32 v41, v41, v216, -v203
    v_fma_f32 v42, v42, v216, -v203
    v_fma_f32 v43, v43, v216, -v203
    v_exp_f32 v36, v36
    v_exp_f32 v37, v37
    v_exp_f32 v38, v38
    v_exp_f32 v39, v39
    v_exp_f32 v40, v40
    v_exp_f32 v41, v41
    v_exp_f32 v42, v42
    v_exp_f32 v43, v43
    v_fma_f32 v44, v44, v216, -v203
    v_fma_f32 v45, v45, v216, -v203
    v_fma_f32 v46, v46, v216, -v203
    v_fma_f32 v47, v47, v216, -v203
    v_fma_f32 v48, v48, v216, -v203
    v_fma_f32 v49, v49, v216, -v203
    v_fma_f32 v50, v50, v216, -v203
    v_fma_f32 v51, v51, v216, -v203
    v_exp_f32 v44, v44
    v_exp_f32 v45, v45
    v_exp_f32 v46, v46
    v_exp_f32 v47, v47
    v_exp_f32 v48, v48
    v_exp_f32 v49, v49
    v_exp_f32 v50, v50
    v_exp_f32 v51, v51
    v_mov_b32 v212, v36
    v_mov_b32 v213, v37
    v_mov_b32 v214, v38
    v_mov_b32 v215, v39
    v_add_f32 v212, v212, v40
    v_add_f32 v213, v213, v41
    v_add_f32 v214, v214, v42
    v_add_f32 v215, v215, v43
    v_cvt_pk_bf16_f32 v132, v36, v37
    v_cvt_pk_bf16_f32 v133, v38, v39
    v_cvt_pk_bf16_f32 v134, v40, v41
    v_cvt_pk_bf16_f32 v135, v42, v43
    v_fma_f32 v52, v52, v216, -v203
    v_fma_f32 v53, v53, v216, -v203
    v_fma_f32 v54, v54, v216, -v203
    v_fma_f32 v55, v55, v216, -v203
    v_fma_f32 v56, v56, v216, -v203
    v_fma_f32 v57, v57, v216, -v203
    v_fma_f32 v58, v58, v216, -v203
    v_fma_f32 v59, v59, v216, -v203
    v_exp_f32 v52, v52
    v_exp_f32 v53, v53
    v_exp_f32 v54, v54
    v_exp_f32 v55, v55
    v_exp_f32 v56, v56
    v_exp_f32 v57, v57
    v_exp_f32 v58, v58
    v_exp_f32 v59, v59
    v_add_f32 v212, v212, v44
    v_add_f32 v213, v213, v45
    v_add_f32 v214, v214, v46
    v_add_f32 v215, v215, v47
    v_add_f32 v212, v212, v48
    v_add_f32 v213, v213, v49
    v_add_f32 v214, v214, v50
    v_add_f32 v215, v215, v51
    v_cvt_pk_bf16_f32 v136, v44, v45
    v_cvt_pk_bf16_f32 v137, v46, v47
    v_cvt_pk_bf16_f32 v138, v48, v49
    v_cvt_pk_bf16_f32 v139, v50, v51
    v_fma_f32 v60, v60, v216, -v203
    v_fma_f32 v61, v61, v216, -v203
    v_fma_f32 v62, v62, v216, -v203
    v_fma_f32 v63, v63, v216, -v203
    v_fma_f32 v64, v64, v216, -v203
    v_fma_f32 v65, v65, v216, -v203
    v_fma_f32 v66, v66, v216, -v203
    v_fma_f32 v67, v67, v216, -v203
    v_exp_f32 v60, v60
    v_exp_f32 v61, v61
    v_exp_f32 v62, v62
    v_exp_f32 v63, v63
    v_exp_f32 v64, v64
    v_exp_f32 v65, v65
    v_exp_f32 v66, v66
    v_exp_f32 v67, v67
    v_add_f32 v212, v212, v52
    v_add_f32 v213, v213, v53
    v_add_f32 v214, v214, v54
    v_add_f32 v215, v215, v55
    v_add_f32 v212, v212, v56
    v_add_f32 v213, v213, v57
    v_add_f32 v214, v214, v58
    v_add_f32 v215, v215, v59
    v_cvt_pk_bf16_f32 v140, v52, v53
    v_cvt_pk_bf16_f32 v141, v54, v55
    v_cvt_pk_bf16_f32 v142, v56, v57
    v_cvt_pk_bf16_f32 v143, v58, v59
    v_add_f32 v212, v212, v60
    v_add_f32 v213, v213, v61
    v_add_f32 v214, v214, v62
    v_add_f32 v215, v215, v63
    v_add_f32 v212, v212, v64
    v_add_f32 v213, v213, v65
    v_add_f32 v214, v214, v66
    v_add_f32 v215, v215, v67
    v_cvt_pk_bf16_f32 v144, v60, v61
    v_cvt_pk_bf16_f32 v145, v62, v63
    v_cvt_pk_bf16_f32 v146, v64, v65
    v_cvt_pk_bf16_f32 v147, v66, v67
    v_add_f32 v212, v212, v213
    v_add_f32 v214, v214, v215
    v_add_f32 v212, v212, v214
    v_add_f32 v201, v201, v212
    ds_read_b128 v[148:151], v180 offset:16384
    ds_read_b128 v[152:155], v181 offset:16384
    ds_read_b128 v[156:159], v182 offset:16384
    ds_read_b128 v[160:163], v183 offset:16384
    s_waitcnt vmcnt(4)
    s_barrier
    s_setprio 3
    s_waitcnt lgkmcnt(3)
    v_mfma_f32_32x32x16_bf16 v[36:51], v[148:151], v[4:7], 0
    ds_read_b128 v[148:151], v184 offset:16384
    s_waitcnt lgkmcnt(3)
    v_mfma_f32_32x32x16_bf16 v[36:51], v[152:155], v[8:11], v[36:51]
    ds_read_b128 v[152:155], v185 offset:16384
    s_add_u32 s52, s46, 0
    s_add_u32 m0, s52, 0
    s_nop 0
    buffer_load_dwordx4 v196, s[12:15], s47 offen lds
    s_waitcnt lgkmcnt(3)
    v_mfma_f32_32x32x16_bf16 v[36:51], v[156:159], v[12:15], v[36:51]
    ds_read_b128 v[156:159], v186 offset:16384
    s_waitcnt lgkmcnt(3)
    v_mfma_f32_32x32x16_bf16 v[36:51], v[160:163], v[16:19], v[36:51]
    ds_read_b128 v[160:163], v187 offset:16384
    s_waitcnt lgkmcnt(3)
    v_mfma_f32_32x32x16_bf16 v[36:51], v[148:151], v[20:23], v[36:51]
    ds_read_b128 v[148:151], v180 offset:24576
    s_waitcnt lgkmcnt(3)
    v_mfma_f32_32x32x16_bf16 v[36:51], v[152:155], v[24:27], v[36:51]
    ds_read_b128 v[152:155], v181 offset:24576
    s_add_u32 m0, s52, 1024
    s_nop 0
    buffer_load_dwordx4 v197, s[12:15], s47 offen lds
    s_waitcnt lgkmcnt(3)
    v_mfma_f32_32x32x16_bf16 v[36:51], v[156:159], v[28:31], v[36:51]
    ds_read_b128 v[156:159], v182 offset:24576
    s_waitcnt lgkmcnt(3)
    v_mfma_f32_32x32x16_bf16 v[36:51], v[160:163], v[32:35], v[36:51]
    ds_read_b128 v[160:163], v183 offset:24576
    s_waitcnt lgkmcnt(3)
    v_mfma_f32_32x32x16_bf16 v[52:67], v[148:151], v[4:7], 0
    ds_read_b128 v[148:151], v184 offset:24576
    s_waitcnt lgkmcnt(3)
    v_mfma_f32_32x32x16_bf16 v[52:67], v[152:155], v[8:11], v[52:67]
    ds_read_b128 v[152:155], v185 offset:24576
    s_add_u32 m0, s52, 2048
    s_nop 0
    buffer_load_dwordx4 v198, s[12:15], s47 offen lds
    s_waitcnt lgkmcnt(3)
    v_mfma_f32_32x32x16_bf16 v[52:67], v[156:159], v[12:15], v[52:67]
    ds_read_b128 v[156:159], v186 offset:24576
    s_waitcnt lgkmcnt(3)
    v_mfma_f32_32x32x16_bf16 v[52:67], v[160:163], v[16:19], v[52:67]
    ds_read_b128 v[160:163], v187 offset:24576
    s_waitcnt lgkmcnt(3)
    v_mfma_f32_32x32x16_bf16 v[52:67], v[148:151], v[20:23], v[52:67]
    ds_read_b64_tr_b16 v[164:165], v188 offset:32768
    ds_read_b64_tr_b16 v[166:167], v188 offset:34816
    s_waitcnt lgkmcnt(4)
    v_mfma_f32_32x32x16_bf16 v[52:67], v[152:155], v[24:27], v[52:67]
    ds_read_b64_tr_b16 v[168:169], v188 offset:36864
    ds_read_b64_tr_b16 v[170:171], v188 offset:38912
    s_add_u32 m0, s52, 3072
    s_nop 0
    buffer_load_dwordx4 v199, s[12:15], s47 offen lds
    s_add_u32 s47, s47, 16384
    s_waitcnt lgkmcnt(5)
    v_mfma_f32_32x32x16_bf16 v[52:67], v[156:159], v[28:31], v[52:67]
    ds_read_b64_tr_b16 v[172:173], v188 offset:40960
    ds_read_b64_tr_b16 v[174:175], v188 offset:43008
    s_waitcnt lgkmcnt(6)
    v_mfma_f32_32x32x16_bf16 v[52:67], v[160:163], v[32:35], v[52:67]
    ds_read_b64_tr_b16 v[176:177], v188 offset:45056
    ds_read_b64_tr_b16 v[178:179], v188 offset:47104
    s_waitcnt lgkmcnt(6)
    v_mfma_f32_32x32x16_bf16 v[68:83], v[164:167], v[132:135], v[68:83]
    ds_read_b64_tr_b16 v[164:165], v189 offset:32768
    ds_read_b64_tr_b16 v[166:167], v189 offset:34816
    v_cvt_pk_bf16_f32 v36, 0, v36
    v_cvt_pk_bf16_f32 v37, 0, v37
    v_cvt_pk_bf16_f32 v38, 0, v38
    v_cvt_pk_bf16_f32 v39, 0, v39
    v_cvt_pk_bf16_f32 v40, 0, v40
    v_cvt_pk_bf16_f32 v41, 0, v41
    v_cvt_pk_bf16_f32 v42, 0, v42
    s_waitcnt lgkmcnt(6)
    v_mfma_f32_32x32x16_bf16 v[68:83], v[168:171], v[136:139], v[68:83]
    ds_read_b64_tr_b16 v[168:169], v189 offset:36864
    ds_read_b64_tr_b16 v[170:171], v189 offset:38912
    v_cvt_pk_bf16_f32 v43, 0, v43
    v_mul_f32 v36, v217, v36
    v_mul_f32 v37, v217, v37
    v_mul_f32 v38, v217, v38
    v_mul_f32 v39, v217, v39
    v_mul_f32 v40, v217, v40
    v_mul_f32 v41, v217, v41
    s_waitcnt lgkmcnt(6)
    v_mfma_f32_32x32x16_bf16 v[68:83], v[172:175], v[140:143], v[68:83]
    ds_read_b64_tr_b16 v[172:173], v189 offset:40960
    ds_read_b64_tr_b16 v[174:175], v189 offset:43008
    v_mul_f32 v42, v217, v42
    v_mul_f32 v43, v217, v43
    v_cvt_pk_bf16_f32 v36, 0, v36
    v_cvt_pk_bf16_f32 v37, 0, v37
    v_cvt_pk_bf16_f32 v38, 0, v38
    v_cvt_pk_bf16_f32 v39, 0, v39
    v_cvt_pk_bf16_f32 v40, 0, v40
    s_waitcnt lgkmcnt(6)
    v_mfma_f32_32x32x16_bf16 v[68:83], v[176:179], v[144:147], v[68:83]
    ds_read_b64_tr_b16 v[176:177], v189 offset:45056
    ds_read_b64_tr_b16 v[178:179], v189 offset:47104
    v_cvt_pk_bf16_f32 v41, 0, v41
    v_cvt_pk_bf16_f32 v42, 0, v42
    v_cvt_pk_bf16_f32 v43, 0, v43
    v_cvt_pk_bf16_f32 v44, 0, v44
    v_cvt_pk_bf16_f32 v45, 0, v45
    v_cvt_pk_bf16_f32 v46, 0, v46
    v_cvt_pk_bf16_f32 v47, 0, v47
    s_waitcnt lgkmcnt(6)
    v_mfma_f32_32x32x16_bf16 v[84:99], v[164:167], v[132:135], v[84:99]
    ds_read_b64_tr_b16 v[164:165], v190 offset:32768
    ds_read_b64_tr_b16 v[166:167], v190 offset:34816
    v_cvt_pk_bf16_f32 v48, 0, v48
    v_cvt_pk_bf16_f32 v49, 0, v49
    v_cvt_pk_bf16_f32 v50, 0, v50
    v_cvt_pk_bf16_f32 v51, 0, v51
    v_mul_f32 v44, v217, v44
    v_mul_f32 v45, v217, v45
    v_mul_f32 v46, v217, v46
    s_waitcnt lgkmcnt(6)
    v_mfma_f32_32x32x16_bf16 v[84:99], v[168:171], v[136:139], v[84:99]
    ds_read_b64_tr_b16 v[168:169], v190 offset:36864
    ds_read_b64_tr_b16 v[170:171], v190 offset:38912
    v_mul_f32 v47, v217, v47
    v_mul_f32 v48, v217, v48
    v_mul_f32 v49, v217, v49
    v_mul_f32 v50, v217, v50
    v_mul_f32 v51, v217, v51
    v_cvt_pk_bf16_f32 v44, 0, v44
    v_cvt_pk_bf16_f32 v45, 0, v45
    s_waitcnt lgkmcnt(6)
    v_mfma_f32_32x32x16_bf16 v[84:99], v[172:175], v[140:143], v[84:99]
    ds_read_b64_tr_b16 v[172:173], v190 offset:40960
    ds_read_b64_tr_b16 v[174:175], v190 offset:43008
    v_cvt_pk_bf16_f32 v46, 0, v46
    v_cvt_pk_bf16_f32 v47, 0, v47
    v_cvt_pk_bf16_f32 v48, 0, v48
    v_cvt_pk_bf16_f32 v49, 0, v49
    v_cvt_pk_bf16_f32 v50, 0, v50
    v_cvt_pk_bf16_f32 v51, 0, v51
    v_cvt_pk_bf16_f32 v52, 0, v52
    s_waitcnt lgkmcnt(6)
    v_mfma_f32_32x32x16_bf16 v[84:99], v[176:179], v[144:147], v[84:99]
    ds_read_b64_tr_b16 v[176:177], v190 offset:45056
    ds_read_b64_tr_b16 v[178:179], v190 offset:47104
    v_cvt_pk_bf16_f32 v53, 0, v53
    v_cvt_pk_bf16_f32 v54, 0, v54
    v_cvt_pk_bf16_f32 v55, 0, v55
    v_cvt_pk_bf16_f32 v56, 0, v56
    v_cvt_pk_bf16_f32 v57, 0, v57
    v_cvt_pk_bf16_f32 v58, 0, v58
    v_cvt_pk_bf16_f32 v59, 0, v59
    s_waitcnt lgkmcnt(6)
    v_mfma_f32_32x32x16_bf16 v[100:115], v[164:167], v[132:135], v[100:115]
    ds_read_b64_tr_b16 v[164:165], v191 offset:32768
    ds_read_b64_tr_b16 v[166:167], v191 offset:34816
    v_mul_f32 v52, v217, v52
    v_mul_f32 v53, v217, v53
    v_mul_f32 v54, v217, v54
    v_mul_f32 v55, v217, v55
    v_mul_f32 v56, v217, v56
    v_mul_f32 v57, v217, v57
    v_mul_f32 v58, v217, v58
    s_waitcnt lgkmcnt(6)
    v_mfma_f32_32x32x16_bf16 v[100:115], v[168:171], v[136:139], v[100:115]
    ds_read_b64_tr_b16 v[168:169], v191 offset:36864
    ds_read_b64_tr_b16 v[170:171], v191 offset:38912
    v_mul_f32 v59, v217, v59
    v_cvt_pk_bf16_f32 v52, 0, v52
    v_cvt_pk_bf16_f32 v53, 0, v53
    v_cvt_pk_bf16_f32 v54, 0, v54
    v_cvt_pk_bf16_f32 v55, 0, v55
    v_cvt_pk_bf16_f32 v56, 0, v56
    v_cvt_pk_bf16_f32 v57, 0, v57
    s_waitcnt lgkmcnt(6)
    v_mfma_f32_32x32x16_bf16 v[100:115], v[172:175], v[140:143], v[100:115]
    ds_read_b64_tr_b16 v[172:173], v191 offset:40960
    ds_read_b64_tr_b16 v[174:175], v191 offset:43008
    v_cvt_pk_bf16_f32 v58, 0, v58
    v_cvt_pk_bf16_f32 v59, 0, v59
    v_cvt_pk_bf16_f32 v60, 0, v60
    v_cvt_pk_bf16_f32 v61, 0, v61
    v_cvt_pk_bf16_f32 v62, 0, v62
    v_cvt_pk_bf16_f32 v63, 0, v63
    v_cvt_pk_bf16_f32 v64, 0, v64
    s_waitcnt lgkmcnt(6)
    v_mfma_f32_32x32x16_bf16 v[100:115], v[176:179], v[144:147], v[100:115]
    ds_read_b64_tr_b16 v[176:177], v191 offset:45056
    ds_read_b64_tr_b16 v[178:179], v191 offset:47104
    v_cvt_pk_bf16_f32 v65, 0, v65
    v_cvt_pk_bf16_f32 v66, 0, v66
    v_cvt_pk_bf16_f32 v67, 0, v67
    v_mul_f32 v60, v217, v60
    v_mul_f32 v61, v217, v61
    v_mul_f32 v62, v217, v62
    v_mul_f32 v63, v217, v63
    s_waitcnt lgkmcnt(6)
    v_mfma_f32_32x32x16_bf16 v[116:131], v[164:167], v[132:135], v[116:131]
    v_mul_f32 v64, v217, v64
    v_mul_f32 v65, v217, v65
    v_mul_f32 v66, v217, v66
    v_mul_f32 v67, v217, v67
    v_cvt_pk_bf16_f32 v60, 0, v60
    v_cvt_pk_bf16_f32 v61, 0, v61
    v_cvt_pk_bf16_f32 v62, 0, v62
    s_waitcnt lgkmcnt(4)
    v_mfma_f32_32x32x16_bf16 v[116:131], v[168:171], v[136:139], v[116:131]
    v_cvt_pk_bf16_f32 v63, 0, v63
    v_cvt_pk_bf16_f32 v64, 0, v64
    v_cvt_pk_bf16_f32 v65, 0, v65
    v_cvt_pk_bf16_f32 v66, 0, v66
    v_cvt_pk_bf16_f32 v67, 0, v67
    v_max3_f32 v204, v36, v37, v38
    v_max3_f32 v205, v44, v45, v46
    s_waitcnt lgkmcnt(2)
    v_mfma_f32_32x32x16_bf16 v[116:131], v[172:175], v[140:143], v[116:131]
    v_max3_f32 v206, v52, v53, v54
    v_max3_f32 v207, v60, v61, v62
    v_max3_f32 v204, v204, v39, v40
    v_max3_f32 v205, v205, v47, v48
    v_max3_f32 v206, v206, v55, v56
    v_max3_f32 v207, v207, v63, v64
    v_max3_f32 v204, v204, v41, v42
    s_waitcnt lgkmcnt(0)
    v_mfma_f32_32x32x16_bf16 v[116:131], v[176:179], v[144:147], v[116:131]
    v_max3_f32 v205, v205, v49, v50
    v_max3_f32 v206, v206, v57, v58
    v_max3_f32 v207, v207, v65, v66
    v_max3_f32 v204, v204, v43, v51
    v_max3_f32 v206, v206, v59, v67
    v_max3_f32 v204, v204, v205, v206
    v_max_f32 v204, v204, v207
    s_setprio 0
    s_barrier
    v_mov_b32 v205, v204
    s_nop 1
    v_permlane32_swap_b32 v204, v205
    v_max_f32 v204, v204, v205
    v_sub_f32 v205, v204, v200
    v_cmp_lt_f32 vcc, v218, v205
    s_cbranch_vccz L_attn_kernel_nr7
    v_max_f32 v204, v204, v200
    v_mul_f32 v203, v216, v204
    v_fma_f32 v205, v200, v216, -v203
    v_exp_f32 v202, v205
    v_mov_b32 v200, v204
    v_mul_f32 v201, v202, v201
    v_mul_f32 v68, v202, v68
    v_mul_f32 v69, v202, v69
    v_mul_f32 v70, v202, v70
    v_mul_f32 v71, v202, v71
    v_mul_f32 v72, v202, v72
    v_mul_f32 v73, v202, v73
    v_mul_f32 v74, v202, v74
    v_mul_f32 v75, v202, v75
    v_mul_f32 v76, v202, v76
    v_mul_f32 v77, v202, v77
    v_mul_f32 v78, v202, v78
    v_mul_f32 v79, v202, v79
    v_mul_f32 v80, v202, v80
    v_mul_f32 v81, v202, v81
    v_mul_f32 v82, v202, v82
    v_mul_f32 v83, v202, v83
    v_mul_f32 v84, v202, v84
    v_mul_f32 v85, v202, v85
    v_mul_f32 v86, v202, v86
    v_mul_f32 v87, v202, v87
    v_mul_f32 v88, v202, v88
    v_mul_f32 v89, v202, v89
    v_mul_f32 v90, v202, v90
    v_mul_f32 v91, v202, v91
    v_mul_f32 v92, v202, v92
    v_mul_f32 v93, v202, v93
    v_mul_f32 v94, v202, v94
    v_mul_f32 v95, v202, v95
    v_mul_f32 v96, v202, v96
    v_mul_f32 v97, v202, v97
    v_mul_f32 v98, v202, v98
    v_mul_f32 v99, v202, v99
    v_mul_f32 v100, v202, v100
    v_mul_f32 v101, v202, v101
    v_mul_f32 v102, v202, v102
    v_mul_f32 v103, v202, v103
    v_mul_f32 v104, v202, v104
    v_mul_f32 v105, v202, v105
    v_mul_f32 v106, v202, v106
    v_mul_f32 v107, v202, v107
    v_mul_f32 v108, v202, v108
    v_mul_f32 v109, v202, v109
    v_mul_f32 v110, v202, v110
    v_mul_f32 v111, v202, v111
    v_mul_f32 v112, v202, v112
    v_mul_f32 v113, v202, v113
    v_mul_f32 v114, v202, v114
    v_mul_f32 v115, v202, v115
    v_mul_f32 v116, v202, v116
    v_mul_f32 v117, v202, v117
    v_mul_f32 v118, v202, v118
    v_mul_f32 v119, v202, v119
    v_mul_f32 v120, v202, v120
    v_mul_f32 v121, v202, v121
    v_mul_f32 v122, v202, v122
    v_mul_f32 v123, v202, v123
    v_mul_f32 v124, v202, v124
    v_mul_f32 v125, v202, v125
    v_mul_f32 v126, v202, v126
    v_mul_f32 v127, v202, v127
    v_mul_f32 v128, v202, v128
    v_mul_f32 v129, v202, v129
    v_mul_f32 v130, v202, v130
    v_mul_f32 v131, v202, v131
L_attn_kernel_nr7:
    v_fma_f32 v36, v36, v216, -v203
    v_fma_f32 v37, v37, v216, -v203
    v_fma_f32 v38, v38, v216, -v203
    v_fma_f32 v39, v39, v216, -v203
    v_fma_f32 v40, v40, v216, -v203
    v_fma_f32 v41, v41, v216, -v203
    v_fma_f32 v42, v42, v216, -v203
    v_fma_f32 v43, v43, v216, -v203
    v_exp_f32 v36, v36
    v_exp_f32 v37, v37
    v_exp_f32 v38, v38
    v_exp_f32 v39, v39
    v_exp_f32 v40, v40
    v_exp_f32 v41, v41
    v_exp_f32 v42, v42
    v_exp_f32 v43, v43
    v_fma_f32 v44, v44, v216, -v203
    v_fma_f32 v45, v45, v216, -v203
    v_fma_f32 v46, v46, v216, -v203
    v_fma_f32 v47, v47, v216, -v203
    v_fma_f32 v48, v48, v216, -v203
    v_fma_f32 v49, v49, v216, -v203
    v_fma_f32 v50, v50, v216, -v203
    v_fma_f32 v51, v51, v216, -v203
    v_exp_f32 v44, v44
    v_exp_f32 v45, v45
    v_exp_f32 v46, v46
    v_exp_f32 v47, v47
    v_exp_f32 v48, v48
    v_exp_f32 v49, v49
    v_exp_f32 v50, v50
    v_exp_f32 v51, v51
    v_mov_b32 v212, v36
    v_mov_b32 v213, v37
    v_mov_b32 v214, v38
    v_mov_b32 v215, v39
    v_add_f32 v212, v212, v40
    v_add_f32 v213, v213, v41
    v_add_f32 v214, v214, v42
    v_add_f32 v215, v215, v43
    v_cvt_pk_bf16_f32 v132, v36, v37
    v_cvt_pk_bf16_f32 v133, v38, v39
    v_cvt_pk_bf16_f32 v134, v40, v41
    v_cvt_pk_bf16_f32 v135, v42, v43
    v_fma_f32 v52, v52, v216, -v203
    v_fma_f32 v53, v53, v216, -v203
    v_fma_f32 v54, v54, v216, -v203
    v_fma_f32 v55, v55, v216, -v203
    v_fma_f32 v56, v56, v216, -v203
    v_fma_f32 v57, v57, v216, -v203
    v_fma_f32 v58, v58, v216, -v203
    v_fma_f32 v59, v59, v216, -v203
    v_exp_f32 v52, v52
    v_exp_f32 v53, v53
    v_exp_f32 v54, v54
    v_exp_f32 v55, v55
    v_exp_f32 v56, v56
    v_exp_f32 v57, v57
    v_exp_f32 v58, v58
    v_exp_f32 v59, v59
    v_add_f32 v212, v212, v44
    v_add_f32 v213, v213, v45
    v_add_f32 v214, v214, v46
    v_add_f32 v215, v215, v47
    v_add_f32 v212, v212, v48
    v_add_f32 v213, v213, v49
    v_add_f32 v214, v214, v50
    v_add_f32 v215, v215, v51
    v_cvt_pk_bf16_f32 v136, v44, v45
    v_cvt_pk_bf16_f32 v137, v46, v47
    v_cvt_pk_bf16_f32 v138, v48, v49
    v_cvt_pk_bf16_f32 v139, v50, v51
    v_fma_f32 v60, v60, v216, -v203
    v_fma_f32 v61, v61, v216, -v203
    v_fma_f32 v62, v62, v216, -v203
    v_fma_f32 v63, v63, v216, -v203
    v_fma_f32 v64, v64, v216, -v203
    v_fma_f32 v65, v65, v216, -v203
    v_fma_f32 v66, v66, v216, -v203
    v_fma_f32 v67, v67, v216, -v203
    v_exp_f32 v60, v60
    v_exp_f32 v61, v61
    v_exp_f32 v62, v62
    v_exp_f32 v63, v63
    v_exp_f32 v64, v64
    v_exp_f32 v65, v65
    v_exp_f32 v66, v66
    v_exp_f32 v67, v67
    v_add_f32 v212, v212, v52
    v_add_f32 v213, v213, v53
    v_add_f32 v214, v214, v54
    v_add_f32 v215, v215, v55
    v_add_f32 v212, v212, v56
    v_add_f32 v213, v213, v57
    v_add_f32 v214, v214, v58
    v_add_f32 v215, v215, v59
    v_cvt_pk_bf16_f32 v140, v52, v53
    v_cvt_pk_bf16_f32 v141, v54, v55
    v_cvt_pk_bf16_f32 v142, v56, v57
    v_cvt_pk_bf16_f32 v143, v58, v59
    v_add_f32 v212, v212, v60
    v_add_f32 v213, v213, v61
    v_add_f32 v214, v214, v62
    v_add_f32 v215, v215, v63
    v_add_f32 v212, v212, v64
    v_add_f32 v213, v213, v65
    v_add_f32 v214, v214, v66
    v_add_f32 v215, v215, v67
    v_cvt_pk_bf16_f32 v144, v60, v61
    v_cvt_pk_bf16_f32 v145, v62, v63
    v_cvt_pk_bf16_f32 v146, v64, v65
    v_cvt_pk_bf16_f32 v147, v66, v67
    v_add_f32 v212, v212, v213
    v_add_f32 v214, v214, v215
    v_add_f32 v212, v212, v214
    v_add_f32 v201, v201, v212
    ds_read_b128 v[148:151], v180 offset:32768
    ds_read_b128 v[152:155], v181 offset:32768
    ds_read_b128 v[156:159], v182 offset:32768
    ds_read_b128 v[160:163], v183 offset:32768
    s_waitcnt vmcnt(4)
    s_barrier
    s_setprio 3
    s_waitcnt lgkmcnt(3)
    v_mfma_f32_32x32x16_bf16 v[36:51], v[148:151], v[4:7], 0
    ds_read_b128 v[148:151], v184 offset:32768
    s_waitcnt lgkmcnt(3)
    v_mfma_f32_32x32x16_bf16 v[36:51], v[152:155], v[8:11], v[36:51]
    ds_read_b128 v[152:155], v185 offset:32768
    s_add_u32 s52, s46, 16384
    s_add_u32 m0, s52, 0
    s_nop 0
    buffer_load_dwordx4 v196, s[12:15], s47 offen lds
    s_waitcnt lgkmcnt(3)
    v_mfma_f32_32x32x16_bf16 v[36:51], v[156:159], v[12:15], v[36:51]
    ds_read_b128 v[156:159], v186 offset:32768
    s_waitcnt lgkmcnt(3)
    v_mfma_f32_32x32x16_bf16 v[36:51], v[160:163], v[16:19], v[36:51]
    ds_read_b128 v[160:163], v187 offset:32768
    s_waitcnt lgkmcnt(3)
    v_mfma_f32_32x32x16_bf16 v[36:51], v[148:151], v[20:23], v[36:51]
    ds_read_b128 v[148:151], v180 offset:40960
    s_waitcnt lgkmcnt(3)
    v_mfma_f32_32x32x16_bf16 v[36:51], v[152:155], v[24:27], v[36:51]
    ds_read_b128 v[152:155], v181 offset:40960
    s_add_u32 m0, s52, 1024
    s_nop 0
    buffer_load_dwordx4 v197, s[12:15], s47 offen lds
    s_waitcnt lgkmcnt(3)
    v_mfma_f32_32x32x16_bf16 v[36:51], v[156:159], v[28:31], v[36:51]
    ds_read_b128 v[156:159], v182 offset:40960
    s_waitcnt lgkmcnt(3)
    v_mfma_f32_32x32x16_bf16 v[36:51], v[160:163], v[32:35], v[36:51]
    ds_read_b128 v[160:163], v183 offset:40960
    s_waitcnt lgkmcnt(3)
    v_mfma_f32_32x32x16_bf16 v[52:67], v[148:151], v[4:7], 0
    ds_read_b128 v[148:151], v184 offset:40960
    s_waitcnt lgkmcnt(3)
    v_mfma_f32_32x32x16_bf16 v[52:67], v[152:155], v[8:11], v[52:67]
    ds_read_b128 v[152:155], v185 offset:40960
    s_add_u32 m0, s52, 2048
    s_nop 0
    buffer_load_dwordx4 v198, s[12:15], s47 offen lds
    s_waitcnt lgkmcnt(3)
    v_mfma_f32_32x32x16_bf16 v[52:67], v[156:159], v[12:15], v[52:67]
    ds_read_b128 v[156:159], v186 offset:40960
    s_waitcnt lgkmcnt(3)
    v_mfma_f32_32x32x16_bf16 v[52:67], v[160:163], v[16:19], v[52:67]
    ds_read_b128 v[160:163], v187 offset:40960
    s_waitcnt lgkmcnt(3)
    v_mfma_f32_32x32x16_bf16 v[52:67], v[148:151], v[20:23], v[52:67]
    ds_read_b64_tr_b16 v[164:165], v188 offset:49152
    ds_read_b64_tr_b16 v[166:167], v188 offset:51200
    s_waitcnt lgkmcnt(4)
    v_mfma_f32_32x32x16_bf16 v[52:67], v[152:155], v[24:27], v[52:67]
    ds_read_b64_tr_b16 v[168:169], v188 offset:53248
    ds_read_b64_tr_b16 v[170:171], v188 offset:55296
    s_add_u32 m0, s52, 3072
    s_nop 0
    buffer_load_dwordx4 v199, s[12:15], s47 offen lds
    s_add_u32 s47, s47, 16384
    s_waitcnt lgkmcnt(5)
    v_mfma_f32_32x32x16_bf16 v[52:67], v[156:159], v[28:31], v[52:67]
    ds_read_b64_tr_b16 v[172:173], v188 offset:57344
    ds_read_b64_tr_b16 v[174:175], v188 offset:59392
    s_waitcnt lgkmcnt(6)
    v_mfma_f32_32x32x16_bf16 v[52:67], v[160:163], v[32:35], v[52:67]
    ds_read_b64_tr_b16 v[176:177], v188 offset:61440
    ds_read_b64_tr_b16 v[178:179], v188 offset:63488
    s_waitcnt lgkmcnt(6)
    v_mfma_f32_32x32x16_bf16 v[68:83], v[164:167], v[132:135], v[68:83]
    ds_read_b64_tr_b16 v[164:165], v189 offset:49152
    ds_read_b64_tr_b16 v[166:167], v189 offset:51200
    v_cvt_pk_bf16_f32 v36, 0, v36
    v_cvt_pk_bf16_f32 v37, 0, v37
    v_cvt_pk_bf16_f32 v38, 0, v38
    v_cvt_pk_bf16_f32 v39, 0, v39
    v_cvt_pk_bf16_f32 v40, 0, v40
    v_cvt_pk_bf16_f32 v41, 0, v41
    v_cvt_pk_bf16_f32 v42, 0, v42
    s_waitcnt lgkmcnt(6)
    v_mfma_f32_32x32x16_bf16 v[68:83], v[168:171], v[136:139], v[68:83]
    ds_read_b64_tr_b16 v[168:169], v189 offset:53248
    ds_read_b64_tr_b16 v[170:171], v189 offset:55296
    v_cvt_pk_bf16_f32 v43, 0, v43
    v_mul_f32 v36, v217, v36
    v_mul_f32 v37, v217, v37
    v_mul_f32 v38, v217, v38
    v_mul_f32 v39, v217, v39
    v_mul_f32 v40, v217, v40
    v_mul_f32 v41, v217, v41
    s_waitcnt lgkmcnt(6)
    v_mfma_f32_32x32x16_bf16 v[68:83], v[172:175], v[140:143], v[68:83]
    ds_read_b64_tr_b16 v[172:173], v189 offset:57344
    ds_read_b64_tr_b16 v[174:175], v189 offset:59392
    v_mul_f32 v42, v217, v42
    v_mul_f32 v43, v217, v43
    v_cvt_pk_bf16_f32 v36, 0, v36
    v_cvt_pk_bf16_f32 v37, 0, v37
    v_cvt_pk_bf16_f32 v38, 0, v38
    v_cvt_pk_bf16_f32 v39, 0, v39
    v_cvt_pk_bf16_f32 v40, 0, v40
    s_waitcnt lgkmcnt(6)
    v_mfma_f32_32x32x16_bf16 v[68:83], v[176:179], v[144:147], v[68:83]
    ds_read_b64_tr_b16 v[176:177], v189 offset:61440
    ds_read_b64_tr_b16 v[178:179], v189 offset:63488
    v_cvt_pk_bf16_f32 v41, 0, v41
    v_cvt_pk_bf16_f32 v42, 0, v42
    v_cvt_pk_bf16_f32 v43, 0, v43
    v_cvt_pk_bf16_f32 v44, 0, v44
    v_cvt_pk_bf16_f32 v45, 0, v45
    v_cvt_pk_bf16_f32 v46, 0, v46
    v_cvt_pk_bf16_f32 v47, 0, v47
    s_waitcnt lgkmcnt(6)
    v_mfma_f32_32x32x16_bf16 v[84:99], v[164:167], v[132:135], v[84:99]
    ds_read_b64_tr_b16 v[164:165], v190 offset:49152
    ds_read_b64_tr_b16 v[166:167], v190 offset:51200
    v_cvt_pk_bf16_f32 v48, 0, v48
    v_cvt_pk_bf16_f32 v49, 0, v49
    v_cvt_pk_bf16_f32 v50, 0, v50
    v_cvt_pk_bf16_f32 v51, 0, v51
    v_mul_f32 v44, v217, v44
    v_mul_f32 v45, v217, v45
    v_mul_f32 v46, v217, v46
    s_waitcnt lgkmcnt(6)
    v_mfma_f32_32x32x16_bf16 v[84:99], v[168:171], v[136:139], v[84:99]
    ds_read_b64_tr_b16 v[168:169], v190 offset:53248
    ds_read_b64_tr_b16 v[170:171], v190 offset:55296
    v_mul_f32 v47, v217, v47
    v_mul_f32 v48, v217, v48
    v_mul_f32 v49, v217, v49
    v_mul_f32 v50, v217, v50
    v_mul_f32 v51, v217, v51
    v_cvt_pk_bf16_f32 v44, 0, v44
    v_cvt_pk_bf16_f32 v45, 0, v45
    s_waitcnt lgkmcnt(6)
    v_mfma_f32_32x32x16_bf16 v[84:99], v[172:175], v[140:143], v[84:99]
    ds_read_b64_tr_b16 v[172:173], v190 offset:57344
    ds_read_b64_tr_b16 v[174:175], v190 offset:59392
    v_cvt_pk_bf16_f32 v46, 0, v46
    v_cvt_pk_bf16_f32 v47, 0, v47
    v_cvt_pk_bf16_f32 v48, 0, v48
    v_cvt_pk_bf16_f32 v49, 0, v49
    v_cvt_pk_bf16_f32 v50, 0, v50
    v_cvt_pk_bf16_f32 v51, 0, v51
    v_cvt_pk_bf16_f32 v52, 0, v52
    s_waitcnt lgkmcnt(6)
    v_mfma_f32_32x32x16_bf16 v[84:99], v[176:179], v[144:147], v[84:99]
    ds_read_b64_tr_b16 v[176:177], v190 offset:61440
    ds_read_b64_tr_b16 v[178:179], v190 offset:63488
    v_cvt_pk_bf16_f32 v53, 0, v53
    v_cvt_pk_bf16_f32 v54, 0, v54
    v_cvt_pk_bf16_f32 v55, 0, v55
    v_cvt_pk_bf16_f32 v56, 0, v56
    v_cvt_pk_bf16_f32 v57, 0, v57
    v_cvt_pk_bf16_f32 v58, 0, v58
    v_cvt_pk_bf16_f32 v59, 0, v59
    s_waitcnt lgkmcnt(6)
    v_mfma_f32_32x32x16_bf16 v[100:115], v[164:167], v[132:135], v[100:115]
    ds_read_b64_tr_b16 v[164:165], v191 offset:49152
    ds_read_b64_tr_b16 v[166:167], v191 offset:51200
    v_mul_f32 v52, v217, v52
    v_mul_f32 v53, v217, v53
    v_mul_f32 v54, v217, v54
    v_mul_f32 v55, v217, v55
    v_mul_f32 v56, v217, v56
    v_mul_f32 v57, v217, v57
    v_mul_f32 v58, v217, v58
    s_waitcnt lgkmcnt(6)
    v_mfma_f32_32x32x16_bf16 v[100:115], v[168:171], v[136:139], v[100:115]
    ds_read_b64_tr_b16 v[168:169], v191 offset:53248
    ds_read_b64_tr_b16 v[170:171], v191 offset:55296
    v_mul_f32 v59, v217, v59
    v_cvt_pk_bf16_f32 v52, 0, v52
    v_cvt_pk_bf16_f32 v53, 0, v53
    v_cvt_pk_bf16_f32 v54, 0, v54
    v_cvt_pk_bf16_f32 v55, 0, v55
    v_cvt_pk_bf16_f32 v56, 0, v56
    v_cvt_pk_bf16_f32 v57, 0, v57
    s_waitcnt lgkmcnt(6)
    v_mfma_f32_32x32x16_bf16 v[100:115], v[172:175], v[140:143], v[100:115]
    ds_read_b64_tr_b16 v[172:173], v191 offset:57344
    ds_read_b64_tr_b16 v[174:175], v191 offset:59392
    v_cvt_pk_bf16_f32 v58, 0, v58
    v_cvt_pk_bf16_f32 v59, 0, v59
    v_cvt_pk_bf16_f32 v60, 0, v60
    v_cvt_pk_bf16_f32 v61, 0, v61
    v_cvt_pk_bf16_f32 v62, 0, v62
    v_cvt_pk_bf16_f32 v63, 0, v63
    v_cvt_pk_bf16_f32 v64, 0, v64
    s_waitcnt lgkmcnt(6)
    v_mfma_f32_32x32x16_bf16 v[100:115], v[176:179], v[144:147], v[100:115]
    ds_read_b64_tr_b16 v[176:177], v191 offset:61440
    ds_read_b64_tr_b16 v[178:179], v191 offset:63488
    v_cvt_pk_bf16_f32 v65, 0, v65
    v_cvt_pk_bf16_f32 v66, 0, v66
    v_cvt_pk_bf16_f32 v67, 0, v67
    v_mul_f32 v60, v217, v60
    v_mul_f32 v61, v217, v61
    v_mul_f32 v62, v217, v62
    v_mul_f32 v63, v217, v63
    s_waitcnt lgkmcnt(6)
    v_mfma_f32_32x32x16_bf16 v[116:131], v[164:167], v[132:135], v[116:131]
    v_mul_f32 v64, v217, v64
    v_mul_f32 v65, v217, v65
    v_mul_f32 v66, v217, v66
    v_mul_f32 v67, v217, v67
    v_cvt_pk_bf16_f32 v60, 0, v60
    v_cvt_pk_bf16_f32 v61, 0, v61
    v_cvt_pk_bf16_f32 v62, 0, v62
    s_waitcnt lgkmcnt(4)
    v_mfma_f32_32x32x16_bf16 v[116:131], v[168:171], v[136:139], v[116:131]
    v_cvt_pk_bf16_f32 v63, 0, v63
    v_cvt_pk_bf16_f32 v64, 0, v64
    v_cvt_pk_bf16_f32 v65, 0, v65
    v_cvt_pk_bf16_f32 v66, 0, v66
    v_cvt_pk_bf16_f32 v67, 0, v67
    v_max3_f32 v204, v36, v37, v38
    v_max3_f32 v205, v44, v45, v46
    s_waitcnt lgkmcnt(2)
    v_mfma_f32_32x32x16_bf16 v[116:131], v[172:175], v[140:143], v[116:131]
    v_max3_f32 v206, v52, v53, v54
    v_max3_f32 v207, v60, v61, v62
    v_max3_f32 v204, v204, v39, v40
    v_max3_f32 v205, v205, v47, v48
    v_max3_f32 v206, v206, v55, v56
    v_max3_f32 v207, v207, v63, v64
    v_max3_f32 v204, v204, v41, v42
    s_waitcnt lgkmcnt(0)
    v_mfma_f32_32x32x16_bf16 v[116:131], v[176:179], v[144:147], v[116:131]
    v_max3_f32 v205, v205, v49, v50
    v_max3_f32 v206, v206, v57, v58
    v_max3_f32 v207, v207, v65, v66
    v_max3_f32 v204, v204, v43, v51
    v_max3_f32 v206, v206, v59, v67
    v_max3_f32 v204, v204, v205, v206
    v_max_f32 v204, v204, v207
    s_setprio 0
    s_barrier
    v_mov_b32 v205, v204
    s_nop 1
    v_permlane32_swap_b32 v204, v205
    v_max_f32 v204, v204, v205
    v_sub_f32 v205, v204, v200
    v_cmp_lt_f32 vcc, v218, v205
    s_cbranch_vccz L_attn_kernel_nr8
    v_max_f32 v204, v204, v200
    v_mul_f32 v203, v216, v204
    v_fma_f32 v205, v200, v216, -v203
    v_exp_f32 v202, v205
    v_mov_b32 v200, v204
    v_mul_f32 v201, v202, v201
    v_mul_f32 v68, v202, v68
    v_mul_f32 v69, v202, v69
    v_mul_f32 v70, v202, v70
    v_mul_f32 v71, v202, v71
    v_mul_f32 v72, v202, v72
    v_mul_f32 v73, v202, v73
    v_mul_f32 v74, v202, v74
    v_mul_f32 v75, v202, v75
    v_mul_f32 v76, v202, v76
    v_mul_f32 v77, v202, v77
    v_mul_f32 v78, v202, v78
    v_mul_f32 v79, v202, v79
    v_mul_f32 v80, v202, v80
    v_mul_f32 v81, v202, v81
    v_mul_f32 v82, v202, v82
    v_mul_f32 v83, v202, v83
    v_mul_f32 v84, v202, v84
    v_mul_f32 v85, v202, v85
    v_mul_f32 v86, v202, v86
    v_mul_f32 v87, v202, v87
    v_mul_f32 v88, v202, v88
    v_mul_f32 v89, v202, v89
    v_mul_f32 v90, v202, v90
    v_mul_f32 v91, v202, v91
    v_mul_f32 v92, v202, v92
    v_mul_f32 v93, v202, v93
    v_mul_f32 v94, v202, v94
    v_mul_f32 v95, v202, v95
    v_mul_f32 v96, v202, v96
    v_mul_f32 v97, v202, v97
    v_mul_f32 v98, v202, v98
    v_mul_f32 v99, v202, v99
    v_mul_f32 v100, v202, v100
    v_mul_f32 v101, v202, v101
    v_mul_f32 v102, v202, v102
    v_mul_f32 v103, v202, v103
    v_mul_f32 v104, v202, v104
    v_mul_f32 v105, v202, v105
    v_mul_f32 v106, v202, v106
    v_mul_f32 v107, v202, v107
    v_mul_f32 v108, v202, v108
    v_mul_f32 v109, v202, v109
    v_mul_f32 v110, v202, v110
    v_mul_f32 v111, v202, v111
    v_mul_f32 v112, v202, v112
    v_mul_f32 v113, v202, v113
    v_mul_f32 v114, v202, v114
    v_mul_f32 v115, v202, v115
    v_mul_f32 v116, v202, v116
    v_mul_f32 v117, v202, v117
    v_mul_f32 v118, v202, v118
    v_mul_f32 v119, v202, v119
    v_mul_f32 v120, v202, v120
    v_mul_f32 v121, v202, v121
    v_mul_f32 v122, v202, v122
    v_mul_f32 v123, v202, v123
    v_mul_f32 v124, v202, v124
    v_mul_f32 v125, v202, v125
    v_mul_f32 v126, v202, v126
    v_mul_f32 v127, v202, v127
    v_mul_f32 v128, v202, v128
    v_mul_f32 v129, v202, v129
    v_mul_f32 v130, v202, v130
    v_mul_f32 v131, v202, v131
L_attn_kernel_nr8:
    v_fma_f32 v36, v36, v216, -v203
    v_fma_f32 v37, v37, v216, -v203
    v_fma_f32 v38, v38, v216, -v203
    v_fma_f32 v39, v39, v216, -v203
    v_fma_f32 v40, v40, v216, -v203
    v_fma_f32 v41, v41, v216, -v203
    v_fma_f32 v42, v42, v216, -v203
    v_fma_f32 v43, v43, v216, -v203
    v_exp_f32 v36, v36
    v_exp_f32 v37, v37
    v_exp_f32 v38, v38
    v_exp_f32 v39, v39
    v_exp_f32 v40, v40
    v_exp_f32 v41, v41
    v_exp_f32 v42, v42
    v_exp_f32 v43, v43
    v_fma_f32 v44, v44, v216, -v203
    v_fma_f32 v45, v45, v216, -v203
    v_fma_f32 v46, v46, v216, -v203
    v_fma_f32 v47, v47, v216, -v203
    v_fma_f32 v48, v48, v216, -v203
    v_fma_f32 v49, v49, v216, -v203
    v_fma_f32 v50, v50, v216, -v203
    v_fma_f32 v51, v51, v216, -v203
    v_exp_f32 v44, v44
    v_exp_f32 v45, v45
    v_exp_f32 v46, v46
    v_exp_f32 v47, v47
    v_exp_f32 v48, v48
    v_exp_f32 v49, v49
    v_exp_f32 v50, v50
    v_exp_f32 v51, v51
    v_mov_b32 v212, v36
    v_mov_b32 v213, v37
    v_mov_b32 v214, v38
    v_mov_b32 v215, v39
    v_add_f32 v212, v212, v40
    v_add_f32 v213, v213, v41
    v_add_f32 v214, v214, v42
    v_add_f32 v215, v215, v43
    v_cvt_pk_bf16_f32 v132, v36, v37
    v_cvt_pk_bf16_f32 v133, v38, v39
    v_cvt_pk_bf16_f32 v134, v40, v41
    v_cvt_pk_bf16_f32 v135, v42, v43
    v_fma_f32 v52, v52, v216, -v203
    v_fma_f32 v53, v53, v216, -v203
    v_fma_f32 v54, v54, v216, -v203
    v_fma_f32 v55, v55, v216, -v203
    v_fma_f32 v56, v56, v216, -v203
    v_fma_f32 v57, v57, v216, -v203
    v_fma_f32 v58, v58, v216, -v203
    v_fma_f32 v59, v59, v216, -v203
    v_exp_f32 v52, v52
    v_exp_f32 v53, v53
    v_exp_f32 v54, v54
    v_exp_f32 v55, v55
    v_exp_f32 v56, v56
    v_exp_f32 v57, v57
    v_exp_f32 v58, v58
    v_exp_f32 v59, v59
    v_add_f32 v212, v212, v44
    v_add_f32 v213, v213, v45
    v_add_f32 v214, v214, v46
    v_add_f32 v215, v215, v47
    v_add_f32 v212, v212, v48
    v_add_f32 v213, v213, v49
    v_add_f32 v214, v214, v50
    v_add_f32 v215, v215, v51
    v_cvt_pk_bf16_f32 v136, v44, v45
    v_cvt_pk_bf16_f32 v137, v46, v47
    v_cvt_pk_bf16_f32 v138, v48, v49
    v_cvt_pk_bf16_f32 v139, v50, v51
    v_fma_f32 v60, v60, v216, -v203
    v_fma_f32 v61, v61, v216, -v203
    v_fma_f32 v62, v62, v216, -v203
    v_fma_f32 v63, v63, v216, -v203
    v_fma_f32 v64, v64, v216, -v203
    v_fma_f32 v65, v65, v216, -v203
    v_fma_f32 v66, v66, v216, -v203
    v_fma_f32 v67, v67, v216, -v203
    v_exp_f32 v60, v60
    v_exp_f32 v61, v61
    v_exp_f32 v62, v62
    v_exp_f32 v63, v63
    v_exp_f32 v64, v64
    v_exp_f32 v65, v65
    v_exp_f32 v66, v66
    v_exp_f32 v67, v67
    v_add_f32 v212, v212, v52
    v_add_f32 v213, v213, v53
    v_add_f32 v214, v214, v54
    v_add_f32 v215, v215, v55
    v_add_f32 v212, v212, v56
    v_add_f32 v213, v213, v57
    v_add_f32 v214, v214, v58
    v_add_f32 v215, v215, v59
    v_cvt_pk_bf16_f32 v140, v52, v53
    v_cvt_pk_bf16_f32 v141, v54, v55
    v_cvt_pk_bf16_f32 v142, v56, v57
    v_cvt_pk_bf16_f32 v143, v58, v59
    v_add_f32 v212, v212, v60
    v_add_f32 v213, v213, v61
    v_add_f32 v214, v214, v62
    v_add_f32 v215, v215, v63
    v_add_f32 v212, v212, v64
    v_add_f32 v213, v213, v65
    v_add_f32 v214, v214, v66
    v_add_f32 v215, v215, v67
    v_cvt_pk_bf16_f32 v144, v60, v61
    v_cvt_pk_bf16_f32 v145, v62, v63
    v_cvt_pk_bf16_f32 v146, v64, v65
    v_cvt_pk_bf16_f32 v147, v66, v67
    v_add_f32 v212, v212, v213
    v_add_f32 v214, v214, v215
    v_add_f32 v212, v212, v214
    v_add_f32 v201, v201, v212
    ds_read_b64_tr_b16 v[164:165], v188 offset:0
    ds_read_b64_tr_b16 v[166:167], v188 offset:2048
    ds_read_b64_tr_b16 v[168:169], v188 offset:4096
    ds_read_b64_tr_b16 v[170:171], v188 offset:6144
    ds_read_b64_tr_b16 v[172:173], v188 offset:8192
    ds_read_b64_tr_b16 v[174:175], v188 offset:10240
    ds_read_b64_tr_b16 v[176:177], v188 offset:12288
    ds_read_b64_tr_b16 v[178:179], v188 offset:14336
    s_waitcnt vmcnt(0)
    s_barrier
    s_setprio 3
    s_waitcnt lgkmcnt(6)
    v_mfma_f32_32x32x16_bf16 v[68:83], v[164:167], v[132:135], v[68:83]
    ds_read_b64_tr_b16 v[164:165], v189 offset:0
    ds_read_b64_tr_b16 v[166:167], v189 offset:2048
    s_waitcnt lgkmcnt(6)
    v_mfma_f32_32x32x16_bf16 v[68:83], v[168:171], v[136:139], v[68:83]
    ds_read_b64_tr_b16 v[168:169], v189 offset:4096
    ds_read_b64_tr_b16 v[170:171], v189 offset:6144
    s_waitcnt lgkmcnt(6)
    v_mfma_f32_32x32x16_bf16 v[68:83], v[172:175], v[140:143], v[68:83]
    ds_read_b64_tr_b16 v[172:173], v189 offset:8192
    ds_read_b64_tr_b16 v[174:175], v189 offset:10240
    s_waitcnt lgkmcnt(6)
    v_mfma_f32_32x32x16_bf16 v[68:83], v[176:179], v[144:147], v[68:83]
    ds_read_b64_tr_b16 v[176:177], v189 offset:12288
    ds_read_b64_tr_b16 v[178:179], v189 offset:14336
    s_waitcnt lgkmcnt(6)
    v_mfma_f32_32x32x16_bf16 v[84:99], v[164:167], v[132:135], v[84:99]
    ds_read_b64_tr_b16 v[164:165], v190 offset:0
    ds_read_b64_tr_b16 v[166:167], v190 offset:2048
    s_waitcnt lgkmcnt(6)
    v_mfma_f32_32x32x16_bf16 v[84:99], v[168:171], v[136:139], v[84:99]
    ds_read_b64_tr_b16 v[168:169], v190 offset:4096
    ds_read_b64_tr_b16 v[170:171], v190 offset:6144
    s_waitcnt lgkmcnt(6)
    v_mfma_f32_32x32x16_bf16 v[84:99], v[172:175], v[140:143], v[84:99]
    ds_read_b64_tr_b16 v[172:173], v190 offset:8192
    ds_read_b64_tr_b16 v[174:175], v190 offset:10240
    s_waitcnt lgkmcnt(6)
    v_mfma_f32_32x32x16_bf16 v[84:99], v[176:179], v[144:147], v[84:99]
    ds_read_b64_tr_b16 v[176:177], v190 offset:12288
    ds_read_b64_tr_b16 v[178:179], v190 offset:14336
    s_waitcnt lgkmcnt(6)
    v_mfma_f32_32x32x16_bf16 v[100:115], v[164:167], v[132:135], v[100:115]
    ds_read_b64_tr_b16 v[164:165], v191 offset:0
    ds_read_b64_tr_b16 v[166:167], v191 offset:2048
    s_waitcnt lgkmcnt(6)
    v_mfma_f32_32x32x16_bf16 v[100:115], v[168:171], v[136:139], v[100:115]
    ds_read_b64_tr_b16 v[168:169], v191 offset:4096
    ds_read_b64_tr_b16 v[170:171], v191 offset:6144
    s_waitcnt lgkmcnt(6)
    v_mfma_f32_32x32x16_bf16 v[100:115], v[172:175], v[140:143], v[100:115]
    ds_read_b64_tr_b16 v[172:173], v191 offset:8192
    ds_read_b64_tr_b16 v[174:175], v191 offset:10240
    s_waitcnt lgkmcnt(6)
    v_mfma_f32_32x32x16_bf16 v[100:115], v[176:179], v[144:147], v[100:115]
    ds_read_b64_tr_b16 v[176:177], v191 offset:12288
    ds_read_b64_tr_b16 v[178:179], v191 offset:14336
    s_waitcnt lgkmcnt(6)
    v_mfma_f32_32x32x16_bf16 v[116:131], v[164:167], v[132:135], v[116:131]
    s_waitcnt lgkmcnt(4)
    v_mfma_f32_32x32x16_bf16 v[116:131], v[168:171], v[136:139], v[116:131]
    s_waitcnt lgkmcnt(2)
    v_mfma_f32_32x32x16_bf16 v[116:131], v[172:175], v[140:143], v[116:131]
    s_waitcnt lgkmcnt(0)
    v_mfma_f32_32x32x16_bf16 v[116:131], v[176:179], v[144:147], v[116:131]
    s_setprio 0
    s_cmp_lg_u32 s49, 0
    s_cbranch_scc1 L_attn_kernel_fin
    s_waitcnt vmcnt(0)
    s_barrier
L_attn_kernel_fin:
    v_mov_b32 v205, v201
    s_nop 1
    v_permlane32_swap_b32 v201, v205
    v_add_f32 v201, v201, v205
    v_rcp_f32 v206, v201
    v_and_b32 v204, 31, v0
    v_lshrrev_b32 v205, 5, v0
    s_lshl_b32 s37, s36, 8
    s_lshl_b32 s38, s34, 5
    s_add_u32 s37, s37, s38
    v_add_u32 v207, s37, v204
    v_lshlrev_b32 v207, 13, v207
    s_lshl_b32 s38, s33, 8
    v_lshl_add_u32 v208, v205, 3, s38
    v_add_u32 v207, v207, v208
    v_fma_f32 v208, -v206, v201, 1.0
    v_fma_f32 v206, v208, v206, v206
    s_mul_i32 s38, s34, 8704
    s_add_u32 s38, s38, 92160
    v_mul_u32_u24 v209, 272, v204
    v_lshl_add_u32 v209, v205, 3, v209
    v_add_u32 v209, s38, v209
    v_lshrrev_b32 v210, 4, v0
    v_and_b32 v211, 15, v0
    v_add_u32 v207, s37, v210
    v_lshlrev_b32 v207, 13, v207
    s_lshl_b32 s39, s33, 8
    v_lshl_add_u32 v208, v211, 4, s39
    v_add_u32 v207, v207, v208
    v_mul_u32_u24 v210, 272, v210
    v_lshl_add_u32 v210, v211, 4, v210
    v_add_u32 v210, s38, v210
    v_mul_f32 v68, v206, v68
    v_mul_f32 v69, v206, v69
    v_mul_f32 v70, v206, v70
    v_mul_f32 v71, v206, v71
    v_cvt_pk_bf16_f32 v68, v68, v69
    v_cvt_pk_bf16_f32 v69, v70, v71
    ds_write_b64 v209, v[68:69] offset:0
    v_mul_f32 v72, v206, v72
    v_mul_f32 v73, v206, v73
    v_mul_f32 v74, v206, v74
    v_mul_f32 v75, v206, v75
    v_cvt_pk_bf16_f32 v72, v72, v73
    v_cvt_pk_bf16_f32 v73, v74, v75
    ds_write_b64 v209, v[72:73] offset:16
    v_mul_f32 v76, v206, v76
    v_mul_f32 v77, v206, v77
    v_mul_f32 v78, v206, v78
    v_mul_f32 v79, v206, v79
    v_cvt_pk_bf16_f32 v76, v76, v77
    v_cvt_pk_bf16_f32 v77, v78, v79
    ds_write_b64 v209, v[76:77] offset:32
    v_mul_f32 v80, v206, v80
    v_mul_f32 v81, v206, v81
    v_mul_f32 v82, v206, v82
    v_mul_f32 v83, v206, v83
    v_cvt_pk_bf16_f32 v80, v80, v81
    v_cvt_pk_bf16_f32 v81, v82, v83
    ds_write_b64 v209, v[80:81] offset:48
    v_mul_f32 v84, v206, v84
    v_mul_f32 v85, v206, v85
    v_mul_f32 v86, v206, v86
    v_mul_f32 v87, v206, v87
    v_cvt_pk_bf16_f32 v84, v84, v85
    v_cvt_pk_bf16_f32 v85, v86, v87
    ds_write_b64 v209, v[84:85] offset:64
    v_mul_f32 v88, v206, v88
    v_mul_f32 v89, v206, v89
    v_mul_f32 v90, v206, v90
    v_mul_f32 v91, v206, v91
    v_cvt_pk_bf16_f32 v88, v88, v89
    v_cvt_pk_bf16_f32 v89, v90, v91
    ds_write_b64 v209, v[88:89] offset:80
    v_mul_f32 v92, v206, v92
    v_mul_f32 v93, v206, v93
    v_mul_f32 v94, v206, v94
    v_mul_f32 v95, v206, v95
    v_cvt_pk_bf16_f32 v92, v92, v93
    v_cvt_pk_bf16_f32 v93, v94, v95
    ds_write_b64 v209, v[92:93] offset:96
    v_mul_f32 v96, v206, v96
    v_mul_f32 v97, v206, v97
    v_mul_f32 v98, v206, v98
    v_mul_f32 v99, v206, v99
    v_cvt_pk_bf16_f32 v96, v96, v97
    v_cvt_pk_bf16_f32 v97, v98, v99
    ds_write_b64 v209, v[96:97] offset:112
    v_mul_f32 v100, v206, v100
    v_mul_f32 v101, v206, v101
    v_mul_f32 v102, v206, v102
    v_mul_f32 v103, v206, v103
    v_cvt_pk_bf16_f32 v100, v100, v101
    v_cvt_pk_bf16_f32 v101, v102, v103
    ds_write_b64 v209, v[100:101] offset:128
    v_mul_f32 v104, v206, v104
    v_mul_f32 v105, v206, v105
    v_mul_f32 v106, v206, v106
    v_mul_f32 v107, v206, v107
    v_cvt_pk_bf16_f32 v104, v104, v105
    v_cvt_pk_bf16_f32 v105, v106, v107
    ds_write_b64 v209, v[104:105] offset:144
    v_mul_f32 v108, v206, v108
    v_mul_f32 v109, v206, v109
    v_mul_f32 v110, v206, v110
    v_mul_f32 v111, v206, v111
    v_cvt_pk_bf16_f32 v108, v108, v109
    v_cvt_pk_bf16_f32 v109, v110, v111
    ds_write_b64 v209, v[108:109] offset:160
    v_mul_f32 v112, v206, v112
    v_mul_f32 v113, v206, v113
    v_mul_f32 v114, v206, v114
    v_mul_f32 v115, v206, v115
    v_cvt_pk_bf16_f32 v112, v112, v113
    v_cvt_pk_bf16_f32 v113, v114, v115
    ds_write_b64 v209, v[112:113] offset:176
    v_mul_f32 v116, v206, v116
    v_mul_f32 v117, v206, v117
    v_mul_f32 v118, v206, v118
    v_mul_f32 v119, v206, v119
    v_cvt_pk_bf16_f32 v116, v116, v117
    v_cvt_pk_bf16_f32 v117, v118, v119
    ds_write_b64 v209, v[116:117] offset:192
    v_mul_f32 v120, v206, v120
    v_mul_f32 v121, v206, v121
    v_mul_f32 v122, v206, v122
    v_mul_f32 v123, v206, v123
    v_cvt_pk_bf16_f32 v120, v120, v121
    v_cvt_pk_bf16_f32 v121, v122, v123
    ds_write_b64 v209, v[120:121] offset:208
    v_mul_f32 v124, v206, v124
    v_mul_f32 v125, v206, v125
    v_mul_f32 v126, v206, v126
    v_mul_f32 v127, v206, v127
    v_cvt_pk_bf16_f32 v124, v124, v125
    v_cvt_pk_bf16_f32 v125, v126, v127
    ds_write_b64 v209, v[124:125] offset:224
    v_mul_f32 v128, v206, v128
    v_mul_f32 v129, v206, v129
    v_mul_f32 v130, v206, v130
    v_mul_f32 v131, v206, v131
    v_cvt_pk_bf16_f32 v128, v128, v129
    v_cvt_pk_bf16_f32 v129, v130, v131
    ds_write_b64 v209, v[128:129] offset:240
    s_waitcnt lgkmcnt(0)
    ds_read_b128 v[68:71], v210 offset:0
    ds_read_b128 v[72:75], v210 offset:1088
    ds_read_b128 v[76:79], v210 offset:2176
    ds_read_b128 v[80:83], v210 offset:3264
    ds_read_b128 v[84:87], v210 offset:4352
    ds_read_b128 v[88:91], v210 offset:5440
    ds_read_b128 v[92:95], v210 offset:6528
    ds_read_b128 v[96:99], v210 offset:7616
    s_waitcnt lgkmcnt(7)
    s_mov_b32 s39, 0
    buffer_store_dwordx4 v[68:71], v207, s[20:23], s39 offen
    s_waitcnt lgkmcnt(6)
    s_mov_b32 s39, 32768
    buffer_store_dwordx4 v[72:75], v207, s[20:23], s39 offen
    s_waitcnt lgkmcnt(5)
    s_mov_b32 s39, 65536
    buffer_store_dwordx4 v[76:79], v207, s[20:23], s39 offen
    s_waitcnt lgkmcnt(4)
    s_mov_b32 s39, 98304
    buffer_store_dwordx4 v[80:83], v207, s[20:23], s39 offen
    s_waitcnt lgkmcnt(3)
    s_mov_b32 s39, 131072
    buffer_store_dwordx4 v[84:87], v207, s[20:23], s39 offen
    s_waitcnt lgkmcnt(2)
    s_mov_b32 s39, 163840
    buffer_store_dwordx4 v[88:91], v207, s[20:23], s39 offen
    s_waitcnt lgkmcnt(1)
    s_mov_b32 s39, 196608
    buffer_store_dwordx4 v[92:95], v207, s[20:23], s39 offen
    s_waitcnt lgkmcnt(0)
    s_mov_b32 s39, 229376
    buffer_store_dwordx4 v[96:99], v207, s[20:23], s39 offen
L_attn_kernel_end:
    s_endpgm
.globl wo_kernel
.p2align 8
.type wo_kernel,@function
wo_kernel:
    s_cmp_ge_u32 s2, 256
    s_cbranch_scc1 L_wo_kernel_end
    s_load_dwordx2 s[4:5], s[0:1], 104
    s_load_dwordx2 s[6:7], s[0:1], 32
    v_lshrrev_b32 v1, 6, v0
    v_and_b32 v0, 63, v0
    s_nop 0
    v_readfirstlane_b32 s34, v1
    s_and_b32 s3, s2, 7
    s_lshr_b32 s35, s2, 3
    s_and_b32 s32, s3, 3
    s_lshl_b32 s32, s32, 2
    s_and_b32 s36, s35, 3
    s_add_u32 s32, s32, s36
    s_lshr_b32 s33, s3, 2
    s_lshl_b32 s33, s33, 2
    s_bfe_u32 s36, s35, 0x20002
    s_add_u32 s33, s33, s36
    s_lshr_b32 s45, s35, 4
    s_lshl_b32 s32, s32, 7
    s_waitcnt lgkmcnt(0)
    s_add_u32 s8, s4, 0x2000000
    s_addc_u32 s9, s5, 0
    s_mov_b32 s10, 0x1000000
    s_mov_b32 s11, 0x00020000
    s_mov_b32 s12, s6
    s_mov_b32 s13, s7
    s_mov_b32 s14, 0x800000
    s_mov_b32 s15, 0x00020000
    s_add_u32 s20, s4, 0x4000000
    s_addc_u32 s21, s5, 0
    s_mov_b32 s22, 0x1000000
    s_mov_b32 s23, 0x00020000
    s_cmp_ge_u32 s34, 4
    s_cbranch_scc1 L_wo_kernel_loader
    s_and_b32 s36, s34, 1
    s_lshr_b32 s37, s34, 1
    v_and_b32 v140, 15, v0
    v_lshrrev_b32 v141, 4, v0
    v_lshrrev_b32 v142, 1, v140
    v_xor_b32 v142, v141, v142
    v_lshlrev_b32 v142, 4, v142
    v_lshl_add_u32 v142, v140, 7, v142
    s_lshl_b32 s38, s36, 13
    v_add_u32 v136, s38, v142
    v_xor_b32 v137, 64, v136
    v_lshrrev_b32 v142, 3, v140
    v_and_b32 v143, 1, v141
    v_lshl_or_b32 v142, v143, 1, v142
    v_lshlrev_b32 v142, 5, v142
    v_and_b32 v143, 3, v140
    v_lshl_add_u32 v142, v143, 3, v142
    v_lshrrev_b32 v143, 2, v140
    v_lshl_add_u32 v143, v141, 3, v143
    v_lshl_add_u32 v138, v143, 7, v142
    s_lshl_b32 s38, s37, 13
    s_add_u32 s38, s38, 16384
    v_add_u32 v138, s38, v138
    v_xor_b32 v139, 32, v138
    v_mov_b32 v132, v136
    v_mov_b32 v133, v137
    v_mov_b32 v134, v138
    v_mov_b32 v135, v139
    v_mov_b32 v4, 0
    v_mov_b32 v5, 0
    v_mov_b32 v6, 0
    v_mov_b32 v7, 0
    v_mov_b32 v8, 0
    v_mov_b32 v9, 0
    v_mov_b32 v10, 0
    v_mov_b32 v11, 0
    v_mov_b32 v12, 0
    v_mov_b32 v13, 0
    v_mov_b32 v14, 0
    v_mov_b32 v15, 0
    v_mov_b32 v16, 0
    v_mov_b32 v17, 0
    v_mov_b32 v18, 0
    v_mov_b32 v19, 0
    v_mov_b32 v20, 0
    v_mov_b32 v21, 0
    v_mov_b32 v22, 0
    v_mov_b32 v23, 0
    v_mov_b32 v24, 0
    v_mov_b32 v25, 0
    v_mov_b32 v26, 0
    v_mov_b32 v27, 0
    v_mov_b32 v28, 0
    v_mov_b32 v29, 0
    v_mov_b32 v30, 0
    v_mov_b32 v31, 0
    v_mov_b32 v32, 0
    v_mov_b32 v33, 0
    v_mov_b32 v34, 0
    v_mov_b32 v35, 0
    v_mov_b32 v36, 0
    v_mov_b32 v37, 0
    v_mov_b32 v38, 0
    v_mov_b32 v39, 0
    v_mov_b32 v40, 0
    v_mov_b32 v41, 0
    v_mov_b32 v42, 0
    v_mov_b32 v43, 0
    v_mov_b32 v44, 0
    v_mov_b32 v45, 0
    v_mov_b32 v46, 0
    v_mov_b32 v47, 0
    v_mov_b32 v48, 0
    v_mov_b32 v49, 0
    v_mov_b32 v50, 0
    v_mov_b32 v51, 0
    v_mov_b32 v52, 0
    v_mov_b32 v53, 0
    v_mov_b32 v54, 0
    v_mov_b32 v55, 0
    v_mov_b32 v56, 0
    v_mov_b32 v57, 0
    v_mov_b32 v58, 0
    v_mov_b32 v59, 0
    v_mov_b32 v60, 0
    v_mov_b32 v61, 0
    v_mov_b32 v62, 0
    v_mov_b32 v63, 0
    v_mov_b32 v64, 0
    v_mov_b32 v65, 0
    v_mov_b32 v66, 0
    v_mov_b32 v67, 0
    v_xor_b32 v144, 64, v134
    v_xor_b32 v145, 64, v135
    s_mov_b32 s39, 0
    s_mov_b32 s35, 0
    s_barrier
    ds_read_b128 v[68:71], v132 offset:0
    ds_read_b128 v[72:75], v132 offset:2048
    ds_read_b128 v[76:79], v132 offset:4096
    ds_read_b128 v[80:83], v132 offset:6144
    ds_read_b64_tr_b16 v[84:85], v134 offset:0
    ds_read_b64_tr_b16 v[86:87], v134 offset:512
    ds_read_b64_tr_b16 v[88:89], v135 offset:0
    ds_read_b64_tr_b16 v[90:91], v135 offset:512
    ds_read_b64_tr_b16 v[92:93], v144 offset:0
    ds_read_b64_tr_b16 v[94:95], v144 offset:512
    ds_read_b64_tr_b16 v[96:97], v145 offset:0
    ds_read_b64_tr_b16 v[98:99], v145 offset:512
L_wo_kernel_cloop:
    s_waitcnt lgkmcnt(0)
    v_mfma_f32_16x16x32_bf16 v[4:7], v[84:87], v[68:71], v[4:7]
    ds_read_b128 v[100:103], v133 offset:0
    v_mfma_f32_16x16x32_bf16 v[8:11], v[88:91], v[68:71], v[8:11]
    ds_read_b128 v[104:107], v133 offset:2048
    v_mfma_f32_16x16x32_bf16 v[12:15], v[92:95], v[68:71], v[12:15]
    ds_read_b128 v[108:111], v133 offset:4096
    v_mfma_f32_16x16x32_bf16 v[16:19], v[96:99], v[68:71], v[16:19]
    ds_read_b128 v[112:115], v133 offset:6144
    v_mfma_f32_16x16x32_bf16 v[20:23], v[84:87], v[72:75], v[20:23]
    ds_read_b64_tr_b16 v[116:117], v134 offset:4096
    v_mfma_f32_16x16x32_bf16 v[24:27], v[88:91], v[72:75], v[24:27]
    ds_read_b64_tr_b16 v[118:119], v134 offset:4608
    v_mfma_f32_16x16x32_bf16 v[28:31], v[92:95], v[72:75], v[28:31]
    ds_read_b64_tr_b16 v[120:121], v135 offset:4096
    v_mfma_f32_16x16x32_bf16 v[32:35], v[96:99], v[72:75], v[32:35]
    ds_read_b64_tr_b16 v[122:123], v135 offset:4608
    v_mfma_f32_16x16x32_bf16 v[36:39], v[84:87], v[76:79], v[36:39]
    ds_read_b64_tr_b16 v[124:125], v144 offset:4096
    v_mfma_f32_16x16x32_bf16 v[40:43], v[88:91], v[76:79], v[40:43]
    ds_read_b64_tr_b16 v[126:127], v144 offset:4608
    v_mfma_f32_16x16x32_bf16 v[44:47], v[92:95], v[76:79], v[44:47]
    ds_read_b64_tr_b16 v[128:129], v145 offset:4096
    v_mfma_f32_16x16x32_bf16 v[48:51], v[96:99], v[76:79], v[48:51]
    ds_read_b64_tr_b16 v[130:131], v145 offset:4608
    v_mfma_f32_16x16x32_bf16 v[52:55], v[84:87], v[80:83], v[52:55]
    v_mfma_f32_16x16x32_bf16 v[56:59], v[88:91], v[80:83], v[56:59]
    v_mfma_f32_16x16x32_bf16 v[60:63], v[92:95], v[80:83], v[60:63]
    v_mfma_f32_16x16x32_bf16 v[64:67], v[96:99], v[80:83], v[64:67]
    s_waitcnt lgkmcnt(0)
    s_barrier
    s_add_u32 s39, s39, 32768
    s_cmp_ge_u32 s39, 131072
    s_cselect_b32 s39, 0, s39
    v_add_u32 v132, s39, v136
    v_add_u32 v133, s39, v137
    v_add_u32 v134, s39, v138
    v_add_u32 v135, s39, v139
    v_xor_b32 v144, 64, v134
    v_xor_b32 v145, 64, v135
    v_mfma_f32_16x16x32_bf16 v[4:7], v[116:119], v[100:103], v[4:7]
    ds_read_b128 v[68:71], v132 offset:0
    v_mfma_f32_16x16x32_bf16 v[8:11], v[120:123], v[100:103], v[8:11]
    ds_read_b128 v[72:75], v132 offset:2048
    v_mfma_f32_16x16x32_bf16 v[12:15], v[124:127], v[100:103], v[12:15]
    ds_read_b128 v[76:79], v132 offset:4096
    v_mfma_f32_16x16x32_bf16 v[16:19], v[128:131], v[100:103], v[16:19]
    ds_read_b128 v[80:83], v132 offset:6144
    v_mfma_f32_16x16x32_bf16 v[20:23], v[116:119], v[104:107], v[20:23]
    ds_read_b64_tr_b16 v[84:85], v134 offset:0
    v_mfma_f32_16x16x32_bf16 v[24:27], v[120:123], v[104:107], v[24:27]
    ds_read_b64_tr_b16 v[86:87], v134 offset:512
    v_mfma_f32_16x16x32_bf16 v[28:31], v[124:127], v[104:107], v[28:31]
    ds_read_b64_tr_b16 v[88:89], v135 offset:0
    v_mfma_f32_16x16x32_bf16 v[32:35], v[128:131], v[104:107], v[32:35]
    ds_read_b64_tr_b16 v[90:91], v135 offset:512
    v_mfma_f32_16x16x32_bf16 v[36:39], v[116:119], v[108:111], v[36:39]
    ds_read_b64_tr_b16 v[92:93], v144 offset:0
    v_mfma_f32_16x16x32_bf16 v[40:43], v[120:123], v[108:111], v[40:43]
    ds_read_b64_tr_b16 v[94:95], v144 offset:512
    v_mfma_f32_16x16x32_bf16 v[44:47], v[124:127], v[108:111], v[44:47]
    ds_read_b64_tr_b16 v[96:97], v145 offset:0
    v_mfma_f32_16x16x32_bf16 v[48:51], v[128:131], v[108:111], v[48:51]
    ds_read_b64_tr_b16 v[98:99], v145 offset:512
    v_mfma_f32_16x16x32_bf16 v[52:55], v[116:119], v[112:115], v[52:55]
    v_mfma_f32_16x16x32_bf16 v[56:59], v[120:123], v[112:115], v[56:59]
    v_mfma_f32_16x16x32_bf16 v[60:63], v[124:127], v[112:115], v[60:63]
    v_mfma_f32_16x16x32_bf16 v[64:67], v[128:131], v[112:115], v[64:67]
    s_add_u32 s35, s35, 1
    s_cmp_lt_u32 s35, 31
    s_cbranch_scc1 L_wo_kernel_cloop
    s_waitcnt lgkmcnt(0)
    v_mfma_f32_16x16x32_bf16 v[4:7], v[84:87], v[68:71], v[4:7]
    ds_read_b128 v[100:103], v133 offset:0
    v_mfma_f32_16x16x32_bf16 v[8:11], v[88:91], v[68:71], v[8:11]
    ds_read_b128 v[104:107], v133 offset:2048
    v_mfma_f32_16x16x32_bf16 v[12:15], v[92:95], v[68:71], v[12:15]
    ds_read_b128 v[108:111], v133 offset:4096
    v_mfma_f32_16x16x32_bf16 v[16:19], v[96:99], v[68:71], v[16:19]
    ds_read_b128 v[112:115], v133 offset:6144
    v_mfma_f32_16x16x32_bf16 v[20:23], v[84:87], v[72:75], v[20:23]
    ds_read_b64_tr_b16 v[116:117], v134 offset:4096
    v_mfma_f32_16x16x32_bf16 v[24:27], v[88:91], v[72:75], v[24:27]
    ds_read_b64_tr_b16 v[118:119], v134 offset:4608
    v_mfma_f32_16x16x32_bf16 v[28:31], v[92:95], v[72:75], v[28:31]
    ds_read_b64_tr_b16 v[120:121], v135 offset:4096
    v_mfma_f32_16x16x32_bf16 v[32:35], v[96:99], v[72:75], v[32:35]
    ds_read_b64_tr_b16 v[122:123], v135 offset:4608
    v_mfma_f32_16x16x32_bf16 v[36:39], v[84:87], v[76:79], v[36:39]
    ds_read_b64_tr_b16 v[124:125], v144 offset:4096
    v_mfma_f32_16x16x32_bf16 v[40:43], v[88:91], v[76:79], v[40:43]
    ds_read_b64_tr_b16 v[126:127], v144 offset:4608
    v_mfma_f32_16x16x32_bf16 v[44:47], v[92:95], v[76:79], v[44:47]
    ds_read_b64_tr_b16 v[128:129], v145 offset:4096
    v_mfma_f32_16x16x32_bf16 v[48:51], v[96:99], v[76:79], v[48:51]
    ds_read_b64_tr_b16 v[130:131], v145 offset:4608
    v_mfma_f32_16x16x32_bf16 v[52:55], v[84:87], v[80:83], v[52:55]
    v_mfma_f32_16x16x32_bf16 v[56:59], v[88:91], v[80:83], v[56:59]
    v_mfma_f32_16x16x32_bf16 v[60:63], v[92:95], v[80:83], v[60:63]
    v_mfma_f32_16x16x32_bf16 v[64:67], v[96:99], v[80:83], v[64:67]
    s_waitcnt lgkmcnt(0)
    v_mfma_f32_16x16x32_bf16 v[4:7], v[116:119], v[100:103], v[4:7]
    v_mfma_f32_16x16x32_bf16 v[8:11], v[120:123], v[100:103], v[8:11]
    v_mfma_f32_16x16x32_bf16 v[12:15], v[124:127], v[100:103], v[12:15]
    v_mfma_f32_16x16x32_bf16 v[16:19], v[128:131], v[100:103], v[16:19]
    v_mfma_f32_16x16x32_bf16 v[20:23], v[116:119], v[104:107], v[20:23]
    v_mfma_f32_16x16x32_bf16 v[24:27], v[120:123], v[104:107], v[24:27]
    v_mfma_f32_16x16x32_bf16 v[28:31], v[124:127], v[104:107], v[28:31]
    v_mfma_f32_16x16x32_bf16 v[32:35], v[128:131], v[104:107], v[32:35]
    v_mfma_f32_16x16x32_bf16 v[36:39], v[116:119], v[108:111], v[36:39]
    v_mfma_f32_16x16x32_bf16 v[40:43], v[120:123], v[108:111], v[40:43]
    v_mfma_f32_16x16x32_bf16 v[44:47], v[124:127], v[108:111], v[44:47]
    v_mfma_f32_16x16x32_bf16 v[48:51], v[128:131], v[108:111], v[48:51]
    v_mfma_f32_16x16x32_bf16 v[52:55], v[116:119], v[112:115], v[52:55]
    v_mfma_f32_16x16x32_bf16 v[56:59], v[120:123], v[112:115], v[56:59]
    v_mfma_f32_16x16x32_bf16 v[60:63], v[124:127], v[112:115], v[60:63]
    v_mfma_f32_16x16x32_bf16 v[64:67], v[128:131], v[112:115], v[64:67]
    v_and_b32 v141, 15, v0
    v_lshrrev_b32 v142, 4, v0
    s_lshl_b32 s46, s36, 6
    s_add_u32 s46, s46, s32
    v_add_u32 v141, s46, v141
    v_lshlrev_b32 v141, 12, v141
    s_lshl_b32 s46, s33, 9
    s_lshl_b32 s47, s37, 8
    s_add_u32 s46, s46, s47
    s_lshl_b32 s47, s45, 23
    s_add_u32 s46, s46, s47
    v_lshl_add_u32 v142, v142, 4, s46
    v_add_u32 v140, v141, v142
    s_mov_b32 s46, 0
    buffer_store_dwordx4 v[4:7], v140, s[20:23], s46 offen offset:0
    buffer_store_dwordx4 v[8:11], v140, s[20:23], s46 offen offset:64
    buffer_store_dwordx4 v[12:15], v140, s[20:23], s46 offen offset:128
    buffer_store_dwordx4 v[16:19], v140, s[20:23], s46 offen offset:192
    s_mov_b32 s46, 65536
    buffer_store_dwordx4 v[20:23], v140, s[20:23], s46 offen offset:0
    buffer_store_dwordx4 v[24:27], v140, s[20:23], s46 offen offset:64
    buffer_store_dwordx4 v[28:31], v140, s[20:23], s46 offen offset:128
    buffer_store_dwordx4 v[32:35], v140, s[20:23], s46 offen offset:192
    s_mov_b32 s46, 131072
    buffer_store_dwordx4 v[36:39], v140, s[20:23], s46 offen offset:0
    buffer_store_dwordx4 v[40:43], v140, s[20:23], s46 offen offset:64
    buffer_store_dwordx4 v[44:47], v140, s[20:23], s46 offen offset:128
    buffer_store_dwordx4 v[48:51], v140, s[20:23], s46 offen offset:192
    s_mov_b32 s46, 196608
    buffer_store_dwordx4 v[52:55], v140, s[20:23], s46 offen offset:0
    buffer_store_dwordx4 v[56:59], v140, s[20:23], s46 offen offset:64
    buffer_store_dwordx4 v[60:63], v140, s[20:23], s46 offen offset:128
    buffer_store_dwordx4 v[64:67], v140, s[20:23], s46 offen offset:192
    s_endpgm
L_wo_kernel_loader:
    s_sub_u32 s34, s34, 4
    v_lshrrev_b32 v1, 3, v0
    v_and_b32 v2, 7, v0
    v_lshrrev_b32 v3, 4, v0
    s_lshl_b32 s46, s34, 5
    s_add_u32 s46, s46, s32
    s_mov_b32 s48, 8192
    v_add_u32 v4, 0, v3
    v_and_b32 v4, 7, v4
    v_xor_b32 v4, v2, v4
    v_lshlrev_b32 v4, 4, v4
    v_add_u32 v5, s46, v1
    v_add_u32 v5, 0, v5
    v_mul_lo_u32 v5, v5, s48
    v_add_u32 v8, v5, v4
    v_add_u32 v4, 4, v3
    v_and_b32 v4, 7, v4
    v_xor_b32 v4, v2, v4
    v_lshlrev_b32 v4, 4, v4
    v_add_u32 v5, s46, v1
    v_add_u32 v5, 8, v5
    v_mul_lo_u32 v5, v5, s48
    v_add_u32 v9, v5, v4
    v_add_u32 v4, 0, v3
    v_and_b32 v4, 7, v4
    v_xor_b32 v4, v2, v4
    v_lshlrev_b32 v4, 4, v4
    v_add_u32 v5, s46, v1
    v_add_u32 v5, 16, v5
    v_mul_lo_u32 v5, v5, s48
    v_add_u32 v10, v5, v4
    v_add_u32 v4, 4, v3
    v_and_b32 v4, 7, v4
    v_xor_b32 v4, v2, v4
    v_lshlrev_b32 v4, 4, v4
    v_add_u32 v5, s46, v1
    v_add_u32 v5, 24, v5
    v_mul_lo_u32 v5, v5, s48
    v_add_u32 v11, v5, v4
    s_and_b32 s46, s34, 1
    s_lshl_b32 s46, s46, 5
    s_lshl_b32 s47, s33, 8
    s_lshr_b32 s49, s34, 1
    s_lshl_b32 s49, s49, 7
    s_add_u32 s47, s47, s49
    v_and_b32 v4, 1, v3
    v_or_b32 v4, 0, v4
    v_lshrrev_b32 v5, 1, v2
    v_xor_b32 v4, v5, v4
    v_lshlrev_b32 v4, 5, v4
    v_and_b32 v5, 1, v2
    v_lshl_add_u32 v4, v5, 4, v4
    v_add_u32 v5, s46, v1
    v_add_u32 v5, 0, v5
    v_lshlrev_b32 v5, 11, v5
    v_add3_u32 v16, v5, v4, s47
    v_and_b32 v4, 1, v3
    v_or_b32 v4, 2, v4
    v_lshrrev_b32 v5, 1, v2
    v_xor_b32 v4, v5, v4
    v_lshlrev_b32 v4, 5, v4
    v_and_b32 v5, 1, v2
    v_lshl_add_u32 v4, v5, 4, v4
    v_add_u32 v5, s46, v1
    v_add_u32 v5, 8, v5
    v_lshlrev_b32 v5, 11, v5
    v_add3_u32 v17, v5, v4, s47
    v_and_b32 v4, 1, v3
    v_or_b32 v4, 0, v4
    v_lshrrev_b32 v5, 1, v2
    v_xor_b32 v4, v5, v4
    v_lshlrev_b32 v4, 5, v4
    v_and_b32 v5, 1, v2
    v_lshl_add_u32 v4, v5, 4, v4
    v_add_u32 v5, s46, v1
    v_add_u32 v5, 16, v5
    v_lshlrev_b32 v5, 11, v5
    v_add3_u32 v18, v5, v4, s47
    v_and_b32 v4, 1, v3
    v_or_b32 v4, 2, v4
    v_lshrrev_b32 v5, 1, v2
    v_xor_b32 v4, v5, v4
    v_lshlrev_b32 v4, 5, v4
    v_and_b32 v5, 1, v2
    v_lshl_add_u32 v4, v5, 4, v4
    v_add_u32 v5, s46, v1
    v_add_u32 v5, 24, v5
    v_lshlrev_b32 v5, 11, v5
    v_add3_u32 v19, v5, v4, s47
    s_lshl_b32 s50, s34, 12
    s_lshl_b32 s51, s34, 12
    s_add_u32 s51, s51, 16384
    s_mul_i32 s52, s45, 4096
    s_mul_i32 s53, s45, 4194304
    s_mov_b32 s39, 0
    s_add_u32 s54, s39, s50
    s_add_u32 m0, s54, 0
    s_nop 0
    buffer_load_dwordx4 v8, s[8:11], s52 offen lds
    s_add_u32 s54, s39, s50
    s_add_u32 m0, s54, 1024
    s_nop 0
    buffer_load_dwordx4 v9, s[8:11], s52 offen lds
    s_add_u32 s54, s39, s50
    s_add_u32 m0, s54, 2048
    s_nop 0
    buffer_load_dwordx4 v10, s[8:11], s52 offen lds
    s_add_u32 s54, s39, s50
    s_add_u32 m0, s54, 3072
    s_nop 0
    buffer_load_dwordx4 v11, s[8:11], s52 offen lds
    s_add_u32 s54, s39, s51
    s_add_u32 m0, s54, 0
    s_nop 0
    buffer_load_dwordx4 v16, s[12:15], s53 offen lds
    s_add_u32 s54, s39, s51
    s_add_u32 m0, s54, 1024
    s_nop 0
    buffer_load_dwordx4 v17, s[12:15], s53 offen lds
    s_add_u32 s54, s39, s51
    s_add_u32 m0, s54, 2048
    s_nop 0
    buffer_load_dwordx4 v18, s[12:15], s53 offen lds
    s_add_u32 s54, s39, s51
    s_add_u32 m0, s54, 3072
    s_nop 0
    buffer_load_dwordx4 v19, s[12:15], s53 offen lds
    s_add_u32 s52, s52, 128
    s_add_u32 s53, s53, 131072
    s_add_u32 s39, s39, 32768
    s_cmp_ge_u32 s39, 131072
    s_cselect_b32 s39, 0, s39
    s_add_u32 s54, s39, s50
    s_add_u32 m0, s54, 0
    s_nop 0
    buffer_load_dwordx4 v8, s[8:11], s52 offen lds
    s_add_u32 s54, s39, s50
    s_add_u32 m0, s54, 1024
    s_nop 0
    buffer_load_dwordx4 v9, s[8:11], s52 offen lds
    s_add_u32 s54, s39, s50
    s_add_u32 m0, s54, 2048
    s_nop 0
    buffer_load_dwordx4 v10, s[8:11], s52 offen lds
    s_add_u32 s54, s39, s50
    s_add_u32 m0, s54, 3072
    s_nop 0
    buffer_load_dwordx4 v11, s[8:11], s52 offen lds
    s_add_u32 s54, s39, s51
    s_add_u32 m0, s54, 0
    s_nop 0
    buffer_load_dwordx4 v16, s[12:15], s53 offen lds
    s_add_u32 s54, s39, s51
    s_add_u32 m0, s54, 1024
    s_nop 0
    buffer_load_dwordx4 v17, s[12:15], s53 offen lds
    s_add_u32 s54, s39, s51
    s_add_u32 m0, s54, 2048
    s_nop 0
    buffer_load_dwordx4 v18, s[12:15], s53 offen lds
    s_add_u32 s54, s39, s51
    s_add_u32 m0, s54, 3072
    s_nop 0
    buffer_load_dwordx4 v19, s[12:15], s53 offen lds
    s_add_u32 s52, s52, 128
    s_add_u32 s53, s53, 131072
    s_add_u32 s39, s39, 32768
    s_cmp_ge_u32 s39, 131072
    s_cselect_b32 s39, 0, s39
    s_add_u32 s54, s39, s50
    s_add_u32 m0, s54, 0
    s_nop 0
    buffer_load_dwordx4 v8, s[8:11], s52 offen lds
    s_add_u32 s54, s39, s50
    s_add_u32 m0, s54, 1024
    s_nop 0
    buffer_load_dwordx4 v9, s[8:11], s52 offen lds
    s_add_u32 s54, s39, s50
    s_add_u32 m0, s54, 2048
    s_nop 0
    buffer_load_dwordx4 v10, s[8:11], s52 offen lds
    s_add_u32 s54, s39, s50
    s_add_u32 m0, s54, 3072
    s_nop 0
    buffer_load_dwordx4 v11, s[8:11], s52 offen lds
    s_add_u32 s54, s39, s51
    s_add_u32 m0, s54, 0
    s_nop 0
    buffer_load_dwordx4 v16, s[12:15], s53 offen lds
    s_add_u32 s54, s39, s51
    s_add_u32 m0, s54, 1024
    s_nop 0
    buffer_load_dwordx4 v17, s[12:15], s53 offen lds
    s_add_u32 s54, s39, s51
    s_add_u32 m0, s54, 2048
    s_nop 0
    buffer_load_dwordx4 v18, s[12:15], s53 offen lds
    s_add_u32 s54, s39, s51
    s_add_u32 m0, s54, 3072
    s_nop 0
    buffer_load_dwordx4 v19, s[12:15], s53 offen lds
    s_add_u32 s52, s52, 128
    s_add_u32 s53, s53, 131072
    s_add_u32 s39, s39, 32768
    s_cmp_ge_u32 s39, 131072
    s_cselect_b32 s39, 0, s39
    s_add_u32 s54, s39, s50
    s_add_u32 m0, s54, 0
    s_nop 0
    buffer_load_dwordx4 v8, s[8:11], s52 offen lds
    s_add_u32 s54, s39, s50
    s_add_u32 m0, s54, 1024
    s_nop 0
    buffer_load_dwordx4 v9, s[8:11], s52 offen lds
    s_add_u32 s54, s39, s50
    s_add_u32 m0, s54, 2048
    s_nop 0
    buffer_load_dwordx4 v10, s[8:11], s52 offen lds
    s_add_u32 s54, s39, s50
    s_add_u32 m0, s54, 3072
    s_nop 0
    buffer_load_dwordx4 v11, s[8:11], s52 offen lds
    s_add_u32 s54, s39, s51
    s_add_u32 m0, s54, 0
    s_nop 0
    buffer_load_dwordx4 v16, s[12:15], s53 offen lds
    s_add_u32 s54, s39, s51
    s_add_u32 m0, s54, 1024
    s_nop 0
    buffer_load_dwordx4 v17, s[12:15], s53 offen lds
    s_add_u32 s54, s39, s51
    s_add_u32 m0, s54, 2048
    s_nop 0
    buffer_load_dwordx4 v18, s[12:15], s53 offen lds
    s_add_u32 s54, s39, s51
    s_add_u32 m0, s54, 3072
    s_nop 0
    buffer_load_dwordx4 v19, s[12:15], s53 offen lds
    s_add_u32 s52, s52, 128
    s_add_u32 s53, s53, 131072
    s_add_u32 s39, s39, 32768
    s_cmp_ge_u32 s39, 131072
    s_cselect_b32 s39, 0, s39
    s_waitcnt vmcnt(24)
    s_barrier
    s_mov_b32 s35, 0
L_wo_kernel_lloop:
    s_waitcnt vmcnt(16)
    s_barrier
    s_add_u32 s54, s39, s50
    s_add_u32 m0, s54, 0
    s_nop 0
    buffer_load_dwordx4 v8, s[8:11], s52 offen lds
    s_add_u32 s54, s39, s50
    s_add_u32 m0, s54, 1024
    s_nop 0
    buffer_load_dwordx4 v9, s[8:11], s52 offen lds
    s_add_u32 s54, s39, s50
    s_add_u32 m0, s54, 2048
    s_nop 0
    buffer_load_dwordx4 v10, s[8:11], s52 offen lds
    s_add_u32 s54, s39, s50
    s_add_u32 m0, s54, 3072
    s_nop 0
    buffer_load_dwordx4 v11, s[8:11], s52 offen lds
    s_add_u32 s54, s39, s51
    s_add_u32 m0, s54, 0
    s_nop 0
    buffer_load_dwordx4 v16, s[12:15], s53 offen lds
    s_add_u32 s54, s39, s51
    s_add_u32 m0, s54, 1024
    s_nop 0
    buffer_load_dwordx4 v17, s[12:15], s53 offen lds
    s_add_u32 s54, s39, s51
    s_add_u32 m0, s54, 2048
    s_nop 0
    buffer_load_dwordx4 v18, s[12:15], s53 offen lds
    s_add_u32 s54, s39, s51
    s_add_u32 m0, s54, 3072
    s_nop 0
    buffer_load_dwordx4 v19, s[12:15], s53 offen lds
    s_add_u32 s52, s52, 128
    s_add_u32 s53, s53, 131072
    s_add_u32 s39, s39, 32768
    s_cmp_ge_u32 s39, 131072
    s_cselect_b32 s39, 0, s39
    s_add_u32 s35, s35, 1
    s_cmp_lt_u32 s35, 28
    s_cbranch_scc1 L_wo_kernel_lloop
    s_waitcnt vmcnt(16)
    s_barrier
    s_waitcnt vmcnt(8)
    s_barrier
    s_waitcnt vmcnt(0)
    s_barrier
L_wo_kernel_end:
    s_endpgm
.globl ln2_kernel
.p2align 8
.type ln2_kernel,@function
ln2_kernel:
    s_cmp_ge_u32 s2, 512
    s_cbranch_scc1 L_ln2_kernel_end
    s_load_dwordx2 s[4:5], s[0:1], 0
    s_load_dwordx2 s[8:9], s[0:1], 104
    s_load_dwordx2 s[28:29], s[0:1], 104
    v_lshrrev_b32 v1, 6, v0
    v_and_b32 v2, 63, v0
    s_lshl_b32 s3, s2, 2
    v_add_u32 v1, s3, v1
    v_lshlrev_b32 v33, 12, v1
    v_lshl_add_u32 v33, v2, 6, v33
    v_lshlrev_b32 v1, 11, v1
    v_lshl_add_u32 v1, v2, 4, v1
    v_lshlrev_b32 v3, 5, v2
    s_waitcnt lgkmcnt(0)
    s_mov_b32 s12, s4
    s_mov_b32 s13, s5
    s_mov_b32 s14, 0x400000
    s_mov_b32 s15, 0x00020000
    s_mov_b32 s16, s8
    s_mov_b32 s17, s9
    s_mov_b32 s18, 0x6000
    s_mov_b32 s19, 0x00020000
    s_add_u32 s20, s8, 0x900000
    s_addc_u32 s21, s9, 0
    s_mov_b32 s22, 0x400000
    s_mov_b32 s23, 0x00020000
    buffer_load_dwordx4 v[4:7], v1, s[12:15], 0 offen
    buffer_load_dwordx4 v[8:11], v1, s[12:15], 0 offen offset:1024
    s_mov_b32 s24, 12288
    s_mov_b32 s25, 16384
    buffer_load_dwordx4 v[48:51], v3, s[16:19], s24 offen
    buffer_load_dwordx4 v[52:55], v3, s[16:19], s24 offen offset:16
    buffer_load_dwordx4 v[56:59], v3, s[16:19], s24 offen offset:2048
    buffer_load_dwordx4 v[60:63], v3, s[16:19], s24 offen offset:2064
    buffer_load_dwordx4 v[64:67], v3, s[16:19], s25 offen
    buffer_load_dwordx4 v[68:71], v3, s[16:19], s25 offen offset:16
    buffer_load_dwordx4 v[72:75], v3, s[16:19], s25 offen offset:2048
    buffer_load_dwordx4 v[76:79], v3, s[16:19], s25 offen offset:2064
    s_mov_b32 s26, 0xffff0000
    s_add_u32 s36, s8, 0x4000000
    s_addc_u32 s37, s9, 0
    s_mov_b32 s38, 0x1000000
    s_mov_b32 s39, 0x00020000
    s_add_u32 s40, s8, 0x500000
    s_addc_u32 s41, s9, 0
    s_mov_b32 s42, 0x400000
    s_mov_b32 s43, 0x00020000
    v_lshlrev_b32 v34, 1, v1
    s_mov_b32 s27, 0x800000
    s_mov_b32 s30, 8192
    buffer_load_dwordx4 v[80:83], v34, s[36:39], 0 offen
    buffer_load_dwordx4 v[84:87], v34, s[36:39], 0 offen offset:16
    buffer_load_dwordx4 v[88:91], v34, s[36:39], 0 offen offset:2048
    buffer_load_dwordx4 v[92:95], v34, s[36:39], 0 offen offset:2064
    buffer_load_dwordx4 v[96:99], v34, s[36:39], s27 offen
    buffer_load_dwordx4 v[100:103], v34, s[36:39], s27 offen offset:16
    buffer_load_dwordx4 v[104:107], v34, s[36:39], s27 offen offset:2048
    buffer_load_dwordx4 v[108:111], v34, s[36:39], s27 offen offset:2064
    buffer_load_dwordx4 v[112:115], v3, s[16:19], s30 offen
    buffer_load_dwordx4 v[116:119], v3, s[16:19], s30 offen offset:16
    buffer_load_dwordx4 v[120:123], v3, s[16:19], s30 offen offset:2048
    buffer_load_dwordx4 v[124:127], v3, s[16:19], s30 offen offset:2064
    s_waitcnt vmcnt(0)
    v_lshlrev_b32 v16, 16, v4
    v_and_b32 v17, s26, v4
    v_lshlrev_b32 v18, 16, v5
    v_and_b32 v19, s26, v5
    v_lshlrev_b32 v20, 16, v6
    v_and_b32 v21, s26, v6
    v_lshlrev_b32 v22, 16, v7
    v_and_b32 v23, s26, v7
    v_lshlrev_b32 v24, 16, v8
    v_and_b32 v25, s26, v8
    v_lshlrev_b32 v26, 16, v9
    v_and_b32 v27, s26, v9
    v_lshlrev_b32 v28, 16, v10
    v_and_b32 v29, s26, v10
    v_lshlrev_b32 v30, 16, v11
    v_and_b32 v31, s26, v11
    v_add_f32 v80, v80, v96
    v_add_f32 v81, v81, v97
    v_add_f32 v82, v82, v98
    v_add_f32 v83, v83, v99
    v_add_f32 v84, v84, v100
    v_add_f32 v85, v85, v101
    v_add_f32 v86, v86, v102
    v_add_f32 v87, v87, v103
    v_add_f32 v88, v88, v104
    v_add_f32 v89, v89, v105
    v_add_f32 v90, v90, v106
    v_add_f32 v91, v91, v107
    v_add_f32 v92, v92, v108
    v_add_f32 v93, v93, v109
    v_add_f32 v94, v94, v110
    v_add_f32 v95, v95, v111
    v_cvt_pk_bf16_f32 v80, 0, v80
    v_cvt_pk_bf16_f32 v81, 0, v81
    v_cvt_pk_bf16_f32 v82, 0, v82
    v_cvt_pk_bf16_f32 v83, 0, v83
    v_cvt_pk_bf16_f32 v84, 0, v84
    v_cvt_pk_bf16_f32 v85, 0, v85
    v_cvt_pk_bf16_f32 v86, 0, v86
    v_cvt_pk_bf16_f32 v87, 0, v87
    v_cvt_pk_bf16_f32 v88, 0, v88
    v_cvt_pk_bf16_f32 v89, 0, v89
    v_cvt_pk_bf16_f32 v90, 0, v90
    v_cvt_pk_bf16_f32 v91, 0, v91
    v_cvt_pk_bf16_f32 v92, 0, v92
    v_cvt_pk_bf16_f32 v93, 0, v93
    v_cvt_pk_bf16_f32 v94, 0, v94
    v_cvt_pk_bf16_f32 v95, 0, v95
    v_mul_f32 v80, v80, v112
    v_mul_f32 v81, v81, v113
    v_mul_f32 v82, v82, v114
    v_mul_f32 v83, v83, v115
    v_mul_f32 v84, v84, v116
    v_mul_f32 v85, v85, v117
    v_mul_f32 v86, v86, v118
    v_mul_f32 v87, v87, v119
    v_mul_f32 v88, v88, v120
    v_mul_f32 v89, v89, v121
    v_mul_f32 v90, v90, v122
    v_mul_f32 v91, v91, v123
    v_mul_f32 v92, v92, v124
    v_mul_f32 v93, v93, v125
    v_mul_f32 v94, v94, v126
    v_mul_f32 v95, v95, v127
    v_cvt_pk_bf16_f32 v80, 0, v80
    v_cvt_pk_bf16_f32 v81, 0, v81
    v_cvt_pk_bf16_f32 v82, 0, v82
    v_cvt_pk_bf16_f32 v83, 0, v83
    v_cvt_pk_bf16_f32 v84, 0, v84
    v_cvt_pk_bf16_f32 v85, 0, v85
    v_cvt_pk_bf16_f32 v86, 0, v86
    v_cvt_pk_bf16_f32 v87, 0, v87
    v_cvt_pk_bf16_f32 v88, 0, v88
    v_cvt_pk_bf16_f32 v89, 0, v89
    v_cvt_pk_bf16_f32 v90, 0, v90
    v_cvt_pk_bf16_f32 v91, 0, v91
    v_cvt_pk_bf16_f32 v92, 0, v92
    v_cvt_pk_bf16_f32 v93, 0, v93
    v_cvt_pk_bf16_f32 v94, 0, v94
    v_cvt_pk_bf16_f32 v95, 0, v95
    v_add_f32 v16, v16, v80
    v_add_f32 v17, v17, v81
    v_add_f32 v18, v18, v82
    v_add_f32 v19, v19, v83
    v_add_f32 v20, v20, v84
    v_add_f32 v21, v21, v85
    v_add_f32 v22, v22, v86
    v_add_f32 v23, v23, v87
    v_add_f32 v24, v24, v88
    v_add_f32 v25, v25, v89
    v_add_f32 v26, v26, v90
    v_add_f32 v27, v27, v91
    v_add_f32 v28, v28, v92
    v_add_f32 v29, v29, v93
    v_add_f32 v30, v30, v94
    v_add_f32 v31, v31, v95
    v_cvt_pk_bf16_f32 v16, 0, v16
    v_cvt_pk_bf16_f32 v17, 0, v17
    v_cvt_pk_bf16_f32 v18, 0, v18
    v_cvt_pk_bf16_f32 v19, 0, v19
    v_cvt_pk_bf16_f32 v20, 0, v20
    v_cvt_pk_bf16_f32 v21, 0, v21
    v_cvt_pk_bf16_f32 v22, 0, v22
    v_cvt_pk_bf16_f32 v23, 0, v23
    v_cvt_pk_bf16_f32 v24, 0, v24
    v_cvt_pk_bf16_f32 v25, 0, v25
    v_cvt_pk_bf16_f32 v26, 0, v26
    v_cvt_pk_bf16_f32 v27, 0, v27
    v_cvt_pk_bf16_f32 v28, 0, v28
    v_cvt_pk_bf16_f32 v29, 0, v29
    v_cvt_pk_bf16_f32 v30, 0, v30
    v_cvt_pk_bf16_f32 v31, 0, v31
    v_cvt_pk_bf16_f32 v80, v16, v17
    v_cvt_pk_bf16_f32 v81, v18, v19
    v_cvt_pk_bf16_f32 v82, v20, v21
    v_cvt_pk_bf16_f32 v83, v22, v23
    v_cvt_pk_bf16_f32 v84, v24, v25
    v_cvt_pk_bf16_f32 v85, v26, v27
    v_cvt_pk_bf16_f32 v86, v28, v29
    v_cvt_pk_bf16_f32 v87, v30, v31
    buffer_store_dwordx4 v[80:83], v1, s[40:43], 0 offen
    buffer_store_dwordx4 v[84:87], v1, s[40:43], 0 offen offset:1024
    v_add_f32 v12, v16, v17
    v_add_f32 v12, v12, v18
    v_add_f32 v12, v12, v19
    v_add_f32 v12, v12, v20
    v_add_f32 v12, v12, v21
    v_add_f32 v12, v12, v22
    v_add_f32 v12, v12, v23
    v_add_f32 v12, v12, v24
    v_add_f32 v12, v12, v25
    v_add_f32 v12, v12, v26
    v_add_f32 v12, v12, v27
    v_add_f32 v12, v12, v28
    v_add_f32 v12, v12, v29
    v_add_f32 v12, v12, v30
    v_add_f32 v12, v12, v31
    ds_swizzle_b32 v13, v12 offset:0x41f
    s_waitcnt lgkmcnt(0)
    v_add_f32 v12, v12, v13
    ds_swizzle_b32 v13, v12 offset:0x81f
    s_waitcnt lgkmcnt(0)
    v_add_f32 v12, v12, v13
    ds_swizzle_b32 v13, v12 offset:0x101f
    s_waitcnt lgkmcnt(0)
    v_add_f32 v12, v12, v13
    ds_swizzle_b32 v13, v12 offset:0x201f
    s_waitcnt lgkmcnt(0)
    v_add_f32 v12, v12, v13
    ds_swizzle_b32 v13, v12 offset:0x401f
    s_waitcnt lgkmcnt(0)
    v_add_f32 v12, v12, v13
    v_mov_b32 v13, v12
    s_nop 1
    v_permlane32_swap_b32 v12, v13
    v_add_f32 v12, v12, v13
    v_mul_f32 v12, 0x3a800000, v12
    v_mov_b32 v14, 0
    v_sub_f32 v13, v16, v12
    v_fmac_f32 v14, v13, v13
    v_sub_f32 v13, v17, v12
    v_fmac_f32 v14, v13, v13
    v_sub_f32 v13, v18, v12
    v_fmac_f32 v14, v13, v13
    v_sub_f32 v13, v19, v12
    v_fmac_f32 v14, v13, v13
    v_sub_f32 v13, v20, v12
    v_fmac_f32 v14, v13, v13
    v_sub_f32 v13, v21, v12
    v_fmac_f32 v14, v13, v13
    v_sub_f32 v13, v22, v12
    v_fmac_f32 v14, v13, v13
    v_sub_f32 v13, v23, v12
    v_fmac_f32 v14, v13, v13
    v_sub_f32 v13, v24, v12
    v_fmac_f32 v14, v13, v13
    v_sub_f32 v13, v25, v12
    v_fmac_f32 v14, v13, v13
    v_sub_f32 v13, v26, v12
    v_fmac_f32 v14, v13, v13
    v_sub_f32 v13, v27, v12
    v_fmac_f32 v14, v13, v13
    v_sub_f32 v13, v28, v12
    v_fmac_f32 v14, v13, v13
    v_sub_f32 v13, v29, v12
    v_fmac_f32 v14, v13, v13
    v_sub_f32 v13, v30, v12
    v_fmac_f32 v14, v13, v13
    v_sub_f32 v13, v31, v12
    v_fmac_f32 v14, v13, v13
    ds_swizzle_b32 v13, v14 offset:0x41f
    s_waitcnt lgkmcnt(0)
    v_add_f32 v14, v14, v13
    ds_swizzle_b32 v13, v14 offset:0x81f
    s_waitcnt lgkmcnt(0)
    v_add_f32 v14, v14, v13
    ds_swizzle_b32 v13, v14 offset:0x101f
    s_waitcnt lgkmcnt(0)
    v_add_f32 v14, v14, v13
    ds_swizzle_b32 v13, v14 offset:0x201f
    s_waitcnt lgkmcnt(0)
    v_add_f32 v14, v14, v13
    ds_swizzle_b32 v13, v14 offset:0x401f
    s_waitcnt lgkmcnt(0)
    v_add_f32 v14, v14, v13
    v_mov_b32 v13, v14
    s_nop 1
    v_permlane32_swap_b32 v14, v13
    v_add_f32 v14, v14, v13
    v_mul_f32 v14, 0x3a800000, v14
    v_cvt_pk_bf16_f32 v12, 0, v12
    v_cvt_pk_bf16_f32 v14, 0, v14
    v_add_f32 v14, 0x3727c5ac, v14
    v_cvt_pk_bf16_f32 v14, 0, v14
    v_sqrt_f32 v14, v14
    s_nop 0
    v_cvt_pk_bf16_f32 v14, 0, v14
    v_rcp_f32 v15, v14
    s_waitcnt vmcnt(0)
    v_sub_f32 v16, v16, v12
    v_cvt_pk_bf16_f32 v16, 0, v16
    v_mul_f32 v13, v16, v15
    v_fma_f32 v32, -v13, v14, v16
    v_fma_f32 v13, v32, v15, v13
    v_cvt_pk_bf16_f32 v13, 0, v13
    v_add_f32 v32, 1.0, v64
    v_cvt_pk_bf16_f32 v32, 0, v32
    v_mul_f32 v13, v13, v32
    v_cvt_pk_bf16_f32 v13, 0, v13
    v_add_f32 v16, v13, v48
    v_sub_f32 v17, v17, v12
    v_cvt_pk_bf16_f32 v17, 0, v17
    v_mul_f32 v13, v17, v15
    v_fma_f32 v32, -v13, v14, v17
    v_fma_f32 v13, v32, v15, v13
    v_cvt_pk_bf16_f32 v13, 0, v13
    v_add_f32 v32, 1.0, v65
    v_cvt_pk_bf16_f32 v32, 0, v32
    v_mul_f32 v13, v13, v32
    v_cvt_pk_bf16_f32 v13, 0, v13
    v_add_f32 v17, v13, v49
    v_sub_f32 v18, v18, v12
    v_cvt_pk_bf16_f32 v18, 0, v18
    v_mul_f32 v13, v18, v15
    v_fma_f32 v32, -v13, v14, v18
    v_fma_f32 v13, v32, v15, v13
    v_cvt_pk_bf16_f32 v13, 0, v13
    v_add_f32 v32, 1.0, v66
    v_cvt_pk_bf16_f32 v32, 0, v32
    v_mul_f32 v13, v13, v32
    v_cvt_pk_bf16_f32 v13, 0, v13
    v_add_f32 v18, v13, v50
    v_sub_f32 v19, v19, v12
    v_cvt_pk_bf16_f32 v19, 0, v19
    v_mul_f32 v13, v19, v15
    v_fma_f32 v32, -v13, v14, v19
    v_fma_f32 v13, v32, v15, v13
    v_cvt_pk_bf16_f32 v13, 0, v13
    v_add_f32 v32, 1.0, v67
    v_cvt_pk_bf16_f32 v32, 0, v32
    v_mul_f32 v13, v13, v32
    v_cvt_pk_bf16_f32 v13, 0, v13
    v_add_f32 v19, v13, v51
    v_sub_f32 v20, v20, v12
    v_cvt_pk_bf16_f32 v20, 0, v20
    v_mul_f32 v13, v20, v15
    v_fma_f32 v32, -v13, v14, v20
    v_fma_f32 v13, v32, v15, v13
    v_cvt_pk_bf16_f32 v13, 0, v13
    v_add_f32 v32, 1.0, v68
    v_cvt_pk_bf16_f32 v32, 0, v32
    v_mul_f32 v13, v13, v32
    v_cvt_pk_bf16_f32 v13, 0, v13
    v_add_f32 v20, v13, v52
    v_sub_f32 v21, v21, v12
    v_cvt_pk_bf16_f32 v21, 0, v21
    v_mul_f32 v13, v21, v15
    v_fma_f32 v32, -v13, v14, v21
    v_fma_f32 v13, v32, v15, v13
    v_cvt_pk_bf16_f32 v13, 0, v13
    v_add_f32 v32, 1.0, v69
    v_cvt_pk_bf16_f32 v32, 0, v32
    v_mul_f32 v13, v13, v32
    v_cvt_pk_bf16_f32 v13, 0, v13
    v_add_f32 v21, v13, v53
    v_sub_f32 v22, v22, v12
    v_cvt_pk_bf16_f32 v22, 0, v22
    v_mul_f32 v13, v22, v15
    v_fma_f32 v32, -v13, v14, v22
    v_fma_f32 v13, v32, v15, v13
    v_cvt_pk_bf16_f32 v13, 0, v13
    v_add_f32 v32, 1.0, v70
    v_cvt_pk_bf16_f32 v32, 0, v32
    v_mul_f32 v13, v13, v32
    v_cvt_pk_bf16_f32 v13, 0, v13
    v_add_f32 v22, v13, v54
    v_sub_f32 v23, v23, v12
    v_cvt_pk_bf16_f32 v23, 0, v23
    v_mul_f32 v13, v23, v15
    v_fma_f32 v32, -v13, v14, v23
    v_fma_f32 v13, v32, v15, v13
    v_cvt_pk_bf16_f32 v13, 0, v13
    v_add_f32 v32, 1.0, v71
    v_cvt_pk_bf16_f32 v32, 0, v32
    v_mul_f32 v13, v13, v32
    v_cvt_pk_bf16_f32 v13, 0, v13
    v_add_f32 v23, v13, v55
    v_sub_f32 v24, v24, v12
    v_cvt_pk_bf16_f32 v24, 0, v24
    v_mul_f32 v13, v24, v15
    v_fma_f32 v32, -v13, v14, v24
    v_fma_f32 v13, v32, v15, v13
    v_cvt_pk_bf16_f32 v13, 0, v13
    v_add_f32 v32, 1.0, v72
    v_cvt_pk_bf16_f32 v32, 0, v32
    v_mul_f32 v13, v13, v32
    v_cvt_pk_bf16_f32 v13, 0, v13
    v_add_f32 v24, v13, v56
    v_sub_f32 v25, v25, v12
    v_cvt_pk_bf16_f32 v25, 0, v25
    v_mul_f32 v13, v25, v15
    v_fma_f32 v32, -v13, v14, v25
    v_fma_f32 v13, v32, v15, v13
    v_cvt_pk_bf16_f32 v13, 0, v13
    v_add_f32 v32, 1.0, v73
    v_cvt_pk_bf16_f32 v32, 0, v32
    v_mul_f32 v13, v13, v32
    v_cvt_pk_bf16_f32 v13, 0, v13
    v_add_f32 v25, v13, v57
    v_sub_f32 v26, v26, v12
    v_cvt_pk_bf16_f32 v26, 0, v26
    v_mul_f32 v13, v26, v15
    v_fma_f32 v32, -v13, v14, v26
    v_fma_f32 v13, v32, v15, v13
    v_cvt_pk_bf16_f32 v13, 0, v13
    v_add_f32 v32, 1.0, v74
    v_cvt_pk_bf16_f32 v32, 0, v32
    v_mul_f32 v13, v13, v32
    v_cvt_pk_bf16_f32 v13, 0, v13
    v_add_f32 v26, v13, v58
    v_sub_f32 v27, v27, v12
    v_cvt_pk_bf16_f32 v27, 0, v27
    v_mul_f32 v13, v27, v15
    v_fma_f32 v32, -v13, v14, v27
    v_fma_f32 v13, v32, v15, v13
    v_cvt_pk_bf16_f32 v13, 0, v13
    v_add_f32 v32, 1.0, v75
    v_cvt_pk_bf16_f32 v32, 0, v32
    v_mul_f32 v13, v13, v32
    v_cvt_pk_bf16_f32 v13, 0, v13
    v_add_f32 v27, v13, v59
    v_sub_f32 v28, v28, v12
    v_cvt_pk_bf16_f32 v28, 0, v28
    v_mul_f32 v13, v28, v15
    v_fma_f32 v32, -v13, v14, v28
    v_fma_f32 v13, v32, v15, v13
    v_cvt_pk_bf16_f32 v13, 0, v13
    v_add_f32 v32, 1.0, v76
    v_cvt_pk_bf16_f32 v32, 0, v32
    v_mul_f32 v13, v13, v32
    v_cvt_pk_bf16_f32 v13, 0, v13
    v_add_f32 v28, v13, v60
    v_sub_f32 v29, v29, v12
    v_cvt_pk_bf16_f32 v29, 0, v29
    v_mul_f32 v13, v29, v15
    v_fma_f32 v32, -v13, v14, v29
    v_fma_f32 v13, v32, v15, v13
    v_cvt_pk_bf16_f32 v13, 0, v13
    v_add_f32 v32, 1.0, v77
    v_cvt_pk_bf16_f32 v32, 0, v32
    v_mul_f32 v13, v13, v32
    v_cvt_pk_bf16_f32 v13, 0, v13
    v_add_f32 v29, v13, v61
    v_sub_f32 v30, v30, v12
    v_cvt_pk_bf16_f32 v30, 0, v30
    v_mul_f32 v13, v30, v15
    v_fma_f32 v32, -v13, v14, v30
    v_fma_f32 v13, v32, v15, v13
    v_cvt_pk_bf16_f32 v13, 0, v13
    v_add_f32 v32, 1.0, v78
    v_cvt_pk_bf16_f32 v32, 0, v32
    v_mul_f32 v13, v13, v32
    v_cvt_pk_bf16_f32 v13, 0, v13
    v_add_f32 v30, v13, v62
    v_sub_f32 v31, v31, v12
    v_cvt_pk_bf16_f32 v31, 0, v31
    v_mul_f32 v13, v31, v15
    v_fma_f32 v32, -v13, v14, v31
    v_fma_f32 v13, v32, v15, v13
    v_cvt_pk_bf16_f32 v13, 0, v13
    v_add_f32 v32, 1.0, v79
    v_cvt_pk_bf16_f32 v32, 0, v32
    v_mul_f32 v13, v13, v32
    v_cvt_pk_bf16_f32 v13, 0, v13
    v_add_f32 v31, v13, v63
    v_cvt_pk_bf16_f32 v4, v16, v17
    v_cvt_pk_bf16_f32 v5, v18, v19
    v_cvt_pk_bf16_f32 v6, v20, v21
    v_cvt_pk_bf16_f32 v7, v22, v23
    v_cvt_pk_bf16_f32 v8, v24, v25
    v_cvt_pk_bf16_f32 v9, v26, v27
    v_cvt_pk_bf16_f32 v10, v28, v29
    v_cvt_pk_bf16_f32 v11, v30, v31
    buffer_store_dwordx4 v[4:7], v1, s[20:23], 0 offen
    buffer_store_dwordx4 v[8:11], v1, s[20:23], 0 offen offset:1024
L_ln2_kernel_end:
    s_endpgm
.globl gu_kernel
.p2align 8
.type gu_kernel,@function
gu_kernel:
    s_cmp_ge_u32 s2, 256
    s_cbranch_scc1 L_gu_kernel_end
    s_load_dwordx2 s[4:5], s[0:1], 104
    s_load_dwordx4 s[40:43], s[0:1], 48
    v_lshrrev_b32 v1, 6, v0
    v_and_b32 v0, 63, v0
    s_nop 0
    v_readfirstlane_b32 s34, v1
    s_and_b32 s3, s2, 7
    s_lshr_b32 s35, s2, 3
    s_and_b32 s32, s3, 1
    s_lshl_b32 s32, s32, 2
    s_and_b32 s36, s35, 3
    s_add_u32 s32, s32, s36
    s_lshr_b32 s33, s3, 1
    s_lshl_b32 s33, s33, 3
    s_lshr_b32 s36, s35, 2
    s_add_u32 s33, s33, s36
    s_lshl_b32 s32, s32, 8
    s_waitcnt lgkmcnt(0)
    s_add_u32 s8, s4, 0x900000
    s_addc_u32 s9, s5, 0
    s_mov_b32 s10, 0x400000
    s_mov_b32 s11, 0x00020000
    s_add_u32 s20, s4, 0x3000000
    s_addc_u32 s21, s5, 0
    s_mov_b32 s22, 0xe00000
    s_mov_b32 s23, 0x00020000
    s_cmp_ge_u32 s34, 4
    s_cselect_b32 s12, s42, s40
    s_cselect_b32 s13, s43, s41
    s_mov_b32 s14, 7340032
    s_mov_b32 s15, 0x00020000
    v_and_b32 v198, 15, v0
    v_lshrrev_b32 v199, 4, v0
    v_lshrrev_b32 v200, 1, v198
    v_xor_b32 v200, v199, v200
    v_lshlrev_b32 v200, 4, v200
    v_lshl_add_u32 v200, v198, 7, v200
    s_lshl_b32 s38, s34, 12
    v_add_u32 v188, s38, v200
    v_xor_b32 v189, 64, v188
    v_lshrrev_b32 v200, 3, v198
    v_and_b32 v201, 1, v199
    v_lshl_or_b32 v200, v201, 1, v200
    v_lshlrev_b32 v200, 5, v200
    v_and_b32 v201, 3, v198
    v_lshl_add_u32 v200, v201, 3, v200
    v_lshrrev_b32 v201, 2, v198
    v_lshl_add_u32 v201, v199, 3, v201
    v_lshl_add_u32 v190, v201, 7, v200
    v_add_u32 v190, 32768, v190
    v_xor_b32 v191, 32, v190
    v_xor_b32 v192, 64, v190
    v_xor_b32 v193, 96, v190
    v_lshrrev_b32 v200, 3, v0
    v_and_b32 v201, 7, v0
    s_lshl_b32 s37, s34, 5
    s_add_u32 s37, s37, s32
    v_add_u32 v203, 0, v199
    v_and_b32 v203, 7, v203
    v_xor_b32 v203, v201, v203
    v_lshlrev_b32 v203, 4, v203
    v_add_u32 v204, s37, v200
    v_add_u32 v204, 0, v204
    v_lshl_add_u32 v194, v204, 11, v203
    v_add_u32 v203, 4, v199
    v_and_b32 v203, 7, v203
    v_xor_b32 v203, v201, v203
    v_lshlrev_b32 v203, 4, v203
    v_add_u32 v204, s37, v200
    v_add_u32 v204, 8, v204
    v_lshl_add_u32 v195, v204, 11, v203
    s_and_b32 s37, s34, 1
    s_lshl_b32 s37, s37, 5
    s_mul_i32 s38, s33, 224
    s_bfe_u32 s39, s34, 0x10001
    s_lshl_b32 s39, s39, 7
    s_add_u32 s38, s38, s39
    s_mov_b32 s48, 7168
    v_and_b32 v203, 1, v199
    v_or_b32 v203, 0, v203
    v_lshrrev_b32 v204, 1, v201
    v_xor_b32 v203, v204, v203
    v_lshlrev_b32 v203, 5, v203
    v_and_b32 v204, 1, v201
    v_lshl_add_u32 v203, v204, 4, v203
    v_add_u32 v204, s37, v200
    v_add_u32 v204, 0, v204
    v_mul_lo_u32 v204, v204, s48
    v_add3_u32 v196, v204, v203, s38
    v_and_b32 v203, 1, v199
    v_or_b32 v203, 2, v203
    v_lshrrev_b32 v204, 1, v201
    v_xor_b32 v203, v204, v203
    v_lshlrev_b32 v203, 5, v203
    v_and_b32 v204, 1, v201
    v_lshl_add_u32 v203, v204, 4, v203
    v_add_u32 v204, s37, v200
    v_add_u32 v204, 8, v204
    v_mul_lo_u32 v204, v204, s48
    v_add3_u32 v197, v204, v203, s38
    s_lshl_b32 s50, s34, 12
    s_lshl_b32 s51, s34, 12
    s_add_u32 s51, s51, 32768
    s_mov_b32 s52, 0
    s_mov_b32 s53, 0
    s_mov_b32 s39, 0
    v_mov_b32 v4, 0
    v_mov_b32 v5, 0
    v_mov_b32 v6, 0
    v_mov_b32 v7, 0
    v_mov_b32 v8, 0
    v_mov_b32 v9, 0
    v_mov_b32 v10, 0
    v_mov_b32 v11, 0
    v_mov_b32 v12, 0
    v_mov_b32 v13, 0
    v_mov_b32 v14, 0
    v_mov_b32 v15, 0
    v_mov_b32 v16, 0
    v_mov_b32 v17, 0
    v_mov_b32 v18, 0
    v_mov_b32 v19, 0
    v_mov_b32 v20, 0
    v_mov_b32 v21, 0
    v_mov_b32 v22, 0
    v_mov_b32 v23, 0
    v_mov_b32 v24, 0
    v_mov_b32 v25, 0
    v_mov_b32 v26, 0
    v_mov_b32 v27, 0
    v_mov_b32 v28, 0
    v_mov_b32 v29, 0
    v_mov_b32 v30, 0
    v_mov_b32 v31, 0
    v_mov_b32 v32, 0
    v_mov_b32 v33, 0
    v_mov_b32 v34, 0
    v_mov_b32 v35, 0
    v_mov_b32 v36, 0
    v_mov_b32 v37, 0
    v_mov_b32 v38, 0
    v_mov_b32 v39, 0
    v_mov_b32 v40, 0
    v_mov_b32 v41, 0
    v_mov_b32 v42, 0
    v_mov_b32 v43, 0
    v_mov_b32 v44, 0
    v_mov_b32 v45, 0
    v_mov_b32 v46, 0
    v_mov_b32 v47, 0
    v_mov_b32 v48, 0
    v_mov_b32 v49, 0
    v_mov_b32 v50, 0
    v_mov_b32 v51, 0
    v_mov_b32 v52, 0
    v_mov_b32 v53, 0
    v_mov_b32 v54, 0
    v_mov_b32 v55, 0
    v_mov_b32 v56, 0
    v_mov_b32 v57, 0
    v_mov_b32 v58, 0
    v_mov_b32 v59, 0
    v_mov_b32 v60, 0
    v_mov_b32 v61, 0
    v_mov_b32 v62, 0
    v_mov_b32 v63, 0
    v_mov_b32 v64, 0
    v_mov_b32 v65, 0
    v_mov_b32 v66, 0
    v_mov_b32 v67, 0
    v_mov_b32 v68, 0
    v_mov_b32 v69, 0
    v_mov_b32 v70, 0
    v_mov_b32 v71, 0
    v_mov_b32 v72, 0
    v_mov_b32 v73, 0
    v_mov_b32 v74, 0
    v_mov_b32 v75, 0
    v_mov_b32 v76, 0
    v_mov_b32 v77, 0
    v_mov_b32 v78, 0
    v_mov_b32 v79, 0
    v_mov_b32 v80, 0
    v_mov_b32 v81, 0
    v_mov_b32 v82, 0
    v_mov_b32 v83, 0
    v_mov_b32 v84, 0
    v_mov_b32 v85, 0
    v_mov_b32 v86, 0
    v_mov_b32 v87, 0
    v_mov_b32 v88, 0
    v_mov_b32 v89, 0
    v_mov_b32 v90, 0
    v_mov_b32 v91, 0
    v_mov_b32 v92, 0
    v_mov_b32 v93, 0
    v_mov_b32 v94, 0
    v_mov_b32 v95, 0
    v_mov_b32 v96, 0
    v_mov_b32 v97, 0
    v_mov_b32 v98, 0
    v_mov_b32 v99, 0
    v_mov_b32 v100, 0
    v_mov_b32 v101, 0
    v_mov_b32 v102, 0
    v_mov_b32 v103, 0
    v_mov_b32 v104, 0
    v_mov_b32 v105, 0
    v_mov_b32 v106, 0
    v_mov_b32 v107, 0
    v_mov_b32 v108, 0
    v_mov_b32 v109, 0
    v_mov_b32 v110, 0
    v_mov_b32 v111, 0
    v_mov_b32 v112, 0
    v_mov_b32 v113, 0
    v_mov_b32 v114, 0
    v_mov_b32 v115, 0
    s_add_u32 s54, s39, s50
    s_add_u32 m0, s54, 0
    s_add_u32 s55, s52, 0
    buffer_load_dwordx4 v194, s[8:11], s55 offen lds
    s_add_u32 s54, s39, s50
    s_add_u32 m0, s54, 1024
    s_add_u32 s55, s52, 0
    buffer_load_dwordx4 v195, s[8:11], s55 offen lds
    s_add_u32 s54, s39, s50
    s_add_u32 m0, s54, 2048
    s_add_u32 s55, s52, 32768
    buffer_load_dwordx4 v194, s[8:11], s55 offen lds
    s_add_u32 s54, s39, s50
    s_add_u32 m0, s54, 3072
    s_add_u32 s55, s52, 32768
    buffer_load_dwordx4 v195, s[8:11], s55 offen lds
    s_add_u32 s54, s39, s51
    s_add_u32 m0, s54, 0
    s_add_u32 s55, s53, 0
    buffer_load_dwordx4 v196, s[12:15], s55 offen lds
    s_add_u32 s54, s39, s51
    s_add_u32 m0, s54, 1024
    s_add_u32 s55, s53, 0
    buffer_load_dwordx4 v197, s[12:15], s55 offen lds
    s_add_u32 s54, s39, s51
    s_add_u32 m0, s54, 2048
    s_add_u32 s55, s53, 114688
    buffer_load_dwordx4 v196, s[12:15], s55 offen lds
    s_add_u32 s54, s39, s51
    s_add_u32 m0, s54, 3072
    s_add_u32 s55, s53, 114688
    buffer_load_dwordx4 v197, s[12:15], s55 offen lds
    s_add_u32 s52, s52, 128
    s_add_u32 s53, s53, 458752
    s_xor_b32 s39, s39, 65536
    s_add_u32 s54, s39, s50
    s_add_u32 m0, s54, 0
    s_add_u32 s55, s52, 0
    buffer_load_dwordx4 v194, s[8:11], s55 offen lds
    s_add_u32 s54, s39, s50
    s_add_u32 m0, s54, 1024
    s_add_u32 s55, s52, 0
    buffer_load_dwordx4 v195, s[8:11], s55 offen lds
    s_add_u32 s54, s39, s50
    s_add_u32 m0, s54, 2048
    s_add_u32 s55, s52, 32768
    buffer_load_dwordx4 v194, s[8:11], s55 offen lds
    s_add_u32 s54, s39, s50
    s_add_u32 m0, s54, 3072
    s_add_u32 s55, s52, 32768
    buffer_load_dwordx4 v195, s[8:11], s55 offen lds
    s_add_u32 s54, s39, s51
    s_add_u32 m0, s54, 0
    s_add_u32 s55, s53, 0
    buffer_load_dwordx4 v196, s[12:15], s55 offen lds
    s_add_u32 s54, s39, s51
    s_add_u32 m0, s54, 1024
    s_add_u32 s55, s53, 0
    buffer_load_dwordx4 v197, s[12:15], s55 offen lds
    s_add_u32 s54, s39, s51
    s_add_u32 m0, s54, 2048
    s_add_u32 s55, s53, 114688
    buffer_load_dwordx4 v196, s[12:15], s55 offen lds
    s_add_u32 s54, s39, s51
    s_add_u32 m0, s54, 3072
    s_add_u32 s55, s53, 114688
    buffer_load_dwordx4 v197, s[12:15], s55 offen lds
    s_add_u32 s52, s52, 128
    s_add_u32 s53, s53, 458752
    s_xor_b32 s39, s39, 65536
    s_waitcnt vmcnt(8)
    s_barrier
    s_mov_b32 s35, 0
    ds_read_b128 v[116:119], v188 offset:0
    ds_read_b128 v[120:123], v188 offset:2048
    ds_read_b64_tr_b16 v[132:133], v190 offset:0
    ds_read_b64_tr_b16 v[134:135], v190 offset:512
    ds_read_b64_tr_b16 v[136:137], v191 offset:0
    ds_read_b64_tr_b16 v[138:139], v191 offset:512
    ds_read_b64_tr_b16 v[140:141], v192 offset:0
    ds_read_b64_tr_b16 v[142:143], v192 offset:512
    ds_read_b64_tr_b16 v[144:145], v193 offset:0
    ds_read_b64_tr_b16 v[146:147], v193 offset:512
    ds_read_b64_tr_b16 v[148:149], v190 offset:8192
    ds_read_b64_tr_b16 v[150:151], v190 offset:8704
    ds_read_b64_tr_b16 v[152:153], v191 offset:8192
    ds_read_b64_tr_b16 v[154:155], v191 offset:8704
    ds_read_b64_tr_b16 v[156:157], v192 offset:8192
    ds_read_b64_tr_b16 v[158:159], v192 offset:8704
L_gu_kernel_loop:
    s_waitcnt lgkmcnt(0)
    v_mfma_f32_16x16x32_bf16 v[4:7], v[132:135], v[116:119], v[4:7]
    ds_read_b64_tr_b16 v[160:161], v190 offset:16384
    ds_read_b64_tr_b16 v[162:163], v190 offset:16896
    v_mfma_f32_16x16x32_bf16 v[60:63], v[132:135], v[120:123], v[60:63]
    ds_read_b64_tr_b16 v[164:165], v191 offset:16384
    v_mfma_f32_16x16x32_bf16 v[8:11], v[136:139], v[116:119], v[8:11]
    ds_read_b64_tr_b16 v[166:167], v191 offset:16896
    ds_read_b64_tr_b16 v[168:169], v192 offset:16384
    v_mfma_f32_16x16x32_bf16 v[64:67], v[136:139], v[120:123], v[64:67]
    ds_read_b64_tr_b16 v[170:171], v192 offset:16896
    v_mfma_f32_16x16x32_bf16 v[12:15], v[140:143], v[116:119], v[12:15]
    ds_read_b64_tr_b16 v[172:173], v193 offset:16384
    ds_read_b64_tr_b16 v[174:175], v193 offset:16896
    v_mfma_f32_16x16x32_bf16 v[68:71], v[140:143], v[120:123], v[68:71]
    ds_read_b64_tr_b16 v[176:177], v190 offset:24576
    v_mfma_f32_16x16x32_bf16 v[16:19], v[144:147], v[116:119], v[16:19]
    ds_read_b64_tr_b16 v[178:179], v190 offset:25088
    v_mfma_f32_16x16x32_bf16 v[72:75], v[144:147], v[120:123], v[72:75]
    ds_read_b64_tr_b16 v[180:181], v191 offset:24576
    ds_read_b64_tr_b16 v[182:183], v191 offset:25088
    v_mfma_f32_16x16x32_bf16 v[20:23], v[148:151], v[116:119], v[20:23]
    ds_read_b64_tr_b16 v[184:185], v192 offset:24576
    v_mfma_f32_16x16x32_bf16 v[76:79], v[148:151], v[120:123], v[76:79]
    ds_read_b64_tr_b16 v[186:187], v192 offset:25088
    v_mfma_f32_16x16x32_bf16 v[24:27], v[152:155], v[116:119], v[24:27]
    v_mfma_f32_16x16x32_bf16 v[80:83], v[152:155], v[120:123], v[80:83]
    v_mfma_f32_16x16x32_bf16 v[28:31], v[156:159], v[116:119], v[28:31]
    v_mfma_f32_16x16x32_bf16 v[84:87], v[156:159], v[120:123], v[84:87]
    s_waitcnt lgkmcnt(0)
    v_mfma_f32_16x16x32_bf16 v[32:35], v[160:163], v[116:119], v[32:35]
    ds_read_b128 v[124:127], v189 offset:0
    ds_read_b128 v[128:131], v189 offset:2048
    v_mfma_f32_16x16x32_bf16 v[88:91], v[160:163], v[120:123], v[88:91]
    ds_read_b64_tr_b16 v[132:133], v190 offset:4096
    ds_read_b64_tr_b16 v[134:135], v190 offset:4608
    v_mfma_f32_16x16x32_bf16 v[36:39], v[164:167], v[116:119], v[36:39]
    ds_read_b64_tr_b16 v[136:137], v191 offset:4096
    v_mfma_f32_16x16x32_bf16 v[92:95], v[164:167], v[120:123], v[92:95]
    ds_read_b64_tr_b16 v[138:139], v191 offset:4608
    ds_read_b64_tr_b16 v[140:141], v192 offset:4096
    v_mfma_f32_16x16x32_bf16 v[40:43], v[168:171], v[116:119], v[40:43]
    ds_read_b64_tr_b16 v[142:143], v192 offset:4608
    ds_read_b64_tr_b16 v[144:145], v193 offset:4096
    v_mfma_f32_16x16x32_bf16 v[96:99], v[168:171], v[120:123], v[96:99]
    ds_read_b64_tr_b16 v[146:147], v193 offset:4608
    v_mfma_f32_16x16x32_bf16 v[44:47], v[172:175], v[116:119], v[44:47]
    ds_read_b64_tr_b16 v[148:149], v190 offset:12288
    ds_read_b64_tr_b16 v[150:151], v190 offset:12800
    v_mfma_f32_16x16x32_bf16 v[100:103], v[172:175], v[120:123], v[100:103]
    ds_read_b64_tr_b16 v[152:153], v191 offset:12288
    v_mfma_f32_16x16x32_bf16 v[48:51], v[176:179], v[116:119], v[48:51]
    ds_read_b64_tr_b16 v[154:155], v191 offset:12800
    ds_read_b64_tr_b16 v[156:157], v192 offset:12288
    v_mfma_f32_16x16x32_bf16 v[104:107], v[176:179], v[120:123], v[104:107]
    ds_read_b64_tr_b16 v[158:159], v192 offset:12800
    v_mfma_f32_16x16x32_bf16 v[52:55], v[180:183], v[116:119], v[52:55]
    v_mfma_f32_16x16x32_bf16 v[108:111], v[180:183], v[120:123], v[108:111]
    v_mfma_f32_16x16x32_bf16 v[56:59], v[184:187], v[116:119], v[56:59]
    v_mfma_f32_16x16x32_bf16 v[112:115], v[184:187], v[120:123], v[112:115]
    s_waitcnt lgkmcnt(0)
    v_mfma_f32_16x16x32_bf16 v[4:7], v[132:135], v[124:127], v[4:7]
    ds_read_b64_tr_b16 v[160:161], v190 offset:20480
    ds_read_b64_tr_b16 v[162:163], v190 offset:20992
    v_mfma_f32_16x16x32_bf16 v[60:63], v[132:135], v[128:131], v[60:63]
    ds_read_b64_tr_b16 v[164:165], v191 offset:20480
    v_mfma_f32_16x16x32_bf16 v[8:11], v[136:139], v[124:127], v[8:11]
    ds_read_b64_tr_b16 v[166:167], v191 offset:20992
    ds_read_b64_tr_b16 v[168:169], v192 offset:20480
    v_mfma_f32_16x16x32_bf16 v[64:67], v[136:139], v[128:131], v[64:67]
    ds_read_b64_tr_b16 v[170:171], v192 offset:20992
    v_mfma_f32_16x16x32_bf16 v[12:15], v[140:143], v[124:127], v[12:15]
    ds_read_b64_tr_b16 v[172:173], v193 offset:20480
    ds_read_b64_tr_b16 v[174:175], v193 offset:20992
    v_mfma_f32_16x16x32_bf16 v[68:71], v[140:143], v[128:131], v[68:71]
    ds_read_b64_tr_b16 v[176:177], v190 offset:28672
    v_mfma_f32_16x16x32_bf16 v[16:19], v[144:147], v[124:127], v[16:19]
    ds_read_b64_tr_b16 v[178:179], v190 offset:29184
    v_mfma_f32_16x16x32_bf16 v[72:75], v[144:147], v[128:131], v[72:75]
    ds_read_b64_tr_b16 v[180:181], v191 offset:28672
    ds_read_b64_tr_b16 v[182:183], v191 offset:29184
    v_mfma_f32_16x16x32_bf16 v[20:23], v[148:151], v[124:127], v[20:23]
    ds_read_b64_tr_b16 v[184:185], v192 offset:28672
    v_mfma_f32_16x16x32_bf16 v[76:79], v[148:151], v[128:131], v[76:79]
    ds_read_b64_tr_b16 v[186:187], v192 offset:29184
    v_mfma_f32_16x16x32_bf16 v[24:27], v[152:155], v[124:127], v[24:27]
    v_mfma_f32_16x16x32_bf16 v[80:83], v[152:155], v[128:131], v[80:83]
    v_mfma_f32_16x16x32_bf16 v[28:31], v[156:159], v[124:127], v[28:31]
    v_mfma_f32_16x16x32_bf16 v[84:87], v[156:159], v[128:131], v[84:87]
    s_waitcnt lgkmcnt(0)
    s_waitcnt vmcnt(0)
    s_barrier
    v_xor_b32 v188, 65536, v188
    v_xor_b32 v189, 65536, v189
    v_xor_b32 v190, 65536, v190
    v_xor_b32 v191, 65536, v191
    v_xor_b32 v192, 65536, v192
    v_xor_b32 v193, 65536, v193
    v_mfma_f32_16x16x32_bf16 v[32:35], v[160:163], v[124:127], v[32:35]
    ds_read_b128 v[116:119], v188 offset:0
    ds_read_b128 v[120:123], v188 offset:2048
    v_mfma_f32_16x16x32_bf16 v[88:91], v[160:163], v[128:131], v[88:91]
    ds_read_b64_tr_b16 v[132:133], v190 offset:0
    ds_read_b64_tr_b16 v[134:135], v190 offset:512
    v_mfma_f32_16x16x32_bf16 v[36:39], v[164:167], v[124:127], v[36:39]
    ds_read_b64_tr_b16 v[136:137], v191 offset:0
    v_mfma_f32_16x16x32_bf16 v[92:95], v[164:167], v[128:131], v[92:95]
    ds_read_b64_tr_b16 v[138:139], v191 offset:512
    ds_read_b64_tr_b16 v[140:141], v192 offset:0
    v_mfma_f32_16x16x32_bf16 v[40:43], v[168:171], v[124:127], v[40:43]
    ds_read_b64_tr_b16 v[142:143], v192 offset:512
    ds_read_b64_tr_b16 v[144:145], v193 offset:0
    v_mfma_f32_16x16x32_bf16 v[96:99], v[168:171], v[128:131], v[96:99]
    ds_read_b64_tr_b16 v[146:147], v193 offset:512
    v_mfma_f32_16x16x32_bf16 v[44:47], v[172:175], v[124:127], v[44:47]
    ds_read_b64_tr_b16 v[148:149], v190 offset:8192
    ds_read_b64_tr_b16 v[150:151], v190 offset:8704
    v_mfma_f32_16x16x32_bf16 v[100:103], v[172:175], v[128:131], v[100:103]
    ds_read_b64_tr_b16 v[152:153], v191 offset:8192
    v_mfma_f32_16x16x32_bf16 v[48:51], v[176:179], v[124:127], v[48:51]
    ds_read_b64_tr_b16 v[154:155], v191 offset:8704
    ds_read_b64_tr_b16 v[156:157], v192 offset:8192
    v_mfma_f32_16x16x32_bf16 v[104:107], v[176:179], v[128:131], v[104:107]
    ds_read_b64_tr_b16 v[158:159], v192 offset:8704
    s_add_u32 s54, s39, s50
    s_add_u32 m0, s54, 0
    s_add_u32 s55, s52, 0
    buffer_load_dwordx4 v194, s[8:11], s55 offen lds
    s_add_u32 s54, s39, s50
    s_add_u32 m0, s54, 1024
    s_add_u32 s55, s52, 0
    buffer_load_dwordx4 v195, s[8:11], s55 offen lds
    s_add_u32 s54, s39, s50
    s_add_u32 m0, s54, 2048
    s_add_u32 s55, s52, 32768
    buffer_load_dwordx4 v194, s[8:11], s55 offen lds
    s_add_u32 s54, s39, s50
    s_add_u32 m0, s54, 3072
    s_add_u32 s55, s52, 32768
    buffer_load_dwordx4 v195, s[8:11], s55 offen lds
    s_add_u32 s54, s39, s51
    s_add_u32 m0, s54, 0
    s_add_u32 s55, s53, 0
    buffer_load_dwordx4 v196, s[12:15], s55 offen lds
    s_add_u32 s54, s39, s51
    s_add_u32 m0, s54, 1024
    s_add_u32 s55, s53, 0
    buffer_load_dwordx4 v197, s[12:15], s55 offen lds
    s_add_u32 s54, s39, s51
    s_add_u32 m0, s54, 2048
    s_add_u32 s55, s53, 114688
    buffer_load_dwordx4 v196, s[12:15], s55 offen lds
    s_add_u32 s54, s39, s51
    s_add_u32 m0, s54, 3072
    s_add_u32 s55, s53, 114688
    buffer_load_dwordx4 v197, s[12:15], s55 offen lds
    s_add_u32 s52, s52, 128
    s_add_u32 s53, s53, 458752
    s_xor_b32 s39, s39, 65536
    v_mfma_f32_16x16x32_bf16 v[52:55], v[180:183], v[124:127], v[52:55]
    v_mfma_f32_16x16x32_bf16 v[108:111], v[180:183], v[128:131], v[108:111]
    v_mfma_f32_16x16x32_bf16 v[56:59], v[184:187], v[124:127], v[56:59]
    v_mfma_f32_16x16x32_bf16 v[112:115], v[184:187], v[128:131], v[112:115]
    s_add_u32 s35, s35, 1
    s_cmp_lt_u32 s35, 14
    s_cbranch_scc1 L_gu_kernel_loop
    s_waitcnt lgkmcnt(0)
    v_mfma_f32_16x16x32_bf16 v[4:7], v[132:135], v[116:119], v[4:7]
    ds_read_b64_tr_b16 v[160:161], v190 offset:16384
    ds_read_b64_tr_b16 v[162:163], v190 offset:16896
    v_mfma_f32_16x16x32_bf16 v[60:63], v[132:135], v[120:123], v[60:63]
    ds_read_b64_tr_b16 v[164:165], v191 offset:16384
    v_mfma_f32_16x16x32_bf16 v[8:11], v[136:139], v[116:119], v[8:11]
    ds_read_b64_tr_b16 v[166:167], v191 offset:16896
    ds_read_b64_tr_b16 v[168:169], v192 offset:16384
    v_mfma_f32_16x16x32_bf16 v[64:67], v[136:139], v[120:123], v[64:67]
    ds_read_b64_tr_b16 v[170:171], v192 offset:16896
    v_mfma_f32_16x16x32_bf16 v[12:15], v[140:143], v[116:119], v[12:15]
    ds_read_b64_tr_b16 v[172:173], v193 offset:16384
    ds_read_b64_tr_b16 v[174:175], v193 offset:16896
    v_mfma_f32_16x16x32_bf16 v[68:71], v[140:143], v[120:123], v[68:71]
    ds_read_b64_tr_b16 v[176:177], v190 offset:24576
    v_mfma_f32_16x16x32_bf16 v[16:19], v[144:147], v[116:119], v[16:19]
    ds_read_b64_tr_b16 v[178:179], v190 offset:25088
    v_mfma_f32_16x16x32_bf16 v[72:75], v[144:147], v[120:123], v[72:75]
    ds_read_b64_tr_b16 v[180:181], v191 offset:24576
    ds_read_b64_tr_b16 v[182:183], v191 offset:25088
    v_mfma_f32_16x16x32_bf16 v[20:23], v[148:151], v[116:119], v[20:23]
    ds_read_b64_tr_b16 v[184:185], v192 offset:24576
    v_mfma_f32_16x16x32_bf16 v[76:79], v[148:151], v[120:123], v[76:79]
    ds_read_b64_tr_b16 v[186:187], v192 offset:25088
    v_mfma_f32_16x16x32_bf16 v[24:27], v[152:155], v[116:119], v[24:27]
    v_mfma_f32_16x16x32_bf16 v[80:83], v[152:155], v[120:123], v[80:83]
    v_mfma_f32_16x16x32_bf16 v[28:31], v[156:159], v[116:119], v[28:31]
    v_mfma_f32_16x16x32_bf16 v[84:87], v[156:159], v[120:123], v[84:87]
    s_waitcnt lgkmcnt(0)
    v_mfma_f32_16x16x32_bf16 v[32:35], v[160:163], v[116:119], v[32:35]
    ds_read_b128 v[124:127], v189 offset:0
    ds_read_b128 v[128:131], v189 offset:2048
    v_mfma_f32_16x16x32_bf16 v[88:91], v[160:163], v[120:123], v[88:91]
    ds_read_b64_tr_b16 v[132:133], v190 offset:4096
    ds_read_b64_tr_b16 v[134:135], v190 offset:4608
    v_mfma_f32_16x16x32_bf16 v[36:39], v[164:167], v[116:119], v[36:39]
    ds_read_b64_tr_b16 v[136:137], v191 offset:4096
    v_mfma_f32_16x16x32_bf16 v[92:95], v[164:167], v[120:123], v[92:95]
    ds_read_b64_tr_b16 v[138:139], v191 offset:4608
    ds_read_b64_tr_b16 v[140:141], v192 offset:4096
    v_mfma_f32_16x16x32_bf16 v[40:43], v[168:171], v[116:119], v[40:43]
    ds_read_b64_tr_b16 v[142:143], v192 offset:4608
    ds_read_b64_tr_b16 v[144:145], v193 offset:4096
    v_mfma_f32_16x16x32_bf16 v[96:99], v[168:171], v[120:123], v[96:99]
    ds_read_b64_tr_b16 v[146:147], v193 offset:4608
    v_mfma_f32_16x16x32_bf16 v[44:47], v[172:175], v[116:119], v[44:47]
    ds_read_b64_tr_b16 v[148:149], v190 offset:12288
    ds_read_b64_tr_b16 v[150:151], v190 offset:12800
    v_mfma_f32_16x16x32_bf16 v[100:103], v[172:175], v[120:123], v[100:103]
    ds_read_b64_tr_b16 v[152:153], v191 offset:12288
    v_mfma_f32_16x16x32_bf16 v[48:51], v[176:179], v[116:119], v[48:51]
    ds_read_b64_tr_b16 v[154:155], v191 offset:12800
    ds_read_b64_tr_b16 v[156:157], v192 offset:12288
    v_mfma_f32_16x16x32_bf16 v[104:107], v[176:179], v[120:123], v[104:107]
    ds_read_b64_tr_b16 v[158:159], v192 offset:12800
    v_mfma_f32_16x16x32_bf16 v[52:55], v[180:183], v[116:119], v[52:55]
    v_mfma_f32_16x16x32_bf16 v[108:111], v[180:183], v[120:123], v[108:111]
    v_mfma_f32_16x16x32_bf16 v[56:59], v[184:187], v[116:119], v[56:59]
    v_mfma_f32_16x16x32_bf16 v[112:115], v[184:187], v[120:123], v[112:115]
    s_waitcnt lgkmcnt(0)
    v_mfma_f32_16x16x32_bf16 v[4:7], v[132:135], v[124:127], v[4:7]
    ds_read_b64_tr_b16 v[160:161], v190 offset:20480
    ds_read_b64_tr_b16 v[162:163], v190 offset:20992
    v_mfma_f32_16x16x32_bf16 v[60:63], v[132:135], v[128:131], v[60:63]
    ds_read_b64_tr_b16 v[164:165], v191 offset:20480
    v_mfma_f32_16x16x32_bf16 v[8:11], v[136:139], v[124:127], v[8:11]
    ds_read_b64_tr_b16 v[166:167], v191 offset:20992
    ds_read_b64_tr_b16 v[168:169], v192 offset:20480
    v_mfma_f32_16x16x32_bf16 v[64:67], v[136:139], v[128:131], v[64:67]
    ds_read_b64_tr_b16 v[170:171], v192 offset:20992
    v_mfma_f32_16x16x32_bf16 v[12:15], v[140:143], v[124:127], v[12:15]
    ds_read_b64_tr_b16 v[172:173], v193 offset:20480
    ds_read_b64_tr_b16 v[174:175], v193 offset:20992
    v_mfma_f32_16x16x32_bf16 v[68:71], v[140:143], v[128:131], v[68:71]
    ds_read_b64_tr_b16 v[176:177], v190 offset:28672
    v_mfma_f32_16x16x32_bf16 v[16:19], v[144:147], v[124:127], v[16:19]
    ds_read_b64_tr_b16 v[178:179], v190 offset:29184
    v_mfma_f32_16x16x32_bf16 v[72:75], v[144:147], v[128:131], v[72:75]
    ds_read_b64_tr_b16 v[180:181], v191 offset:28672
    ds_read_b64_tr_b16 v[182:183], v191 offset:29184
    v_mfma_f32_16x16x32_bf16 v[20:23], v[148:151], v[124:127], v[20:23]
    ds_read_b64_tr_b16 v[184:185], v192 offset:28672
    v_mfma_f32_16x16x32_bf16 v[76:79], v[148:151], v[128:131], v[76:79]
    ds_read_b64_tr_b16 v[186:187], v192 offset:29184
    v_mfma_f32_16x16x32_bf16 v[24:27], v[152:155], v[124:127], v[24:27]
    v_mfma_f32_16x16x32_bf16 v[80:83], v[152:155], v[128:131], v[80:83]
    v_mfma_f32_16x16x32_bf16 v[28:31], v[156:159], v[124:127], v[28:31]
    v_mfma_f32_16x16x32_bf16 v[84:87], v[156:159], v[128:131], v[84:87]
    s_waitcnt lgkmcnt(0)
    s_waitcnt vmcnt(0)
    s_barrier
    v_xor_b32 v188, 65536, v188
    v_xor_b32 v189, 65536, v189
    v_xor_b32 v190, 65536, v190
    v_xor_b32 v191, 65536, v191
    v_xor_b32 v192, 65536, v192
    v_xor_b32 v193, 65536, v193
    v_mfma_f32_16x16x32_bf16 v[32:35], v[160:163], v[124:127], v[32:35]
    ds_read_b128 v[116:119], v188 offset:0
    ds_read_b128 v[120:123], v188 offset:2048
    v_mfma_f32_16x16x32_bf16 v[88:91], v[160:163], v[128:131], v[88:91]
    ds_read_b64_tr_b16 v[132:133], v190 offset:0
    ds_read_b64_tr_b16 v[134:135], v190 offset:512
    v_mfma_f32_16x16x32_bf16 v[36:39], v[164:167], v[124:127], v[36:39]
    ds_read_b64_tr_b16 v[136:137], v191 offset:0
    v_mfma_f32_16x16x32_bf16 v[92:95], v[164:167], v[128:131], v[92:95]
    ds_read_b64_tr_b16 v[138:139], v191 offset:512
    ds_read_b64_tr_b16 v[140:141], v192 offset:0
    v_mfma_f32_16x16x32_bf16 v[40:43], v[168:171], v[124:127], v[40:43]
    ds_read_b64_tr_b16 v[142:143], v192 offset:512
    ds_read_b64_tr_b16 v[144:145], v193 offset:0
    v_mfma_f32_16x16x32_bf16 v[96:99], v[168:171], v[128:131], v[96:99]
    ds_read_b64_tr_b16 v[146:147], v193 offset:512
    v_mfma_f32_16x16x32_bf16 v[44:47], v[172:175], v[124:127], v[44:47]
    ds_read_b64_tr_b16 v[148:149], v190 offset:8192
    ds_read_b64_tr_b16 v[150:151], v190 offset:8704
    v_mfma_f32_16x16x32_bf16 v[100:103], v[172:175], v[128:131], v[100:103]
    ds_read_b64_tr_b16 v[152:153], v191 offset:8192
    v_mfma_f32_16x16x32_bf16 v[48:51], v[176:179], v[124:127], v[48:51]
    ds_read_b64_tr_b16 v[154:155], v191 offset:8704
    ds_read_b64_tr_b16 v[156:157], v192 offset:8192
    v_mfma_f32_16x16x32_bf16 v[104:107], v[176:179], v[128:131], v[104:107]
    ds_read_b64_tr_b16 v[158:159], v192 offset:8704
    v_mfma_f32_16x16x32_bf16 v[52:55], v[180:183], v[124:127], v[52:55]
    v_mfma_f32_16x16x32_bf16 v[108:111], v[180:183], v[128:131], v[108:111]
    v_mfma_f32_16x16x32_bf16 v[56:59], v[184:187], v[124:127], v[56:59]
    v_mfma_f32_16x16x32_bf16 v[112:115], v[184:187], v[128:131], v[112:115]
    s_waitcnt lgkmcnt(0)
    v_mfma_f32_16x16x32_bf16 v[4:7], v[132:135], v[116:119], v[4:7]
    ds_read_b64_tr_b16 v[160:161], v190 offset:16384
    ds_read_b64_tr_b16 v[162:163], v190 offset:16896
    v_mfma_f32_16x16x32_bf16 v[60:63], v[132:135], v[120:123], v[60:63]
    ds_read_b64_tr_b16 v[164:165], v191 offset:16384
    v_mfma_f32_16x16x32_bf16 v[8:11], v[136:139], v[116:119], v[8:11]
    ds_read_b64_tr_b16 v[166:167], v191 offset:16896
    ds_read_b64_tr_b16 v[168:169], v192 offset:16384
    v_mfma_f32_16x16x32_bf16 v[64:67], v[136:139], v[120:123], v[64:67]
    ds_read_b64_tr_b16 v[170:171], v192 offset:16896
    v_mfma_f32_16x16x32_bf16 v[12:15], v[140:143], v[116:119], v[12:15]
    ds_read_b64_tr_b16 v[172:173], v193 offset:16384
    ds_read_b64_tr_b16 v[174:175], v193 offset:16896
    v_mfma_f32_16x16x32_bf16 v[68:71], v[140:143], v[120:123], v[68:71]
    ds_read_b64_tr_b16 v[176:177], v190 offset:24576
    v_mfma_f32_16x16x32_bf16 v[16:19], v[144:147], v[116:119], v[16:19]
    ds_read_b64_tr_b16 v[178:179], v190 offset:25088
    v_mfma_f32_16x16x32_bf16 v[72:75], v[144:147], v[120:123], v[72:75]
    ds_read_b64_tr_b16 v[180:181], v191 offset:24576
    ds_read_b64_tr_b16 v[182:183], v191 offset:25088
    v_mfma_f32_16x16x32_bf16 v[20:23], v[148:151], v[116:119], v[20:23]
    ds_read_b64_tr_b16 v[184:185], v192 offset:24576
    v_mfma_f32_16x16x32_bf16 v[76:79], v[148:151], v[120:123], v[76:79]
    ds_read_b64_tr_b16 v[186:187], v192 offset:25088
    v_mfma_f32_16x16x32_bf16 v[24:27], v[152:155], v[116:119], v[24:27]
    v_mfma_f32_16x16x32_bf16 v[80:83], v[152:155], v[120:123], v[80:83]
    v_mfma_f32_16x16x32_bf16 v[28:31], v[156:159], v[116:119], v[28:31]
    v_mfma_f32_16x16x32_bf16 v[84:87], v[156:159], v[120:123], v[84:87]
    s_waitcnt lgkmcnt(0)
    v_mfma_f32_16x16x32_bf16 v[32:35], v[160:163], v[116:119], v[32:35]
    ds_read_b128 v[124:127], v189 offset:0
    ds_read_b128 v[128:131], v189 offset:2048
    v_mfma_f32_16x16x32_bf16 v[88:91], v[160:163], v[120:123], v[88:91]
    ds_read_b64_tr_b16 v[132:133], v190 offset:4096
    ds_read_b64_tr_b16 v[134:135], v190 offset:4608
    v_mfma_f32_16x16x32_bf16 v[36:39], v[164:167], v[116:119], v[36:39]
    ds_read_b64_tr_b16 v[136:137], v191 offset:4096
    v_mfma_f32_16x16x32_bf16 v[92:95], v[164:167], v[120:123], v[92:95]
    ds_read_b64_tr_b16 v[138:139], v191 offset:4608
    ds_read_b64_tr_b16 v[140:141], v192 offset:4096
    v_mfma_f32_16x16x32_bf16 v[40:43], v[168:171], v[116:119], v[40:43]
    ds_read_b64_tr_b16 v[142:143], v192 offset:4608
    ds_read_b64_tr_b16 v[144:145], v193 offset:4096
    v_mfma_f32_16x16x32_bf16 v[96:99], v[168:171], v[120:123], v[96:99]
    ds_read_b64_tr_b16 v[146:147], v193 offset:4608
    v_mfma_f32_16x16x32_bf16 v[44:47], v[172:175], v[116:119], v[44:47]
    ds_read_b64_tr_b16 v[148:149], v190 offset:12288
    ds_read_b64_tr_b16 v[150:151], v190 offset:12800
    v_mfma_f32_16x16x32_bf16 v[100:103], v[172:175], v[120:123], v[100:103]
    ds_read_b64_tr_b16 v[152:153], v191 offset:12288
    v_mfma_f32_16x16x32_bf16 v[48:51], v[176:179], v[116:119], v[48:51]
    ds_read_b64_tr_b16 v[154:155], v191 offset:12800
    ds_read_b64_tr_b16 v[156:157], v192 offset:12288
    v_mfma_f32_16x16x32_bf16 v[104:107], v[176:179], v[120:123], v[104:107]
    ds_read_b64_tr_b16 v[158:159], v192 offset:12800
    v_mfma_f32_16x16x32_bf16 v[52:55], v[180:183], v[116:119], v[52:55]
    v_mfma_f32_16x16x32_bf16 v[108:111], v[180:183], v[120:123], v[108:111]
    v_mfma_f32_16x16x32_bf16 v[56:59], v[184:187], v[116:119], v[56:59]
    v_mfma_f32_16x16x32_bf16 v[112:115], v[184:187], v[120:123], v[112:115]
    s_waitcnt lgkmcnt(0)
    v_mfma_f32_16x16x32_bf16 v[4:7], v[132:135], v[124:127], v[4:7]
    ds_read_b64_tr_b16 v[160:161], v190 offset:20480
    ds_read_b64_tr_b16 v[162:163], v190 offset:20992
    v_mfma_f32_16x16x32_bf16 v[60:63], v[132:135], v[128:131], v[60:63]
    ds_read_b64_tr_b16 v[164:165], v191 offset:20480
    v_mfma_f32_16x16x32_bf16 v[8:11], v[136:139], v[124:127], v[8:11]
    ds_read_b64_tr_b16 v[166:167], v191 offset:20992
    ds_read_b64_tr_b16 v[168:169], v192 offset:20480
    v_mfma_f32_16x16x32_bf16 v[64:67], v[136:139], v[128:131], v[64:67]
    ds_read_b64_tr_b16 v[170:171], v192 offset:20992
    v_mfma_f32_16x16x32_bf16 v[12:15], v[140:143], v[124:127], v[12:15]
    ds_read_b64_tr_b16 v[172:173], v193 offset:20480
    ds_read_b64_tr_b16 v[174:175], v193 offset:20992
    v_mfma_f32_16x16x32_bf16 v[68:71], v[140:143], v[128:131], v[68:71]
    ds_read_b64_tr_b16 v[176:177], v190 offset:28672
    v_mfma_f32_16x16x32_bf16 v[16:19], v[144:147], v[124:127], v[16:19]
    ds_read_b64_tr_b16 v[178:179], v190 offset:29184
    v_mfma_f32_16x16x32_bf16 v[72:75], v[144:147], v[128:131], v[72:75]
    ds_read_b64_tr_b16 v[180:181], v191 offset:28672
    ds_read_b64_tr_b16 v[182:183], v191 offset:29184
    v_mfma_f32_16x16x32_bf16 v[20:23], v[148:151], v[124:127], v[20:23]
    ds_read_b64_tr_b16 v[184:185], v192 offset:28672
    v_mfma_f32_16x16x32_bf16 v[76:79], v[148:151], v[128:131], v[76:79]
    ds_read_b64_tr_b16 v[186:187], v192 offset:29184
    v_mfma_f32_16x16x32_bf16 v[24:27], v[152:155], v[124:127], v[24:27]
    v_mfma_f32_16x16x32_bf16 v[80:83], v[152:155], v[128:131], v[80:83]
    v_mfma_f32_16x16x32_bf16 v[28:31], v[156:159], v[124:127], v[28:31]
    v_mfma_f32_16x16x32_bf16 v[84:87], v[156:159], v[128:131], v[84:87]
    s_waitcnt lgkmcnt(0)
    v_mfma_f32_16x16x32_bf16 v[32:35], v[160:163], v[124:127], v[32:35]
    v_mfma_f32_16x16x32_bf16 v[88:91], v[160:163], v[128:131], v[88:91]
    v_mfma_f32_16x16x32_bf16 v[36:39], v[164:167], v[124:127], v[36:39]
    v_mfma_f32_16x16x32_bf16 v[92:95], v[164:167], v[128:131], v[92:95]
    v_mfma_f32_16x16x32_bf16 v[40:43], v[168:171], v[124:127], v[40:43]
    v_mfma_f32_16x16x32_bf16 v[96:99], v[168:171], v[128:131], v[96:99]
    v_mfma_f32_16x16x32_bf16 v[44:47], v[172:175], v[124:127], v[44:47]
    v_mfma_f32_16x16x32_bf16 v[100:103], v[172:175], v[128:131], v[100:103]
    v_mfma_f32_16x16x32_bf16 v[48:51], v[176:179], v[124:127], v[48:51]
    v_mfma_f32_16x16x32_bf16 v[104:107], v[176:179], v[128:131], v[104:107]
    v_mfma_f32_16x16x32_bf16 v[52:55], v[180:183], v[124:127], v[52:55]
    v_mfma_f32_16x16x32_bf16 v[108:111], v[180:183], v[128:131], v[108:111]
    v_mfma_f32_16x16x32_bf16 v[56:59], v[184:187], v[124:127], v[56:59]
    v_mfma_f32_16x16x32_bf16 v[112:115], v[184:187], v[128:131], v[112:115]
    v_and_b32 v198, 15, v0
    v_lshrrev_b32 v199, 4, v0
    v_mul_u32_u24 v198, 240, v198
    v_lshl_add_u32 v198, v199, 3, v198
    s_mul_i32 s38, s34, 7680
    v_add_u32 v198, s38, v198
    v_mov_b32 v199, 0x3fb8aa3b
    v_cvt_pk_bf16_f32 v4, 0, v4
    v_cvt_pk_bf16_f32 v5, 0, v5
    v_cvt_pk_bf16_f32 v6, 0, v6
    v_cvt_pk_bf16_f32 v7, 0, v7
    v_mul_f32 v200, v199, v4
    v_mul_f32 v201, v199, v5
    v_mul_f32 v202, v199, v6
    v_mul_f32 v203, v199, v7
    v_exp_f32 v200, -v200
    v_exp_f32 v201, -v201
    v_exp_f32 v202, -v202
    v_exp_f32 v203, -v203
    v_cvt_pk_bf16_f32 v32, 0, v32
    v_cvt_pk_bf16_f32 v33, 0, v33
    v_cvt_pk_bf16_f32 v34, 0, v34
    v_cvt_pk_bf16_f32 v35, 0, v35
    v_add_f32 v200, 1.0, v200
    v_add_f32 v201, 1.0, v201
    v_add_f32 v202, 1.0, v202
    v_add_f32 v203, 1.0, v203
    v_rcp_f32 v200, v200
    v_rcp_f32 v201, v201
    v_rcp_f32 v202, v202
    v_rcp_f32 v203, v203
    v_mul_f32 v4, v4, v200
    v_mul_f32 v5, v5, v201
    v_mul_f32 v6, v6, v202
    v_mul_f32 v7, v7, v203
    v_cvt_pk_bf16_f32 v4, 0, v4
    v_cvt_pk_bf16_f32 v5, 0, v5
    v_cvt_pk_bf16_f32 v6, 0, v6
    v_cvt_pk_bf16_f32 v7, 0, v7
    v_mul_f32 v4, v4, v32
    v_mul_f32 v5, v5, v33
    v_mul_f32 v6, v6, v34
    v_mul_f32 v7, v7, v35
    v_cvt_pk_bf16_f32 v4, v4, v5
    v_cvt_pk_bf16_f32 v5, v6, v7
    ds_write_b64 v198, v[4:5] offset:0
    v_cvt_pk_bf16_f32 v8, 0, v8
    v_cvt_pk_bf16_f32 v9, 0, v9
    v_cvt_pk_bf16_f32 v10, 0, v10
    v_cvt_pk_bf16_f32 v11, 0, v11
    v_mul_f32 v200, v199, v8
    v_mul_f32 v201, v199, v9
    v_mul_f32 v202, v199, v10
    v_mul_f32 v203, v199, v11
    v_exp_f32 v200, -v200
    v_exp_f32 v201, -v201
    v_exp_f32 v202, -v202
    v_exp_f32 v203, -v203
    v_cvt_pk_bf16_f32 v36, 0, v36
    v_cvt_pk_bf16_f32 v37, 0, v37
    v_cvt_pk_bf16_f32 v38, 0, v38
    v_cvt_pk_bf16_f32 v39, 0, v39
    v_add_f32 v200, 1.0, v200
    v_add_f32 v201, 1.0, v201
    v_add_f32 v202, 1.0, v202
    v_add_f32 v203, 1.0, v203
    v_rcp_f32 v200, v200
    v_rcp_f32 v201, v201
    v_rcp_f32 v202, v202
    v_rcp_f32 v203, v203
    v_mul_f32 v8, v8, v200
    v_mul_f32 v9, v9, v201
    v_mul_f32 v10, v10, v202
    v_mul_f32 v11, v11, v203
    v_cvt_pk_bf16_f32 v8, 0, v8
    v_cvt_pk_bf16_f32 v9, 0, v9
    v_cvt_pk_bf16_f32 v10, 0, v10
    v_cvt_pk_bf16_f32 v11, 0, v11
    v_mul_f32 v8, v8, v36
    v_mul_f32 v9, v9, v37
    v_mul_f32 v10, v10, v38
    v_mul_f32 v11, v11, v39
    v_cvt_pk_bf16_f32 v8, v8, v9
    v_cvt_pk_bf16_f32 v9, v10, v11
    ds_write_b64 v198, v[8:9] offset:32
    v_cvt_pk_bf16_f32 v12, 0, v12
    v_cvt_pk_bf16_f32 v13, 0, v13
    v_cvt_pk_bf16_f32 v14, 0, v14
    v_cvt_pk_bf16_f32 v15, 0, v15
    v_mul_f32 v200, v199, v12
    v_mul_f32 v201, v199, v13
    v_mul_f32 v202, v199, v14
    v_mul_f32 v203, v199, v15
    v_exp_f32 v200, -v200
    v_exp_f32 v201, -v201
    v_exp_f32 v202, -v202
    v_exp_f32 v203, -v203
    v_cvt_pk_bf16_f32 v40, 0, v40
    v_cvt_pk_bf16_f32 v41, 0, v41
    v_cvt_pk_bf16_f32 v42, 0, v42
    v_cvt_pk_bf16_f32 v43, 0, v43
    v_add_f32 v200, 1.0, v200
    v_add_f32 v201, 1.0, v201
    v_add_f32 v202, 1.0, v202
    v_add_f32 v203, 1.0, v203
    v_rcp_f32 v200, v200
    v_rcp_f32 v201, v201
    v_rcp_f32 v202, v202
    v_rcp_f32 v203, v203
    v_mul_f32 v12, v12, v200
    v_mul_f32 v13, v13, v201
    v_mul_f32 v14, v14, v202
    v_mul_f32 v15, v15, v203
    v_cvt_pk_bf16_f32 v12, 0, v12
    v_cvt_pk_bf16_f32 v13, 0, v13
    v_cvt_pk_bf16_f32 v14, 0, v14
    v_cvt_pk_bf16_f32 v15, 0, v15
    v_mul_f32 v12, v12, v40
    v_mul_f32 v13, v13, v41
    v_mul_f32 v14, v14, v42
    v_mul_f32 v15, v15, v43
    v_cvt_pk_bf16_f32 v12, v12, v13
    v_cvt_pk_bf16_f32 v13, v14, v15
    ds_write_b64 v198, v[12:13] offset:64
    v_cvt_pk_bf16_f32 v16, 0, v16
    v_cvt_pk_bf16_f32 v17, 0, v17
    v_cvt_pk_bf16_f32 v18, 0, v18
    v_cvt_pk_bf16_f32 v19, 0, v19
    v_mul_f32 v200, v199, v16
    v_mul_f32 v201, v199, v17
    v_mul_f32 v202, v199, v18
    v_mul_f32 v203, v199, v19
    v_exp_f32 v200, -v200
    v_exp_f32 v201, -v201
    v_exp_f32 v202, -v202
    v_exp_f32 v203, -v203
    v_cvt_pk_bf16_f32 v44, 0, v44
    v_cvt_pk_bf16_f32 v45, 0, v45
    v_cvt_pk_bf16_f32 v46, 0, v46
    v_cvt_pk_bf16_f32 v47, 0, v47
    v_add_f32 v200, 1.0, v200
    v_add_f32 v201, 1.0, v201
    v_add_f32 v202, 1.0, v202
    v_add_f32 v203, 1.0, v203
    v_rcp_f32 v200, v200
    v_rcp_f32 v201, v201
    v_rcp_f32 v202, v202
    v_rcp_f32 v203, v203
    v_mul_f32 v16, v16, v200
    v_mul_f32 v17, v17, v201
    v_mul_f32 v18, v18, v202
    v_mul_f32 v19, v19, v203
    v_cvt_pk_bf16_f32 v16, 0, v16
    v_cvt_pk_bf16_f32 v17, 0, v17
    v_cvt_pk_bf16_f32 v18, 0, v18
    v_cvt_pk_bf16_f32 v19, 0, v19
    v_mul_f32 v16, v16, v44
    v_mul_f32 v17, v17, v45
    v_mul_f32 v18, v18, v46
    v_mul_f32 v19, v19, v47
    v_cvt_pk_bf16_f32 v16, v16, v17
    v_cvt_pk_bf16_f32 v17, v18, v19
    ds_write_b64 v198, v[16:17] offset:96
    v_cvt_pk_bf16_f32 v20, 0, v20
    v_cvt_pk_bf16_f32 v21, 0, v21
    v_cvt_pk_bf16_f32 v22, 0, v22
    v_cvt_pk_bf16_f32 v23, 0, v23
    v_mul_f32 v200, v199, v20
    v_mul_f32 v201, v199, v21
    v_mul_f32 v202, v199, v22
    v_mul_f32 v203, v199, v23
    v_exp_f32 v200, -v200
    v_exp_f32 v201, -v201
    v_exp_f32 v202, -v202
    v_exp_f32 v203, -v203
    v_cvt_pk_bf16_f32 v48, 0, v48
    v_cvt_pk_bf16_f32 v49, 0, v49
    v_cvt_pk_bf16_f32 v50, 0, v50
    v_cvt_pk_bf16_f32 v51, 0, v51
    v_add_f32 v200, 1.0, v200
    v_add_f32 v201, 1.0, v201
    v_add_f32 v202, 1.0, v202
    v_add_f32 v203, 1.0, v203
    v_rcp_f32 v200, v200
    v_rcp_f32 v201, v201
    v_rcp_f32 v202, v202
    v_rcp_f32 v203, v203
    v_mul_f32 v20, v20, v200
    v_mul_f32 v21, v21, v201
    v_mul_f32 v22, v22, v202
    v_mul_f32 v23, v23, v203
    v_cvt_pk_bf16_f32 v20, 0, v20
    v_cvt_pk_bf16_f32 v21, 0, v21
    v_cvt_pk_bf16_f32 v22, 0, v22
    v_cvt_pk_bf16_f32 v23, 0, v23
    v_mul_f32 v20, v20, v48
    v_mul_f32 v21, v21, v49
    v_mul_f32 v22, v22, v50
    v_mul_f32 v23, v23, v51
    v_cvt_pk_bf16_f32 v20, v20, v21
    v_cvt_pk_bf16_f32 v21, v22, v23
    ds_write_b64 v198, v[20:21] offset:128
    v_cvt_pk_bf16_f32 v24, 0, v24
    v_cvt_pk_bf16_f32 v25, 0, v25
    v_cvt_pk_bf16_f32 v26, 0, v26
    v_cvt_pk_bf16_f32 v27, 0, v27
    v_mul_f32 v200, v199, v24
    v_mul_f32 v201, v199, v25
    v_mul_f32 v202, v199, v26
    v_mul_f32 v203, v199, v27
    v_exp_f32 v200, -v200
    v_exp_f32 v201, -v201
    v_exp_f32 v202, -v202
    v_exp_f32 v203, -v203
    v_cvt_pk_bf16_f32 v52, 0, v52
    v_cvt_pk_bf16_f32 v53, 0, v53
    v_cvt_pk_bf16_f32 v54, 0, v54
    v_cvt_pk_bf16_f32 v55, 0, v55
    v_add_f32 v200, 1.0, v200
    v_add_f32 v201, 1.0, v201
    v_add_f32 v202, 1.0, v202
    v_add_f32 v203, 1.0, v203
    v_rcp_f32 v200, v200
    v_rcp_f32 v201, v201
    v_rcp_f32 v202, v202
    v_rcp_f32 v203, v203
    v_mul_f32 v24, v24, v200
    v_mul_f32 v25, v25, v201
    v_mul_f32 v26, v26, v202
    v_mul_f32 v27, v27, v203
    v_cvt_pk_bf16_f32 v24, 0, v24
    v_cvt_pk_bf16_f32 v25, 0, v25
    v_cvt_pk_bf16_f32 v26, 0, v26
    v_cvt_pk_bf16_f32 v27, 0, v27
    v_mul_f32 v24, v24, v52
    v_mul_f32 v25, v25, v53
    v_mul_f32 v26, v26, v54
    v_mul_f32 v27, v27, v55
    v_cvt_pk_bf16_f32 v24, v24, v25
    v_cvt_pk_bf16_f32 v25, v26, v27
    ds_write_b64 v198, v[24:25] offset:160
    v_cvt_pk_bf16_f32 v28, 0, v28
    v_cvt_pk_bf16_f32 v29, 0, v29
    v_cvt_pk_bf16_f32 v30, 0, v30
    v_cvt_pk_bf16_f32 v31, 0, v31
    v_mul_f32 v200, v199, v28
    v_mul_f32 v201, v199, v29
    v_mul_f32 v202, v199, v30
    v_mul_f32 v203, v199, v31
    v_exp_f32 v200, -v200
    v_exp_f32 v201, -v201
    v_exp_f32 v202, -v202
    v_exp_f32 v203, -v203
    v_cvt_pk_bf16_f32 v56, 0, v56
    v_cvt_pk_bf16_f32 v57, 0, v57
    v_cvt_pk_bf16_f32 v58, 0, v58
    v_cvt_pk_bf16_f32 v59, 0, v59
    v_add_f32 v200, 1.0, v200
    v_add_f32 v201, 1.0, v201
    v_add_f32 v202, 1.0, v202
    v_add_f32 v203, 1.0, v203
    v_rcp_f32 v200, v200
    v_rcp_f32 v201, v201
    v_rcp_f32 v202, v202
    v_rcp_f32 v203, v203
    v_mul_f32 v28, v28, v200
    v_mul_f32 v29, v29, v201
    v_mul_f32 v30, v30, v202
    v_mul_f32 v31, v31, v203
    v_cvt_pk_bf16_f32 v28, 0, v28
    v_cvt_pk_bf16_f32 v29, 0, v29
    v_cvt_pk_bf16_f32 v30, 0, v30
    v_cvt_pk_bf16_f32 v31, 0, v31
    v_mul_f32 v28, v28, v56
    v_mul_f32 v29, v29, v57
    v_mul_f32 v30, v30, v58
    v_mul_f32 v31, v31, v59
    v_cvt_pk_bf16_f32 v28, v28, v29
    v_cvt_pk_bf16_f32 v29, v30, v31
    ds_write_b64 v198, v[28:29] offset:192
    v_cvt_pk_bf16_f32 v60, 0, v60
    v_cvt_pk_bf16_f32 v61, 0, v61
    v_cvt_pk_bf16_f32 v62, 0, v62
    v_cvt_pk_bf16_f32 v63, 0, v63
    v_mul_f32 v200, v199, v60
    v_mul_f32 v201, v199, v61
    v_mul_f32 v202, v199, v62
    v_mul_f32 v203, v199, v63
    v_exp_f32 v200, -v200
    v_exp_f32 v201, -v201
    v_exp_f32 v202, -v202
    v_exp_f32 v203, -v203
    v_cvt_pk_bf16_f32 v88, 0, v88
    v_cvt_pk_bf16_f32 v89, 0, v89
    v_cvt_pk_bf16_f32 v90, 0, v90
    v_cvt_pk_bf16_f32 v91, 0, v91
    v_add_f32 v200, 1.0, v200
    v_add_f32 v201, 1.0, v201
    v_add_f32 v202, 1.0, v202
    v_add_f32 v203, 1.0, v203
    v_rcp_f32 v200, v200
    v_rcp_f32 v201, v201
    v_rcp_f32 v202, v202
    v_rcp_f32 v203, v203
    v_mul_f32 v60, v60, v200
    v_mul_f32 v61, v61, v201
    v_mul_f32 v62, v62, v202
    v_mul_f32 v63, v63, v203
    v_cvt_pk_bf16_f32 v60, 0, v60
    v_cvt_pk_bf16_f32 v61, 0, v61
    v_cvt_pk_bf16_f32 v62, 0, v62
    v_cvt_pk_bf16_f32 v63, 0, v63
    v_mul_f32 v60, v60, v88
    v_mul_f32 v61, v61, v89
    v_mul_f32 v62, v62, v90
    v_mul_f32 v63, v63, v91
    v_cvt_pk_bf16_f32 v60, v60, v61
    v_cvt_pk_bf16_f32 v61, v62, v63
    ds_write_b64 v198, v[60:61] offset:3840
    v_cvt_pk_bf16_f32 v64, 0, v64
    v_cvt_pk_bf16_f32 v65, 0, v65
    v_cvt_pk_bf16_f32 v66, 0, v66
    v_cvt_pk_bf16_f32 v67, 0, v67
    v_mul_f32 v200, v199, v64
    v_mul_f32 v201, v199, v65
    v_mul_f32 v202, v199, v66
    v_mul_f32 v203, v199, v67
    v_exp_f32 v200, -v200
    v_exp_f32 v201, -v201
    v_exp_f32 v202, -v202
    v_exp_f32 v203, -v203
    v_cvt_pk_bf16_f32 v92, 0, v92
    v_cvt_pk_bf16_f32 v93, 0, v93
    v_cvt_pk_bf16_f32 v94, 0, v94
    v_cvt_pk_bf16_f32 v95, 0, v95
    v_add_f32 v200, 1.0, v200
    v_add_f32 v201, 1.0, v201
    v_add_f32 v202, 1.0, v202
    v_add_f32 v203, 1.0, v203
    v_rcp_f32 v200, v200
    v_rcp_f32 v201, v201
    v_rcp_f32 v202, v202
    v_rcp_f32 v203, v203
    v_mul_f32 v64, v64, v200
    v_mul_f32 v65, v65, v201
    v_mul_f32 v66, v66, v202
    v_mul_f32 v67, v67, v203
    v_cvt_pk_bf16_f32 v64, 0, v64
    v_cvt_pk_bf16_f32 v65, 0, v65
    v_cvt_pk_bf16_f32 v66, 0, v66
    v_cvt_pk_bf16_f32 v67, 0, v67
    v_mul_f32 v64, v64, v92
    v_mul_f32 v65, v65, v93
    v_mul_f32 v66, v66, v94
    v_mul_f32 v67, v67, v95
    v_cvt_pk_bf16_f32 v64, v64, v65
    v_cvt_pk_bf16_f32 v65, v66, v67
    ds_write_b64 v198, v[64:65] offset:3872
    v_cvt_pk_bf16_f32 v68, 0, v68
    v_cvt_pk_bf16_f32 v69, 0, v69
    v_cvt_pk_bf16_f32 v70, 0, v70
    v_cvt_pk_bf16_f32 v71, 0, v71
    v_mul_f32 v200, v199, v68
    v_mul_f32 v201, v199, v69
    v_mul_f32 v202, v199, v70
    v_mul_f32 v203, v199, v71
    v_exp_f32 v200, -v200
    v_exp_f32 v201, -v201
    v_exp_f32 v202, -v202
    v_exp_f32 v203, -v203
    v_cvt_pk_bf16_f32 v96, 0, v96
    v_cvt_pk_bf16_f32 v97, 0, v97
    v_cvt_pk_bf16_f32 v98, 0, v98
    v_cvt_pk_bf16_f32 v99, 0, v99
    v_add_f32 v200, 1.0, v200
    v_add_f32 v201, 1.0, v201
    v_add_f32 v202, 1.0, v202
    v_add_f32 v203, 1.0, v203
    v_rcp_f32 v200, v200
    v_rcp_f32 v201, v201
    v_rcp_f32 v202, v202
    v_rcp_f32 v203, v203
    v_mul_f32 v68, v68, v200
    v_mul_f32 v69, v69, v201
    v_mul_f32 v70, v70, v202
    v_mul_f32 v71, v71, v203
    v_cvt_pk_bf16_f32 v68, 0, v68
    v_cvt_pk_bf16_f32 v69, 0, v69
    v_cvt_pk_bf16_f32 v70, 0, v70
    v_cvt_pk_bf16_f32 v71, 0, v71
    v_mul_f32 v68, v68, v96
    v_mul_f32 v69, v69, v97
    v_mul_f32 v70, v70, v98
    v_mul_f32 v71, v71, v99
    v_cvt_pk_bf16_f32 v68, v68, v69
    v_cvt_pk_bf16_f32 v69, v70, v71
    ds_write_b64 v198, v[68:69] offset:3904
    v_cvt_pk_bf16_f32 v72, 0, v72
    v_cvt_pk_bf16_f32 v73, 0, v73
    v_cvt_pk_bf16_f32 v74, 0, v74
    v_cvt_pk_bf16_f32 v75, 0, v75
    v_mul_f32 v200, v199, v72
    v_mul_f32 v201, v199, v73
    v_mul_f32 v202, v199, v74
    v_mul_f32 v203, v199, v75
    v_exp_f32 v200, -v200
    v_exp_f32 v201, -v201
    v_exp_f32 v202, -v202
    v_exp_f32 v203, -v203
    v_cvt_pk_bf16_f32 v100, 0, v100
    v_cvt_pk_bf16_f32 v101, 0, v101
    v_cvt_pk_bf16_f32 v102, 0, v102
    v_cvt_pk_bf16_f32 v103, 0, v103
    v_add_f32 v200, 1.0, v200
    v_add_f32 v201, 1.0, v201
    v_add_f32 v202, 1.0, v202
    v_add_f32 v203, 1.0, v203
    v_rcp_f32 v200, v200
    v_rcp_f32 v201, v201
    v_rcp_f32 v202, v202
    v_rcp_f32 v203, v203
    v_mul_f32 v72, v72, v200
    v_mul_f32 v73, v73, v201
    v_mul_f32 v74, v74, v202
    v_mul_f32 v75, v75, v203
    v_cvt_pk_bf16_f32 v72, 0, v72
    v_cvt_pk_bf16_f32 v73, 0, v73
    v_cvt_pk_bf16_f32 v74, 0, v74
    v_cvt_pk_bf16_f32 v75, 0, v75
    v_mul_f32 v72, v72, v100
    v_mul_f32 v73, v73, v101
    v_mul_f32 v74, v74, v102
    v_mul_f32 v75, v75, v103
    v_cvt_pk_bf16_f32 v72, v72, v73
    v_cvt_pk_bf16_f32 v73, v74, v75
    ds_write_b64 v198, v[72:73] offset:3936
    v_cvt_pk_bf16_f32 v76, 0, v76
    v_cvt_pk_bf16_f32 v77, 0, v77
    v_cvt_pk_bf16_f32 v78, 0, v78
    v_cvt_pk_bf16_f32 v79, 0, v79
    v_mul_f32 v200, v199, v76
    v_mul_f32 v201, v199, v77
    v_mul_f32 v202, v199, v78
    v_mul_f32 v203, v199, v79
    v_exp_f32 v200, -v200
    v_exp_f32 v201, -v201
    v_exp_f32 v202, -v202
    v_exp_f32 v203, -v203
    v_cvt_pk_bf16_f32 v104, 0, v104
    v_cvt_pk_bf16_f32 v105, 0, v105
    v_cvt_pk_bf16_f32 v106, 0, v106
    v_cvt_pk_bf16_f32 v107, 0, v107
    v_add_f32 v200, 1.0, v200
    v_add_f32 v201, 1.0, v201
    v_add_f32 v202, 1.0, v202
    v_add_f32 v203, 1.0, v203
    v_rcp_f32 v200, v200
    v_rcp_f32 v201, v201
    v_rcp_f32 v202, v202
    v_rcp_f32 v203, v203
    v_mul_f32 v76, v76, v200
    v_mul_f32 v77, v77, v201
    v_mul_f32 v78, v78, v202
    v_mul_f32 v79, v79, v203
    v_cvt_pk_bf16_f32 v76, 0, v76
    v_cvt_pk_bf16_f32 v77, 0, v77
    v_cvt_pk_bf16_f32 v78, 0, v78
    v_cvt_pk_bf16_f32 v79, 0, v79
    v_mul_f32 v76, v76, v104
    v_mul_f32 v77, v77, v105
    v_mul_f32 v78, v78, v106
    v_mul_f32 v79, v79, v107
    v_cvt_pk_bf16_f32 v76, v76, v77
    v_cvt_pk_bf16_f32 v77, v78, v79
    ds_write_b64 v198, v[76:77] offset:3968
    v_cvt_pk_bf16_f32 v80, 0, v80
    v_cvt_pk_bf16_f32 v81, 0, v81
    v_cvt_pk_bf16_f32 v82, 0, v82
    v_cvt_pk_bf16_f32 v83, 0, v83
    v_mul_f32 v200, v199, v80
    v_mul_f32 v201, v199, v81
    v_mul_f32 v202, v199, v82
    v_mul_f32 v203, v199, v83
    v_exp_f32 v200, -v200
    v_exp_f32 v201, -v201
    v_exp_f32 v202, -v202
    v_exp_f32 v203, -v203
    v_cvt_pk_bf16_f32 v108, 0, v108
    v_cvt_pk_bf16_f32 v109, 0, v109
    v_cvt_pk_bf16_f32 v110, 0, v110
    v_cvt_pk_bf16_f32 v111, 0, v111
    v_add_f32 v200, 1.0, v200
    v_add_f32 v201, 1.0, v201
    v_add_f32 v202, 1.0, v202
    v_add_f32 v203, 1.0, v203
    v_rcp_f32 v200, v200
    v_rcp_f32 v201, v201
    v_rcp_f32 v202, v202
    v_rcp_f32 v203, v203
    v_mul_f32 v80, v80, v200
    v_mul_f32 v81, v81, v201
    v_mul_f32 v82, v82, v202
    v_mul_f32 v83, v83, v203
    v_cvt_pk_bf16_f32 v80, 0, v80
    v_cvt_pk_bf16_f32 v81, 0, v81
    v_cvt_pk_bf16_f32 v82, 0, v82
    v_cvt_pk_bf16_f32 v83, 0, v83
    v_mul_f32 v80, v80, v108
    v_mul_f32 v81, v81, v109
    v_mul_f32 v82, v82, v110
    v_mul_f32 v83, v83, v111
    v_cvt_pk_bf16_f32 v80, v80, v81
    v_cvt_pk_bf16_f32 v81, v82, v83
    ds_write_b64 v198, v[80:81] offset:4000
    v_cvt_pk_bf16_f32 v84, 0, v84
    v_cvt_pk_bf16_f32 v85, 0, v85
    v_cvt_pk_bf16_f32 v86, 0, v86
    v_cvt_pk_bf16_f32 v87, 0, v87
    v_mul_f32 v200, v199, v84
    v_mul_f32 v201, v199, v85
    v_mul_f32 v202, v199, v86
    v_mul_f32 v203, v199, v87
    v_exp_f32 v200, -v200
    v_exp_f32 v201, -v201
    v_exp_f32 v202, -v202
    v_exp_f32 v203, -v203
    v_cvt_pk_bf16_f32 v112, 0, v112
    v_cvt_pk_bf16_f32 v113, 0, v113
    v_cvt_pk_bf16_f32 v114, 0, v114
    v_cvt_pk_bf16_f32 v115, 0, v115
    v_add_f32 v200, 1.0, v200
    v_add_f32 v201, 1.0, v201
    v_add_f32 v202, 1.0, v202
    v_add_f32 v203, 1.0, v203
    v_rcp_f32 v200, v200
    v_rcp_f32 v201, v201
    v_rcp_f32 v202, v202
    v_rcp_f32 v203, v203
    v_mul_f32 v84, v84, v200
    v_mul_f32 v85, v85, v201
    v_mul_f32 v86, v86, v202
    v_mul_f32 v87, v87, v203
    v_cvt_pk_bf16_f32 v84, 0, v84
    v_cvt_pk_bf16_f32 v85, 0, v85
    v_cvt_pk_bf16_f32 v86, 0, v86
    v_cvt_pk_bf16_f32 v87, 0, v87
    v_mul_f32 v84, v84, v112
    v_mul_f32 v85, v85, v113
    v_mul_f32 v86, v86, v114
    v_mul_f32 v87, v87, v115
    v_cvt_pk_bf16_f32 v84, v84, v85
    v_cvt_pk_bf16_f32 v85, v86, v87
    ds_write_b64 v198, v[84:85] offset:4032
    s_waitcnt lgkmcnt(0)
    s_lshl_b32 s37, s34, 5
    s_add_u32 s37, s37, s32
    s_mul_i32 s39, s33, 224
    s_mov_b32 s46, 4682
    s_mov_b32 s48, 7168
    v_add_u32 v200, 0, v0
    v_mul_u32_u24 v201, s46, v200
    v_lshrrev_b32 v201, 16, v201
    v_mul_u32_u24 v202, 14, v201
    v_sub_u32 v202, v200, v202
    v_mul_u32_u24 v203, 240, v201
    v_lshl_add_u32 v203, v202, 4, v203
    v_add_u32 v203, s38, v203
    ds_read_b128 v[4:7], v203
    v_add_u32 v201, s37, v201
    v_mul_lo_u32 v201, v201, s48
    v_lshl_add_u32 v202, v202, 4, s39
    v_add_u32 v8, v201, v202
    v_add_u32 v200, 64, v0
    v_mul_u32_u24 v201, s46, v200
    v_lshrrev_b32 v201, 16, v201
    v_mul_u32_u24 v202, 14, v201
    v_sub_u32 v202, v200, v202
    v_mul_u32_u24 v203, 240, v201
    v_lshl_add_u32 v203, v202, 4, v203
    v_add_u32 v203, s38, v203
    ds_read_b128 v[12:15], v203
    v_add_u32 v201, s37, v201
    v_mul_lo_u32 v201, v201, s48
    v_lshl_add_u32 v202, v202, 4, s39
    v_add_u32 v16, v201, v202
    v_add_u32 v200, 128, v0
    v_mul_u32_u24 v201, s46, v200
    v_lshrrev_b32 v201, 16, v201
    v_mul_u32_u24 v202, 14, v201
    v_sub_u32 v202, v200, v202
    v_mul_u32_u24 v203, 240, v201
    v_lshl_add_u32 v203, v202, 4, v203
    v_add_u32 v203, s38, v203
    ds_read_b128 v[20:23], v203
    v_add_u32 v201, s37, v201
    v_mul_lo_u32 v201, v201, s48
    v_lshl_add_u32 v202, v202, 4, s39
    v_add_u32 v24, v201, v202
    v_add_u32 v200, 192, v0
    v_mul_u32_u24 v201, s46, v200
    v_lshrrev_b32 v201, 16, v201
    v_mul_u32_u24 v202, 14, v201
    v_sub_u32 v202, v200, v202
    v_mul_u32_u24 v203, 240, v201
    v_lshl_add_u32 v203, v202, 4, v203
    v_add_u32 v203, s38, v203
    ds_read_b128 v[28:31], v203
    v_add_u32 v201, s37, v201
    v_mul_lo_u32 v201, v201, s48
    v_lshl_add_u32 v202, v202, 4, s39
    v_add_u32 v32, v201, v202
    v_add_u32 v200, 256, v0
    v_mul_u32_u24 v201, s46, v200
    v_lshrrev_b32 v201, 16, v201
    v_mul_u32_u24 v202, 14, v201
    v_sub_u32 v202, v200, v202
    v_mul_u32_u24 v203, 240, v201
    v_lshl_add_u32 v203, v202, 4, v203
    v_add_u32 v203, s38, v203
    ds_read_b128 v[36:39], v203
    v_add_u32 v201, s37, v201
    v_mul_lo_u32 v201, v201, s48
    v_lshl_add_u32 v202, v202, 4, s39
    v_add_u32 v40, v201, v202
    v_add_u32 v200, 320, v0
    v_mul_u32_u24 v201, s46, v200
    v_lshrrev_b32 v201, 16, v201
    v_mul_u32_u24 v202, 14, v201
    v_sub_u32 v202, v200, v202
    v_mul_u32_u24 v203, 240, v201
    v_lshl_add_u32 v203, v202, 4, v203
    v_add_u32 v203, s38, v203
    ds_read_b128 v[44:47], v203
    v_add_u32 v201, s37, v201
    v_mul_lo_u32 v201, v201, s48
    v_lshl_add_u32 v202, v202, 4, s39
    v_add_u32 v48, v201, v202
    v_add_u32 v200, 384, v0
    v_mul_u32_u24 v201, s46, v200
    v_lshrrev_b32 v201, 16, v201
    v_mul_u32_u24 v202, 14, v201
    v_sub_u32 v202, v200, v202
    v_mul_u32_u24 v203, 240, v201
    v_lshl_add_u32 v203, v202, 4, v203
    v_add_u32 v203, s38, v203
    ds_read_b128 v[52:55], v203
    v_add_u32 v201, s37, v201
    v_mul_lo_u32 v201, v201, s48
    v_lshl_add_u32 v202, v202, 4, s39
    v_add_u32 v56, v201, v202
    s_waitcnt lgkmcnt(6)
    buffer_store_dwordx4 v[4:7], v8, s[20:23], 0 offen
    s_waitcnt lgkmcnt(5)
    buffer_store_dwordx4 v[12:15], v16, s[20:23], 0 offen
    s_waitcnt lgkmcnt(4)
    buffer_store_dwordx4 v[20:23], v24, s[20:23], 0 offen
    s_waitcnt lgkmcnt(3)
    buffer_store_dwordx4 v[28:31], v32, s[20:23], 0 offen
    s_waitcnt lgkmcnt(2)
    buffer_store_dwordx4 v[36:39], v40, s[20:23], 0 offen
    s_waitcnt lgkmcnt(1)
    buffer_store_dwordx4 v[44:47], v48, s[20:23], 0 offen
    s_waitcnt lgkmcnt(0)
    buffer_store_dwordx4 v[52:55], v56, s[20:23], 0 offen
L_gu_kernel_end:
    s_endpgm
.globl down_kernel
.p2align 8
.type down_kernel,@function
down_kernel:
    s_cmp_ge_u32 s2, 256
    s_cbranch_scc1 L_down_kernel_end
    s_load_dwordx2 s[4:5], s[0:1], 104
    s_load_dwordx2 s[6:7], s[0:1], 64
    s_load_dwordx2 s[42:43], s[0:1], 0
    s_load_dwordx2 s[44:45], s[0:1], 88
    v_lshrrev_b32 v1, 6, v0
    v_and_b32 v0, 63, v0
    s_nop 0
    v_readfirstlane_b32 s34, v1
    s_and_b32 s3, s2, 7
    s_lshr_b32 s35, s2, 3
    s_and_b32 s32, s3, 3
    s_lshl_b32 s32, s32, 2
    s_and_b32 s36, s35, 3
    s_add_u32 s32, s32, s36
    s_lshr_b32 s33, s3, 2
    s_lshl_b32 s33, s33, 3
    s_lshr_b32 s36, s35, 2
    s_add_u32 s33, s33, s36
    s_lshl_b32 s32, s32, 7
    s_waitcnt lgkmcnt(0)
    s_add_u32 s8, s4, 0x3000000
    s_addc_u32 s9, s5, 0
    s_mov_b32 s10, 0xe00000
    s_mov_b32 s11, 0x00020000
    s_mov_b32 s12, s6
    s_mov_b32 s13, s7
    s_mov_b32 s14, 0x700000
    s_mov_b32 s15, 0x00020000
    s_mov_b32 s20, s44
    s_mov_b32 s21, s45
    s_mov_b32 s22, 0x400000
    s_mov_b32 s23, 0x00020000
    s_add_u32 s24, s4, 0x500000
    s_addc_u32 s25, s5, 0
    s_mov_b32 s26, 0x400000
    s_mov_b32 s27, 0x00020000
    s_mov_b32 s28, s4
    s_mov_b32 s29, s5
    s_mov_b32 s30, 0x6000
    s_mov_b32 s31, 0x00020000
    s_cmp_ge_u32 s34, 4
    s_cbranch_scc1 L_down_kernel_loader
    s_and_b32 s36, s34, 1
    s_lshr_b32 s37, s34, 1
    v_and_b32 v92, 15, v0
    v_lshrrev_b32 v93, 4, v0
    v_lshrrev_b32 v94, 1, v92
    v_xor_b32 v94, v93, v94
    v_lshlrev_b32 v94, 4, v94
    v_lshl_add_u32 v94, v92, 7, v94
    s_lshl_b32 s38, s36, 13
    v_add_u32 v88, s38, v94
    v_xor_b32 v89, 64, v88
    v_lshrrev_b32 v94, 3, v92
    v_and_b32 v95, 1, v93
    v_lshl_or_b32 v94, v95, 1, v94
    s_lshl_b32 s38, s37, 1
    v_xor_b32 v94, s38, v94
    v_lshlrev_b32 v94, 5, v94
    v_and_b32 v95, 3, v92
    v_lshl_add_u32 v94, v95, 3, v94
    v_lshrrev_b32 v95, 2, v92
    v_lshl_add_u32 v95, v93, 3, v95
    v_lshl_add_u32 v90, v95, 7, v94
    v_add_u32 v90, 16384, v90
    v_xor_b32 v91, 32, v90
    v_mov_b32 v84, v88
    v_mov_b32 v85, v89
    v_mov_b32 v86, v90
    v_mov_b32 v87, v91
    v_mov_b32 v4, 0
    v_mov_b32 v5, 0
    v_mov_b32 v6, 0
    v_mov_b32 v7, 0
    v_mov_b32 v8, 0
    v_mov_b32 v9, 0
    v_mov_b32 v10, 0
    v_mov_b32 v11, 0
    v_mov_b32 v12, 0
    v_mov_b32 v13, 0
    v_mov_b32 v14, 0
    v_mov_b32 v15, 0
    v_mov_b32 v16, 0
    v_mov_b32 v17, 0
    v_mov_b32 v18, 0
    v_mov_b32 v19, 0
    v_mov_b32 v20, 0
    v_mov_b32 v21, 0
    v_mov_b32 v22, 0
    v_mov_b32 v23, 0
    v_mov_b32 v24, 0
    v_mov_b32 v25, 0
    v_mov_b32 v26, 0
    v_mov_b32 v27, 0
    v_mov_b32 v28, 0
    v_mov_b32 v29, 0
    v_mov_b32 v30, 0
    v_mov_b32 v31, 0
    v_mov_b32 v32, 0
    v_mov_b32 v33, 0
    v_mov_b32 v34, 0
    v_mov_b32 v35, 0
    v_and_b32 v93, 15, v0
    v_lshrrev_b32 v94, 4, v0
    s_lshl_b32 s46, s36, 6
    s_add_u32 s46, s46, s32
    v_add_u32 v93, s46, v93
    v_lshlrev_b32 v93, 11, v93
    s_lshl_b32 s46, s33, 7
    s_lshl_b32 s47, s37, 6
    s_add_u32 s46, s46, s47
    v_lshl_add_u32 v94, v94, 3, s46
    v_add_u32 v92, v93, v94
    v_and_b32 v93, 15, v0
    s_lshl_b32 s46, s36, 6
    v_add_u32 v93, s46, v93
    v_mul_u32_u24 v93, 144, v93
    v_lshrrev_b32 v95, 4, v0
    s_lshl_b32 s47, s37, 6
    s_add_u32 s47, s47, 73728
    v_lshl_add_u32 v95, v95, 3, s47
    v_add_u32 v100, v93, v95
    v_lshlrev_b32 v95, 1, v94
    s_mov_b32 s46, 20480
    buffer_load_dwordx4 v[104:107], v95, s[28:31], s46 offen offset:0
    buffer_load_dwordx4 v[108:111], v95, s[28:31], s46 offen offset:64
    s_mov_b32 s46, 0
    buffer_load_dwordx2 v[112:113], v92, s[24:27], s46 offen offset:0
    buffer_load_dwordx2 v[114:115], v92, s[24:27], s46 offen offset:32
    s_mov_b32 s46, 32768
    buffer_load_dwordx2 v[116:117], v92, s[24:27], s46 offen offset:0
    buffer_load_dwordx2 v[118:119], v92, s[24:27], s46 offen offset:32
    s_mov_b32 s46, 65536
    buffer_load_dwordx2 v[120:121], v92, s[24:27], s46 offen offset:0
    buffer_load_dwordx2 v[122:123], v92, s[24:27], s46 offen offset:32
    s_mov_b32 s46, 98304
    buffer_load_dwordx2 v[124:125], v92, s[24:27], s46 offen offset:0
    buffer_load_dwordx2 v[126:127], v92, s[24:27], s46 offen offset:32
    s_mov_b32 s39, 0
    s_mov_b32 s35, 0
    s_barrier
    ds_read_b128 v[36:39], v84 offset:0
    ds_read_b128 v[40:43], v84 offset:2048
    ds_read_b128 v[44:47], v84 offset:4096
    ds_read_b128 v[48:51], v84 offset:6144
    ds_read_b64_tr_b16 v[52:53], v86 offset:0
    ds_read_b64_tr_b16 v[54:55], v86 offset:512
    ds_read_b64_tr_b16 v[56:57], v87 offset:0
    ds_read_b64_tr_b16 v[58:59], v87 offset:512
L_down_kernel_cloop:
    s_waitcnt lgkmcnt(0)
    v_mfma_f32_16x16x32_bf16 v[4:7], v[52:55], v[36:39], v[4:7]
    ds_read_b128 v[60:63], v85 offset:0
    ds_read_b128 v[64:67], v85 offset:2048
    v_mfma_f32_16x16x32_bf16 v[8:11], v[56:59], v[36:39], v[8:11]
    ds_read_b128 v[68:71], v85 offset:4096
    ds_read_b128 v[72:75], v85 offset:6144
    v_mfma_f32_16x16x32_bf16 v[12:15], v[52:55], v[40:43], v[12:15]
    ds_read_b64_tr_b16 v[76:77], v86 offset:4096
    ds_read_b64_tr_b16 v[78:79], v86 offset:4608
    v_mfma_f32_16x16x32_bf16 v[16:19], v[56:59], v[40:43], v[16:19]
    ds_read_b64_tr_b16 v[80:81], v87 offset:4096
    ds_read_b64_tr_b16 v[82:83], v87 offset:4608
    v_mfma_f32_16x16x32_bf16 v[20:23], v[52:55], v[44:47], v[20:23]
    v_mfma_f32_16x16x32_bf16 v[24:27], v[56:59], v[44:47], v[24:27]
    v_mfma_f32_16x16x32_bf16 v[28:31], v[52:55], v[48:51], v[28:31]
    v_mfma_f32_16x16x32_bf16 v[32:35], v[56:59], v[48:51], v[32:35]
    s_waitcnt lgkmcnt(0)
    s_barrier
    s_add_u32 s39, s39, 24576
    s_cmp_ge_u32 s39, 147456
    s_cselect_b32 s39, 0, s39
    v_add_u32 v84, s39, v88
    v_add_u32 v85, s39, v89
    v_add_u32 v86, s39, v90
    v_add_u32 v87, s39, v91
    v_mfma_f32_16x16x32_bf16 v[4:7], v[76:79], v[60:63], v[4:7]
    ds_read_b128 v[36:39], v84 offset:0
    ds_read_b128 v[40:43], v84 offset:2048
    v_mfma_f32_16x16x32_bf16 v[8:11], v[80:83], v[60:63], v[8:11]
    ds_read_b128 v[44:47], v84 offset:4096
    ds_read_b128 v[48:51], v84 offset:6144
    v_mfma_f32_16x16x32_bf16 v[12:15], v[76:79], v[64:67], v[12:15]
    ds_read_b64_tr_b16 v[52:53], v86 offset:0
    ds_read_b64_tr_b16 v[54:55], v86 offset:512
    v_mfma_f32_16x16x32_bf16 v[16:19], v[80:83], v[64:67], v[16:19]
    ds_read_b64_tr_b16 v[56:57], v87 offset:0
    ds_read_b64_tr_b16 v[58:59], v87 offset:512
    v_mfma_f32_16x16x32_bf16 v[20:23], v[76:79], v[68:71], v[20:23]
    v_mfma_f32_16x16x32_bf16 v[24:27], v[80:83], v[68:71], v[24:27]
    v_mfma_f32_16x16x32_bf16 v[28:31], v[76:79], v[72:75], v[28:31]
    v_mfma_f32_16x16x32_bf16 v[32:35], v[80:83], v[72:75], v[32:35]
    s_add_u32 s35, s35, 1
    s_cmp_lt_u32 s35, 55
    s_cbranch_scc1 L_down_kernel_cloop
    s_waitcnt lgkmcnt(0)
    v_mfma_f32_16x16x32_bf16 v[4:7], v[52:55], v[36:39], v[4:7]
    ds_read_b128 v[60:63], v85 offset:0
    ds_read_b128 v[64:67], v85 offset:2048
    v_mfma_f32_16x16x32_bf16 v[8:11], v[56:59], v[36:39], v[8:11]
    ds_read_b128 v[68:71], v85 offset:4096
    ds_read_b128 v[72:75], v85 offset:6144
    v_mfma_f32_16x16x32_bf16 v[12:15], v[52:55], v[40:43], v[12:15]
    ds_read_b64_tr_b16 v[76:77], v86 offset:4096
    ds_read_b64_tr_b16 v[78:79], v86 offset:4608
    v_mfma_f32_16x16x32_bf16 v[16:19], v[56:59], v[40:43], v[16:19]
    ds_read_b64_tr_b16 v[80:81], v87 offset:4096
    ds_read_b64_tr_b16 v[82:83], v87 offset:4608
    v_mfma_f32_16x16x32_bf16 v[20:23], v[52:55], v[44:47], v[20:23]
    v_mfma_f32_16x16x32_bf16 v[24:27], v[56:59], v[44:47], v[24:27]
    v_mfma_f32_16x16x32_bf16 v[28:31], v[52:55], v[48:51], v[28:31]
    v_mfma_f32_16x16x32_bf16 v[32:35], v[56:59], v[48:51], v[32:35]
    s_waitcnt lgkmcnt(0)
    v_mfma_f32_16x16x32_bf16 v[4:7], v[76:79], v[60:63], v[4:7]
    v_mfma_f32_16x16x32_bf16 v[8:11], v[80:83], v[60:63], v[8:11]
    v_mfma_f32_16x16x32_bf16 v[12:15], v[76:79], v[64:67], v[12:15]
    v_mfma_f32_16x16x32_bf16 v[16:19], v[80:83], v[64:67], v[16:19]
    v_mfma_f32_16x16x32_bf16 v[20:23], v[76:79], v[68:71], v[20:23]
    v_mfma_f32_16x16x32_bf16 v[24:27], v[80:83], v[68:71], v[24:27]
    v_mfma_f32_16x16x32_bf16 v[28:31], v[76:79], v[72:75], v[28:31]
    v_mfma_f32_16x16x32_bf16 v[32:35], v[80:83], v[72:75], v[32:35]
    s_mov_b32 s47, 0xffff0000
    s_waitcnt vmcnt(0)
    v_cvt_pk_bf16_f32 v4, 0, v4
    v_cvt_pk_bf16_f32 v5, 0, v5
    v_cvt_pk_bf16_f32 v6, 0, v6
    v_cvt_pk_bf16_f32 v7, 0, v7
    v_mul_f32 v4, v4, v104
    v_mul_f32 v5, v5, v105
    v_mul_f32 v6, v6, v106
    v_mul_f32 v7, v7, v107
    v_cvt_pk_bf16_f32 v4, 0, v4
    v_cvt_pk_bf16_f32 v5, 0, v5
    v_cvt_pk_bf16_f32 v6, 0, v6
    v_cvt_pk_bf16_f32 v7, 0, v7
    v_lshlrev_b32 v96, 16, v112
    v_and_b32 v97, s47, v112
    v_lshlrev_b32 v98, 16, v113
    v_and_b32 v99, s47, v113
    v_add_f32 v4, v4, v96
    v_add_f32 v5, v5, v97
    v_add_f32 v6, v6, v98
    v_add_f32 v7, v7, v99
    v_cvt_pk_bf16_f32 v4, v4, v5
    v_cvt_pk_bf16_f32 v5, v6, v7
    ds_write_b64 v100, v[4:5] offset:0
    v_cvt_pk_bf16_f32 v8, 0, v8
    v_cvt_pk_bf16_f32 v9, 0, v9
    v_cvt_pk_bf16_f32 v10, 0, v10
    v_cvt_pk_bf16_f32 v11, 0, v11
    v_mul_f32 v8, v8, v108
    v_mul_f32 v9, v9, v109
    v_mul_f32 v10, v10, v110
    v_mul_f32 v11, v11, v111
    v_cvt_pk_bf16_f32 v8, 0, v8
    v_cvt_pk_bf16_f32 v9, 0, v9
    v_cvt_pk_bf16_f32 v10, 0, v10
    v_cvt_pk_bf16_f32 v11, 0, v11
    v_lshlrev_b32 v96, 16, v114
    v_and_b32 v97, s47, v114
    v_lshlrev_b32 v98, 16, v115
    v_and_b32 v99, s47, v115
    v_add_f32 v8, v8, v96
    v_add_f32 v9, v9, v97
    v_add_f32 v10, v10, v98
    v_add_f32 v11, v11, v99
    v_cvt_pk_bf16_f32 v8, v8, v9
    v_cvt_pk_bf16_f32 v9, v10, v11
    ds_write_b64 v100, v[8:9] offset:32
    v_cvt_pk_bf16_f32 v12, 0, v12
    v_cvt_pk_bf16_f32 v13, 0, v13
    v_cvt_pk_bf16_f32 v14, 0, v14
    v_cvt_pk_bf16_f32 v15, 0, v15
    v_mul_f32 v12, v12, v104
    v_mul_f32 v13, v13, v105
    v_mul_f32 v14, v14, v106
    v_mul_f32 v15, v15, v107
    v_cvt_pk_bf16_f32 v12, 0, v12
    v_cvt_pk_bf16_f32 v13, 0, v13
    v_cvt_pk_bf16_f32 v14, 0, v14
    v_cvt_pk_bf16_f32 v15, 0, v15
    v_lshlrev_b32 v96, 16, v116
    v_and_b32 v97, s47, v116
    v_lshlrev_b32 v98, 16, v117
    v_and_b32 v99, s47, v117
    v_add_f32 v12, v12, v96
    v_add_f32 v13, v13, v97
    v_add_f32 v14, v14, v98
    v_add_f32 v15, v15, v99
    v_cvt_pk_bf16_f32 v12, v12, v13
    v_cvt_pk_bf16_f32 v13, v14, v15
    ds_write_b64 v100, v[12:13] offset:2304
    v_cvt_pk_bf16_f32 v16, 0, v16
    v_cvt_pk_bf16_f32 v17, 0, v17
    v_cvt_pk_bf16_f32 v18, 0, v18
    v_cvt_pk_bf16_f32 v19, 0, v19
    v_mul_f32 v16, v16, v108
    v_mul_f32 v17, v17, v109
    v_mul_f32 v18, v18, v110
    v_mul_f32 v19, v19, v111
    v_cvt_pk_bf16_f32 v16, 0, v16
    v_cvt_pk_bf16_f32 v17, 0, v17
    v_cvt_pk_bf16_f32 v18, 0, v18
    v_cvt_pk_bf16_f32 v19, 0, v19
    v_lshlrev_b32 v96, 16, v118
    v_and_b32 v97, s47, v118
    v_lshlrev_b32 v98, 16, v119
    v_and_b32 v99, s47, v119
    v_add_f32 v16, v16, v96
    v_add_f32 v17, v17, v97
    v_add_f32 v18, v18, v98
    v_add_f32 v19, v19, v99
    v_cvt_pk_bf16_f32 v16, v16, v17
    v_cvt_pk_bf16_f32 v17, v18, v19
    ds_write_b64 v100, v[16:17] offset:2336
    v_cvt_pk_bf16_f32 v20, 0, v20
    v_cvt_pk_bf16_f32 v21, 0, v21
    v_cvt_pk_bf16_f32 v22, 0, v22
    v_cvt_pk_bf16_f32 v23, 0, v23
    v_mul_f32 v20, v20, v104
    v_mul_f32 v21, v21, v105
    v_mul_f32 v22, v22, v106
    v_mul_f32 v23, v23, v107
    v_cvt_pk_bf16_f32 v20, 0, v20
    v_cvt_pk_bf16_f32 v21, 0, v21
    v_cvt_pk_bf16_f32 v22, 0, v22
    v_cvt_pk_bf16_f32 v23, 0, v23
    v_lshlrev_b32 v96, 16, v120
    v_and_b32 v97, s47, v120
    v_lshlrev_b32 v98, 16, v121
    v_and_b32 v99, s47, v121
    v_add_f32 v20, v20, v96
    v_add_f32 v21, v21, v97
    v_add_f32 v22, v22, v98
    v_add_f32 v23, v23, v99
    v_cvt_pk_bf16_f32 v20, v20, v21
    v_cvt_pk_bf16_f32 v21, v22, v23
    ds_write_b64 v100, v[20:21] offset:4608
    v_cvt_pk_bf16_f32 v24, 0, v24
    v_cvt_pk_bf16_f32 v25, 0, v25
    v_cvt_pk_bf16_f32 v26, 0, v26
    v_cvt_pk_bf16_f32 v27, 0, v27
    v_mul_f32 v24, v24, v108
    v_mul_f32 v25, v25, v109
    v_mul_f32 v26, v26, v110
    v_mul_f32 v27, v27, v111
    v_cvt_pk_bf16_f32 v24, 0, v24
    v_cvt_pk_bf16_f32 v25, 0, v25
    v_cvt_pk_bf16_f32 v26, 0, v26
    v_cvt_pk_bf16_f32 v27, 0, v27
    v_lshlrev_b32 v96, 16, v122
    v_and_b32 v97, s47, v122
    v_lshlrev_b32 v98, 16, v123
    v_and_b32 v99, s47, v123
    v_add_f32 v24, v24, v96
    v_add_f32 v25, v25, v97
    v_add_f32 v26, v26, v98
    v_add_f32 v27, v27, v99
    v_cvt_pk_bf16_f32 v24, v24, v25
    v_cvt_pk_bf16_f32 v25, v26, v27
    ds_write_b64 v100, v[24:25] offset:4640
    v_cvt_pk_bf16_f32 v28, 0, v28
    v_cvt_pk_bf16_f32 v29, 0, v29
    v_cvt_pk_bf16_f32 v30, 0, v30
    v_cvt_pk_bf16_f32 v31, 0, v31
    v_mul_f32 v28, v28, v104
    v_mul_f32 v29, v29, v105
    v_mul_f32 v30, v30, v106
    v_mul_f32 v31, v31, v107
    v_cvt_pk_bf16_f32 v28, 0, v28
    v_cvt_pk_bf16_f32 v29, 0, v29
    v_cvt_pk_bf16_f32 v30, 0, v30
    v_cvt_pk_bf16_f32 v31, 0, v31
    v_lshlrev_b32 v96, 16, v124
    v_and_b32 v97, s47, v124
    v_lshlrev_b32 v98, 16, v125
    v_and_b32 v99, s47, v125
    v_add_f32 v28, v28, v96
    v_add_f32 v29, v29, v97
    v_add_f32 v30, v30, v98
    v_add_f32 v31, v31, v99
    v_cvt_pk_bf16_f32 v28, v28, v29
    v_cvt_pk_bf16_f32 v29, v30, v31
    ds_write_b64 v100, v[28:29] offset:6912
    v_cvt_pk_bf16_f32 v32, 0, v32
    v_cvt_pk_bf16_f32 v33, 0, v33
    v_cvt_pk_bf16_f32 v34, 0, v34
    v_cvt_pk_bf16_f32 v35, 0, v35
    v_mul_f32 v32, v32, v108
    v_mul_f32 v33, v33, v109
    v_mul_f32 v34, v34, v110
    v_mul_f32 v35, v35, v111
    v_cvt_pk_bf16_f32 v32, 0, v32
    v_cvt_pk_bf16_f32 v33, 0, v33
    v_cvt_pk_bf16_f32 v34, 0, v34
    v_cvt_pk_bf16_f32 v35, 0, v35
    v_lshlrev_b32 v96, 16, v126
    v_and_b32 v97, s47, v126
    v_lshlrev_b32 v98, 16, v127
    v_and_b32 v99, s47, v127
    v_add_f32 v32, v32, v96
    v_add_f32 v33, v33, v97
    v_add_f32 v34, v34, v98
    v_add_f32 v35, v35, v99
    v_cvt_pk_bf16_f32 v32, v32, v33
    v_cvt_pk_bf16_f32 v33, v34, v35
    ds_write_b64 v100, v[32:33] offset:6944
    s_waitcnt lgkmcnt(0)
    s_barrier
    v_lshrrev_b32 v4, 3, v0
    v_and_b32 v5, 7, v0
    s_lshl_b32 s46, s34, 4
    v_add_u32 v4, s46, v4
    v_mul_u32_u24 v6, 144, v4
    v_lshl_add_u32 v6, v5, 4, v6
    v_add_u32 v6, 73728, v6
    v_add_u32 v4, s32, v4
    v_lshlrev_b32 v4, 11, v4
    s_lshl_b32 s46, s33, 7
    v_lshl_add_u32 v5, v5, 4, s46
    v_add_u32 v4, v4, v5
    ds_read_b128 v[8:11], v6
    ds_read_b128 v[12:15], v6 offset:1152
    s_mov_b32 s46, 16384
    s_waitcnt lgkmcnt(1)
    buffer_store_dwordx4 v[8:11], v4, s[20:23], 0 offen
    s_waitcnt lgkmcnt(0)
    buffer_store_dwordx4 v[12:15], v4, s[20:23], s46 offen
    s_endpgm
L_down_kernel_loader:
    s_sub_u32 s34, s34, 4
    v_lshrrev_b32 v1, 3, v0
    v_and_b32 v2, 7, v0
    v_lshrrev_b32 v3, 4, v0
    s_lshl_b32 s46, s34, 5
    s_add_u32 s46, s46, s32
    s_mov_b32 s48, 7168
    v_add_u32 v4, 0, v3
    v_and_b32 v4, 7, v4
    v_xor_b32 v4, v2, v4
    v_lshlrev_b32 v4, 4, v4
    v_add_u32 v5, s46, v1
    v_add_u32 v5, 0, v5
    v_mul_lo_u32 v5, v5, s48
    v_add_u32 v8, v5, v4
    v_add_u32 v4, 4, v3
    v_and_b32 v4, 7, v4
    v_xor_b32 v4, v2, v4
    v_lshlrev_b32 v4, 4, v4
    v_add_u32 v5, s46, v1
    v_add_u32 v5, 8, v5
    v_mul_lo_u32 v5, v5, s48
    v_add_u32 v9, v5, v4
    v_add_u32 v4, 0, v3
    v_and_b32 v4, 7, v4
    v_xor_b32 v4, v2, v4
    v_lshlrev_b32 v4, 4, v4
    v_add_u32 v5, s46, v1
    v_add_u32 v5, 16, v5
    v_mul_lo_u32 v5, v5, s48
    v_add_u32 v10, v5, v4
    v_add_u32 v4, 4, v3
    v_and_b32 v4, 7, v4
    v_xor_b32 v4, v2, v4
    v_lshlrev_b32 v4, 4, v4
    v_add_u32 v5, s46, v1
    v_add_u32 v5, 24, v5
    v_mul_lo_u32 v5, v5, s48
    v_add_u32 v11, v5, v4
    s_lshl_b32 s46, s34, 4
    s_lshl_b32 s47, s33, 7
    v_and_b32 v4, 1, v3
    v_or_b32 v4, 0, v4
    v_lshrrev_b32 v5, 1, v2
    v_xor_b32 v4, v5, v4
    v_lshlrev_b32 v4, 5, v4
    v_and_b32 v5, 1, v2
    v_lshl_add_u32 v4, v5, 4, v4
    v_add_u32 v5, s46, v1
    v_add_u32 v5, 0, v5
    v_lshlrev_b32 v5, 11, v5
    v_add3_u32 v16, v5, v4, s47
    v_and_b32 v4, 1, v3
    v_or_b32 v4, 2, v4
    v_lshrrev_b32 v5, 1, v2
    v_xor_b32 v4, v5, v4
    v_lshlrev_b32 v4, 5, v4
    v_and_b32 v5, 1, v2
    v_lshl_add_u32 v4, v5, 4, v4
    v_add_u32 v5, s46, v1
    v_add_u32 v5, 8, v5
    v_lshlrev_b32 v5, 11, v5
    v_add3_u32 v17, v5, v4, s47
    s_lshl_b32 s50, s34, 12
    s_lshl_b32 s51, s34, 11
    s_add_u32 s51, s51, 16384
    s_mov_b32 s52, 0
    s_mov_b32 s53, 0
    s_mov_b32 s39, 0
    s_add_u32 s54, s39, s50
    s_add_u32 m0, s54, 0
    s_nop 0
    buffer_load_dwordx4 v8, s[8:11], s52 offen lds
    s_add_u32 s54, s39, s50
    s_add_u32 m0, s54, 1024
    s_nop 0
    buffer_load_dwordx4 v9, s[8:11], s52 offen lds
    s_add_u32 s54, s39, s50
    s_add_u32 m0, s54, 2048
    s_nop 0
    buffer_load_dwordx4 v10, s[8:11], s52 offen lds
    s_add_u32 s54, s39, s50
    s_add_u32 m0, s54, 3072
    s_nop 0
    buffer_load_dwordx4 v11, s[8:11], s52 offen lds
    s_add_u32 s54, s39, s51
    s_add_u32 m0, s54, 0
    s_nop 0
    buffer_load_dwordx4 v16, s[12:15], s53 offen lds
    s_add_u32 s54, s39, s51
    s_add_u32 m0, s54, 1024
    s_nop 0
    buffer_load_dwordx4 v17, s[12:15], s53 offen lds
    s_add_u32 s52, s52, 128
    s_add_u32 s53, s53, 131072
    s_add_u32 s39, s39, 24576
    s_cmp_ge_u32 s39, 147456
    s_cselect_b32 s39, 0, s39
    s_add_u32 s54, s39, s50
    s_add_u32 m0, s54, 0
    s_nop 0
    buffer_load_dwordx4 v8, s[8:11], s52 offen lds
    s_add_u32 s54, s39, s50
    s_add_u32 m0, s54, 1024
    s_nop 0
    buffer_load_dwordx4 v9, s[8:11], s52 offen lds
    s_add_u32 s54, s39, s50
    s_add_u32 m0, s54, 2048
    s_nop 0
    buffer_load_dwordx4 v10, s[8:11], s52 offen lds
    s_add_u32 s54, s39, s50
    s_add_u32 m0, s54, 3072
    s_nop 0
    buffer_load_dwordx4 v11, s[8:11], s52 offen lds
    s_add_u32 s54, s39, s51
    s_add_u32 m0, s54, 0
    s_nop 0
    buffer_load_dwordx4 v16, s[12:15], s53 offen lds
    s_add_u32 s54, s39, s51
    s_add_u32 m0, s54, 1024
    s_nop 0
    buffer_load_dwordx4 v17, s[12:15], s53 offen lds
    s_add_u32 s52, s52, 128
    s_add_u32 s53, s53, 131072
    s_add_u32 s39, s39, 24576
    s_cmp_ge_u32 s39, 147456
    s_cselect_b32 s39, 0, s39
    s_add_u32 s54, s39, s50
    s_add_u32 m0, s54, 0
    s_nop 0
    buffer_load_dwordx4 v8, s[8:11], s52 offen lds
    s_add_u32 s54, s39, s50
    s_add_u32 m0, s54, 1024
    s_nop 0
    buffer_load_dwordx4 v9, s[8:11], s52 offen lds
    s_add_u32 s54, s39, s50
    s_add_u32 m0, s54, 2048
    s_nop 0
    buffer_load_dwordx4 v10, s[8:11], s52 offen lds
    s_add_u32 s54, s39, s50
    s_add_u32 m0, s54, 3072
    s_nop 0
    buffer_load_dwordx4 v11, s[8:11], s52 offen lds
    s_add_u32 s54, s39, s51
    s_add_u32 m0, s54, 0
    s_nop 0
    buffer_load_dwordx4 v16, s[12:15], s53 offen lds
    s_add_u32 s54, s39, s51
    s_add_u32 m0, s54, 1024
    s_nop 0
    buffer_load_dwordx4 v17, s[12:15], s53 offen lds
    s_add_u32 s52, s52, 128
    s_add_u32 s53, s53, 131072
    s_add_u32 s39, s39, 24576
    s_cmp_ge_u32 s39, 147456
    s_cselect_b32 s39, 0, s39
    s_add_u32 s54, s39, s50
    s_add_u32 m0, s54, 0
    s_nop 0
    buffer_load_dwordx4 v8, s[8:11], s52 offen lds
    s_add_u32 s54, s39, s50
    s_add_u32 m0, s54, 1024
    s_nop 0
    buffer_load_dwordx4 v9, s[8:11], s52 offen lds
    s_add_u32 s54, s39, s50
    s_add_u32 m0, s54, 2048
    s_nop 0
    buffer_load_dwordx4 v10, s[8:11], s52 offen lds
    s_add_u32 s54, s39, s50
    s_add_u32 m0, s54, 3072
    s_nop 0
    buffer_load_dwordx4 v11, s[8:11], s52 offen lds
    s_add_u32 s54, s39, s51
    s_add_u32 m0, s54, 0
    s_nop 0
    buffer_load_dwordx4 v16, s[12:15], s53 offen lds
    s_add_u32 s54, s39, s51
    s_add_u32 m0, s54, 1024
    s_nop 0
    buffer_load_dwordx4 v17, s[12:15], s53 offen lds
    s_add_u32 s52, s52, 128
    s_add_u32 s53, s53, 131072
    s_add_u32 s39, s39, 24576
    s_cmp_ge_u32 s39, 147456
    s_cselect_b32 s39, 0, s39
    s_add_u32 s54, s39, s50
    s_add_u32 m0, s54, 0
    s_nop 0
    buffer_load_dwordx4 v8, s[8:11], s52 offen lds
    s_add_u32 s54, s39, s50
    s_add_u32 m0, s54, 1024
    s_nop 0
    buffer_load_dwordx4 v9, s[8:11], s52 offen lds
    s_add_u32 s54, s39, s50
    s_add_u32 m0, s54, 2048
    s_nop 0
    buffer_load_dwordx4 v10, s[8:11], s52 offen lds
    s_add_u32 s54, s39, s50
    s_add_u32 m0, s54, 3072
    s_nop 0
    buffer_load_dwordx4 v11, s[8:11], s52 offen lds
    s_add_u32 s54, s39, s51
    s_add_u32 m0, s54, 0
    s_nop 0
    buffer_load_dwordx4 v16, s[12:15], s53 offen lds
    s_add_u32 s54, s39, s51
    s_add_u32 m0, s54, 1024
    s_nop 0
    buffer_load_dwordx4 v17, s[12:15], s53 offen lds
    s_add_u32 s52, s52, 128
    s_add_u32 s53, s53, 131072
    s_add_u32 s39, s39, 24576
    s_cmp_ge_u32 s39, 147456
    s_cselect_b32 s39, 0, s39
    s_add_u32 s54, s39, s50
    s_add_u32 m0, s54, 0
    s_nop 0
    buffer_load_dwordx4 v8, s[8:11], s52 offen lds
    s_add_u32 s54, s39, s50
    s_add_u32 m0, s54, 1024
    s_nop 0
    buffer_load_dwordx4 v9, s[8:11], s52 offen lds
    s_add_u32 s54, s39, s50
    s_add_u32 m0, s54, 2048
    s_nop 0
    buffer_load_dwordx4 v10, s[8:11], s52 offen lds
    s_add_u32 s54, s39, s50
    s_add_u32 m0, s54, 3072
    s_nop 0
    buffer_load_dwordx4 v11, s[8:11], s52 offen lds
    s_add_u32 s54, s39, s51
    s_add_u32 m0, s54, 0
    s_nop 0
    buffer_load_dwordx4 v16, s[12:15], s53 offen lds
    s_add_u32 s54, s39, s51
    s_add_u32 m0, s54, 1024
    s_nop 0
    buffer_load_dwordx4 v17, s[12:15], s53 offen lds
    s_add_u32 s52, s52, 128
    s_add_u32 s53, s53, 131072
    s_add_u32 s39, s39, 24576
    s_cmp_ge_u32 s39, 147456
    s_cselect_b32 s39, 0, s39
    s_waitcnt vmcnt(30)
    s_barrier
    s_mov_b32 s35, 0
L_down_kernel_lloop:
    s_waitcnt vmcnt(24)
    s_barrier
    s_add_u32 s54, s39, s50
    s_add_u32 m0, s54, 0
    s_nop 0
    buffer_load_dwordx4 v8, s[8:11], s52 offen lds
    s_add_u32 s54, s39, s50
    s_add_u32 m0, s54, 1024
    s_nop 0
    buffer_load_dwordx4 v9, s[8:11], s52 offen lds
    s_add_u32 s54, s39, s50
    s_add_u32 m0, s54, 2048
    s_nop 0
    buffer_load_dwordx4 v10, s[8:11], s52 offen lds
    s_add_u32 s54, s39, s50
    s_add_u32 m0, s54, 3072
    s_nop 0
    buffer_load_dwordx4 v11, s[8:11], s52 offen lds
    s_add_u32 s54, s39, s51
    s_add_u32 m0, s54, 0
    s_nop 0
    buffer_load_dwordx4 v16, s[12:15], s53 offen lds
    s_add_u32 s54, s39, s51
    s_add_u32 m0, s54, 1024
    s_nop 0
    buffer_load_dwordx4 v17, s[12:15], s53 offen lds
    s_add_u32 s52, s52, 128
    s_add_u32 s53, s53, 131072
    s_add_u32 s39, s39, 24576
    s_cmp_ge_u32 s39, 147456
    s_cselect_b32 s39, 0, s39
    s_add_u32 s35, s35, 1
    s_cmp_lt_u32 s35, 50
    s_cbranch_scc1 L_down_kernel_lloop
    s_waitcnt vmcnt(24)
    s_barrier
    s_waitcnt vmcnt(18)
    s_barrier
    s_waitcnt vmcnt(12)
    s_barrier
    s_waitcnt vmcnt(6)
    s_barrier
    s_waitcnt vmcnt(0)
    s_barrier
    s_add_u32 s34, s34, 4
    s_barrier
    v_lshrrev_b32 v4, 3, v0
    v_and_b32 v5, 7, v0
    s_lshl_b32 s46, s34, 4
    v_add_u32 v4, s46, v4
    v_mul_u32_u24 v6, 144, v4
    v_lshl_add_u32 v6, v5, 4, v6
    v_add_u32 v6, 73728, v6
    v_add_u32 v4, s32, v4
    v_lshlrev_b32 v4, 11, v4
    s_lshl_b32 s46, s33, 7
    v_lshl_add_u32 v5, v5, 4, s46
    v_add_u32 v4, v4, v5
    ds_read_b128 v[8:11], v6
    ds_read_b128 v[12:15], v6 offset:1152
    s_mov_b32 s46, 16384
    s_waitcnt lgkmcnt(1)
    buffer_store_dwordx4 v[8:11], v4, s[20:23], 0 offen
    s_waitcnt lgkmcnt(0)
    buffer_store_dwordx4 v[12:15], v4, s[20:23], s46 offen
L_down_kernel_end:
    s_endpgm
.section .rodata,"a"
.p2align 6
.amdhsa_kernel mod_kernel
  .amdhsa_next_free_vgpr 112
  .amdhsa_next_free_sgpr 32
  .amdhsa_accum_offset 112
  .amdhsa_group_segment_fixed_size 0
  .amdhsa_kernarg_size 112
  .amdhsa_user_sgpr_count 2
  .amdhsa_user_sgpr_kernarg_segment_ptr 1
  .amdhsa_system_sgpr_workgroup_id_x 1
.end_amdhsa_kernel
.p2align 6
.amdhsa_kernel ln1_kernel
  .amdhsa_next_free_vgpr 80
  .amdhsa_next_free_sgpr 48
  .amdhsa_accum_offset 80
  .amdhsa_group_segment_fixed_size 0
  .amdhsa_kernarg_size 112
  .amdhsa_user_sgpr_count 2
  .amdhsa_user_sgpr_kernarg_segment_ptr 1
  .amdhsa_system_sgpr_workgroup_id_x 1
.end_amdhsa_kernel
.p2align 6
.amdhsa_kernel attn_kernel
  .amdhsa_next_free_vgpr 224
  .amdhsa_next_free_sgpr 96
  .amdhsa_accum_offset 224
  .amdhsa_group_segment_fixed_size 0
  .amdhsa_kernarg_size 112
  .amdhsa_user_sgpr_count 2
  .amdhsa_user_sgpr_kernarg_segment_ptr 1
  .amdhsa_system_sgpr_workgroup_id_x 1
.end_amdhsa_kernel
.p2align 6
.amdhsa_kernel wo_kernel
  .amdhsa_next_free_vgpr 152
  .amdhsa_next_free_sgpr 64
  .amdhsa_accum_offset 152
  .amdhsa_group_segment_fixed_size 0
  .amdhsa_kernarg_size 112
  .amdhsa_user_sgpr_count 2
  .amdhsa_user_sgpr_kernarg_segment_ptr 1
  .amdhsa_system_sgpr_workgroup_id_x 1
.end_amdhsa_kernel
.p2align 6
.amdhsa_kernel ln2_kernel
  .amdhsa_next_free_vgpr 128
  .amdhsa_next_free_sgpr 48
  .amdhsa_accum_offset 128
  .amdhsa_group_segment_fixed_size 0
  .amdhsa_kernarg_size 112
  .amdhsa_user_sgpr_count 2
  .amdhsa_user_sgpr_kernarg_segment_ptr 1
  .amdhsa_system_sgpr_workgroup_id_x 1
.end_amdhsa_kernel
.p2align 6
.amdhsa_kernel gu_kernel
  .amdhsa_next_free_vgpr 208
  .amdhsa_next_free_sgpr 72
  .amdhsa_accum_offset 208
  .amdhsa_group_segment_fixed_size 0
  .amdhsa_kernarg_size 112
  .amdhsa_user_sgpr_count 2
  .amdhsa_user_sgpr_kernarg_segment_ptr 1
  .amdhsa_system_sgpr_workgroup_id_x 1
.end_amdhsa_kernel
.p2align 6
.amdhsa_kernel down_kernel
  .amdhsa_next_free_vgpr 128
  .amdhsa_next_free_sgpr 64
  .amdhsa_accum_offset 128
  .amdhsa_group_segment_fixed_size 0
  .amdhsa_kernarg_size 112
  .amdhsa_user_sgpr_count 2
  .amdhsa_user_sgpr_kernarg_segment_ptr 1
  .amdhsa_system_sgpr_workgroup_id_x 1
.end_amdhsa_kernel
```
